```python
import torch

def _softmax(x, axis=-1):
    return torch.softmax(x, dim=axis)
def _gelu(x):
    return torch.nn.functional.gelu(x, approximate="tanh")
def _silu(x):
    return torch.nn.functional.silu(x)
def _sigmoid(x):
    return torch.sigmoid(x)
def _layernorm(x, axis=-1, eps=1e-5):
    m = x.mean(dim=axis, keepdim=True)
    v = x.var(dim=axis, keepdim=True, unbiased=False)
    return (x - m) / torch.sqrt(v + eps)
def _scatter_add(tgt, idx, src, axis=0):
    return tgt.clone().index_add_(axis, idx, src)
def _segment_sum(src, seg, n):
    out = torch.zeros((n,) + src.shape[1:], dtype=src.dtype)
    return out.index_add_(0, seg, src)
def _pad(x, pw):
    flat = tuple(v for pair in reversed(pw) for v in pair)
    return torch.nn.functional.pad(x, flat)

kernel_name = 'interleave_layers__ssm_conv_h3__glu_gated_swiglu__prompt'

def setup_inputs():

    _w = (lambda a: (lambda t: t.to(torch.bfloat16) if t.is_floating_point() else t)(torch.as_tensor(a)))
    def _A_setup():
        B, S, D = 1, 2048, 512
        ks = 4
        return {
            "q": _w((lambda *s: torch.randn(*s, dtype=torch.bfloat16) * 0.05)(B, S, D)),
            "k": _w((lambda *s: torch.randn(*s, dtype=torch.bfloat16) * 0.2)(B, S, D)),
            "v": _w((lambda *s: torch.randn(*s, dtype=torch.bfloat16) * 0.2)(B, S, D)),
            "shift_k": _w((lambda *s: torch.randn(*s, dtype=torch.bfloat16) * 0.2)(D, ks) * 0.5),
            "ssm_k": _w((lambda *s: torch.randn(*s, dtype=torch.bfloat16) * 0.4)(D, S) * (1.0 / S ** 0.5)),
            "ssm_D": _w((lambda *s: torch.randn(*s, dtype=torch.bfloat16) * 0.2)(D)),
        }
    _A_in = _A_setup()

    def _B_setup():
        B, S, D, F = 1, 2048, 512, 1376
        return {
            "x": _w((lambda *s: torch.randn(*s, dtype=torch.bfloat16) * 0.05)(B, S, D)),
            "w1": _w((lambda *s: torch.randn(*s, dtype=torch.bfloat16) * 0.2)(D, F) * (2.0 / D) ** 0.5),
            "w3": _w((lambda *s: torch.randn(*s, dtype=torch.bfloat16) * 0.2)(D, F) * (2.0 / D) ** 0.5),
            "w2": _w((lambda *s: torch.randn(*s, dtype=torch.bfloat16) * 0.2)(F, D) * (2.0 / F) ** 0.5),
        }
    _B_in = _B_setup()

    return {
        "A_q": _A_in["q"],
        "A_k": _A_in["k"],
        "A_v": _A_in["v"],
        "A_shift_k": _A_in["shift_k"],
        "A_ssm_k": _A_in["ssm_k"],
        "A_ssm_D": _A_in["ssm_D"],
        "B_x": _B_in["x"],
        "B_w1": _B_in["w1"],
        "B_w3": _B_in["w3"],
        "B_w2": _B_in["w2"],
    }

def reference(A_q, A_k, A_v, A_shift_k, A_ssm_k, A_ssm_D, B_x, B_w1, B_w3, B_w2):
    def _A_ref(q, k, v, shift_k, ssm_k, ssm_D):
        B, S, D = q.shape
        ks = shift_k.shape[-1]
        k_pad = _pad(k, ((0, 0), (ks - 1, 0), (0, 0)))
        k_shift = torch.zeros_like(k)
        for t in range(ks):
            k_shift = k_shift + k_pad[:, t:t + S, :] * shift_k[:, ks - 1 - t][None, None, :]
        kv = k_shift * v
        L = 2 * S
        kv_pad = _pad(kv, ((0, 0), (0, S), (0, 0)))
        kf_pad = _pad(ssm_k, ((0, 0), (0, S)))
        kv_f = (lambda x, axes=(-2,-1): torch.fft.rfft2(x.float(), dim=axes))(kv_pad[:, None, :, :], axes=(1, 2))
        kf_f = (lambda x, axes=(-2,-1): torch.fft.rfft2(x.float(), dim=axes))(kf_pad[:, None, :], axes=(1, 2))
        kf_f = (lambda x, *d: x.permute(*d))(kf_f, 1, 2, 0)
        y_f = kv_f * kf_f[None, :, :, :]
        y = (lambda x, s, axes=(-2,-1): torch.fft.irfft2(x, s=s, dim=axes).to(torch.bfloat16))(y_f, (1, L), axes=(1, 2))[:, 0, :S, :]
        y = y + kv * ssm_D[None, None, :]
        return q * y

    def _B_ref(x, w1, w3, w2):
        gate = torch.einsum("bsd,df->bsf", x, w1)
        up = torch.einsum("bsd,df->bsf", x, w3)
        h = _silu(gate) * up
        out = torch.einsum("bsf,fd->bsd", h, w2)
        return out

    x = A_q
    x = x + _A_ref(_layernorm(x, axis=-1), A_k, A_v, A_shift_k, A_ssm_k, A_ssm_D)
    x = x + _B_ref(_layernorm(x, axis=-1), B_w1, B_w3, B_w2)
    x = x + _A_ref(_layernorm(x, axis=-1), A_k, A_v, A_shift_k, A_ssm_k, A_ssm_D)
    x = x + _B_ref(_layernorm(x, axis=-1), B_w1, B_w3, B_w2)
    return x
```

```asm
; @launch grid=(256,1,1) block=(256,1,1) lds=149504
.amdgcn_target "amdgcn-amd-amdhsa--gfx950"
.text
.globl interleave_layers__ssm_conv_h3__glu_gated_swiglu__prompt_kernel
.p2align 8
.type interleave_layers__ssm_conv_h3__glu_gated_swiglu__prompt_kernel,@function
interleave_layers__ssm_conv_h3__glu_gated_swiglu__prompt_kernel:
    s_cmp_ge_u32 s2, 256
    s_cbranch_scc1 L_end
    s_load_dwordx4 s[4:7], s[0:1], 0
    s_load_dwordx4 s[8:11], s[0:1], 16
    s_load_dwordx4 s[12:15], s[0:1], 32
    s_load_dwordx2 s[16:17], s[0:1], 96
    s_load_dwordx4 s[52:55], s[0:1], 56
    s_load_dwordx2 s[56:57], s[0:1], 72
    v_and_b32 v1, 7, v0
    v_lshrrev_b32 v2, 3, v0
    s_lshr_b32 s36, s2, 3
    s_and_b32 s36, s36, 7
    s_lshl_b32 s36, s36, 7
    s_lshr_b32 s37, s2, 6
    s_lshl_b32 s37, s37, 3
    s_and_b32 s38, s2, 7
    s_add_u32 s37, s37, s38
    s_lshl_b32 s37, s37, 16
    s_add_u32 s36, s36, s37
    v_lshlrev_b32 v4, 4, v1
    v_lshlrev_b32 v5, 11, v2
    v_add3_u32 v4, v4, v5, s36
    v_subrev_u32 v5, 3072, v4
    v_subrev_u32 v6, 2048, v4
    v_subrev_u32 v7, 1024, v4
    s_mov_b32 s26, 2097152
    s_mov_b32 s27, 0x20000
    s_mov_b32 s34, 2097152
    s_mov_b32 s35, 0x20000
    s_waitcnt lgkmcnt(0)
    s_mov_b32 s24, s6
    s_mov_b32 s25, s7
    s_mov_b32 s32, s8
    s_mov_b32 s33, s9
    buffer_load_dwordx4 v[16:19], v5, s[24:27], 0 offen
    buffer_load_dwordx4 v[20:23], v6, s[24:27], 0 offen
    buffer_load_dwordx4 v[24:27], v7, s[24:27], 0 offen
    buffer_load_dwordx4 v[28:31], v4, s[24:27], 0 offen
    buffer_load_dwordx4 v[32:35], v4, s[24:27], 0 offen offset:1024
    buffer_load_dwordx4 v[36:39], v4, s[32:35], 0 offen
    buffer_load_dwordx4 v[40:43], v4, s[32:35], 0 offen offset:1024
    s_getpc_b64 s[68:69]
L_pc:
    s_sub_u32 s68, s68, L_pc-interleave_layers__ssm_conv_h3__glu_gated_swiglu__prompt_kernel
    s_subb_u32 s69, s69, 0
    v_and_b32 v190, 15, v0
    s_lshr_b32 s36, s2, 3
    s_lshl_b32 s36, s36, 4
    v_add_u32 v190, s36, v190
    v_lshlrev_b32 v190, 7, v190
    v_min_u32 v190, L_codeend-interleave_layers__ssm_conv_h3__glu_gated_swiglu__prompt_kernel-4, v190
    global_load_dword v188, v190, s[68:69]
    v_lshrrev_b32 v3, 6, v0
    s_nop 0
    v_readfirstlane_b32 s18, v3
    s_and_b32 s60, s2, 7
    s_lshr_b32 s61, s2, 3
    s_lshl_b32 s64, s60, 5
    s_add_u32 s64, s64, s61
    s_mov_b32 s19, s64
    s_lshl_b32 s64, s64, 6
    s_add_u32 s64, s64, 9961472
    s_mov_b32 s20, s4
    s_mov_b32 s21, s5
    s_mov_b32 s22, 2097152
    s_mov_b32 s23, 0x20000
    s_mov_b32 s40, s10
    s_mov_b32 s41, s11
    s_mov_b32 s42, 4096
    s_mov_b32 s43, 0x20000
    s_mov_b32 s28, s16
    s_mov_b32 s29, s17
    s_mov_b32 s30, 30408704
    s_mov_b32 s31, 0x20000
    s_add_u32 s36, s16, 9977856
    s_addc_u32 s37, s17, 0
    s_load_dword s3, s[36:37], 0
    v_and_b32 v9, 63, v0
    s_lshr_b32 s66, s18, 1
    s_and_b32 s67, s18, 1
    s_lshr_b32 s36, s2, 3
    s_and_b32 s36, s36, 7
    s_lshl_b32 s36, s36, 9
    v_lshlrev_b32 v8, 6, v1
    v_add_u32 v8, s36, v8
    buffer_load_dwordx4 v[44:47], v8, s[40:43], 0 offen
    buffer_load_dwordx4 v[48:51], v8, s[40:43], 0 offen offset:16
    buffer_load_dwordx4 v[52:55], v8, s[40:43], 0 offen offset:32
    buffer_load_dwordx4 v[56:59], v8, s[40:43], 0 offen offset:48
    s_lshl_b32 s65, s19, 1
    s_add_u32 s65, s65, s66
    s_lshl_b32 s37, s65, 1
    s_lshl_b32 s65, s65, 12
    s_mov_b32 s44, s12
    s_mov_b32 s45, s13
    s_add_u32 s44, s44, s65
    s_addc_u32 s45, s45, 0
    s_mov_b32 s46, 4096
    s_mov_b32 s47, 0x20000
    s_mov_b32 s48, s14
    s_mov_b32 s49, s15
    s_mov_b32 s50, 1024
    s_mov_b32 s51, 0x20000
    v_lshlrev_b32 v172, 4, v9
    s_lshl_b32 s36, s67, 11
    v_add_u32 v172, s36, v172
    buffer_load_dwordx4 v[192:195], v172, s[44:47], 0 offen
    buffer_load_dwordx4 v[196:199], v172, s[44:47], 0 offen offset:4
    buffer_load_dwordx4 v[200:203], v172, s[44:47], 0 offen offset:8
    buffer_load_dwordx4 v[204:207], v172, s[44:47], 0 offen offset:1024
    buffer_load_dwordx4 v[208:211], v172, s[44:47], 0 offen offset:1028
    buffer_load_dwordx4 v[212:215], v172, s[44:47], 0 offen offset:1032
    v_bfe_u32 v219, v9, 3, 2
    v_and_b32 v220, 7, v9
    v_lshlrev_b32 v13, 1, v220
    v_add_u32 v13, v13, v219
    v_subrev_u32 v13, 16, v13
    v_lshlrev_b32 v13, 1, v13
    v_add_u32 v14, 2, v13
    buffer_load_ushort v216, v13, s[44:47], 0 offen
    buffer_load_ushort v217, v14, s[44:47], 0 offen
    v_mov_b32 v173, s37
    buffer_load_ushort v218, v173, s[48:51], 0 offen
    buffer_load_dwordx4 v[60:63], v4, s[20:23], 0 offen
    buffer_load_dwordx4 v[64:67], v4, s[20:23], 0 offen offset:1024
    v_lshlrev_b32 v10, 4, v9
    s_lshl_b32 s36, s2, 13
    s_lshl_b32 s37, s18, 11
    s_add_u32 s36, s36, s37
    v_add_u32 v10, s36, v10
    buffer_load_dwordx4 v[68:71], v10, s[20:23], 0 offen
    buffer_load_dwordx4 v[72:75], v10, s[20:23], 0 offen offset:1024
    s_cmp_eq_u32 s66, 0
    s_cselect_b32 s52, s52, s54
    s_cselect_b32 s53, s53, s55
    s_mov_b32 s54, 1409024
    s_mov_b32 s55, 0x20000
    s_mov_b32 s58, 1409024
    s_mov_b32 s59, 0x20000
    s_mul_i32 s62, s60, 176128
    s_mul_i32 s63, s61, 96
    s_add_u32 s62, s62, s63
    s_mul_i32 s63, s67, 192
    v_add_u32 v176, s63, v9
    s_mul_i32 s36, s66, 6176
    s_lshl_b32 s63, s63, 4
    s_add_u32 s36, s36, s63
    s_add_u32 s36, s36, 81920
    v_add_u32 v177, 0, v176
    v_mul_u32_u24 v178, 43691, v177
    v_lshrrev_b32 v178, 18, v178
    v_mul_u32_u24 v179, 6, v178
    v_sub_u32 v179, v177, v179
    v_mul_u32_u24 v178, 2752, v178
    v_lshl_add_u32 v184, v179, 4, v178
    s_add_u32 m0, s36, 0
    s_nop 0
    buffer_load_dwordx4 v184, s[52:55], s62 offen lds
    v_add_u32 v177, 64, v176
    v_mul_u32_u24 v178, 43691, v177
    v_lshrrev_b32 v178, 18, v178
    v_mul_u32_u24 v179, 6, v178
    v_sub_u32 v179, v177, v179
    v_mul_u32_u24 v178, 2752, v178
    v_lshl_add_u32 v185, v179, 4, v178
    s_add_u32 m0, s36, 1024
    s_nop 0
    buffer_load_dwordx4 v185, s[52:55], s62 offen lds
    v_add_u32 v177, 128, v176
    v_mul_u32_u24 v178, 43691, v177
    v_lshrrev_b32 v178, 18, v178
    v_mul_u32_u24 v179, 6, v178
    v_sub_u32 v179, v177, v179
    v_mul_u32_u24 v178, 2752, v178
    v_lshl_add_u32 v186, v179, 4, v178
    s_add_u32 m0, s36, 2048
    s_nop 0
    buffer_load_dwordx4 v186, s[52:55], s62 offen lds
    v_lshrrev_b32 v178, 3, v9
    v_and_b32 v179, 7, v9
    v_lshlrev_b32 v178, 10, v178
    v_lshl_add_u32 v187, v179, 4, v178
    s_lshl_b32 s63, s18, 13
    s_lshr_b32 s36, s2, 6
    s_lshl_b32 s36, s36, 3
    s_and_b32 s37, s2, 7
    s_add_u32 s36, s36, s37
    s_lshl_b32 s36, s36, 15
    s_add_u32 s36, s36, s63
    s_lshr_b32 s63, s2, 3
    s_and_b32 s63, s63, 7
    s_lshl_b32 s63, s63, 7
    s_add_u32 s36, s36, s63
    s_lshl_b32 s63, s18, 10
    s_add_u32 s63, s63, 94272
    s_mov_b32 m0, s63
    s_nop 0
    buffer_load_dwordx4 v187, s[56:59], s36 offen lds
    s_add_u32 s36, s36, 1048576
    s_add_u32 m0, s63, 4096
    s_nop 0
    buffer_load_dwordx4 v187, s[56:59], s36 offen lds
    s_waitcnt lgkmcnt(0)
    s_getreg_b32 s36, hwreg(HW_REG_XCC_ID, 0, 4)
    s_add_u32 s16, s3, 13
    s_lshl_b32 s16, s16, 4
    s_or_b32 s16, s16, s36
    s_mov_b32 s17, 0
    s_cmp_lg_u32 s18, 0
    s_cbranch_scc1 L_noid
    v_mov_b32 v174, s16
    v_mov_b32 v175, s64
    s_mov_b64 exec, 1
    buffer_store_dword v174, v175, s[28:31], 0 offen offset:4 sc1
    s_mov_b64 exec, -1
L_noid:
    v_sub_u32 v11, 31, v2
    v_lshlrev_b32 v12, 2, v1
    v_xor_b32 v11, v11, v12
    v_lshlrev_b32 v11, 2, v11
    v_lshlrev_b32 v13, 10, v1
    v_add_u32 v11, v11, v13
    v_add_u32 v11, 65536, v11
    v_xor_b32 v12, v2, v12
    v_lshlrev_b32 v12, 2, v12
    v_add_u32 v12, v12, v13
    v_add_u32 v12, 73728, v12
    s_waitcnt vmcnt(18)
    v_lshlrev_b32 v80, 16, v44
    v_and_b32 v88, 0xffff0000, v44
    v_lshlrev_b32 v96, 16, v45
    v_and_b32 v104, 0xffff0000, v45
    v_lshlrev_b32 v81, 16, v46
    v_and_b32 v89, 0xffff0000, v46
    v_lshlrev_b32 v97, 16, v47
    v_and_b32 v105, 0xffff0000, v47
    v_lshlrev_b32 v82, 16, v48
    v_and_b32 v90, 0xffff0000, v48
    v_lshlrev_b32 v98, 16, v49
    v_and_b32 v106, 0xffff0000, v49
    v_lshlrev_b32 v83, 16, v50
    v_and_b32 v91, 0xffff0000, v50
    v_lshlrev_b32 v99, 16, v51
    v_and_b32 v107, 0xffff0000, v51
    v_lshlrev_b32 v84, 16, v52
    v_and_b32 v92, 0xffff0000, v52
    v_lshlrev_b32 v100, 16, v53
    v_and_b32 v108, 0xffff0000, v53
    v_lshlrev_b32 v85, 16, v54
    v_and_b32 v93, 0xffff0000, v54
    v_lshlrev_b32 v101, 16, v55
    v_and_b32 v109, 0xffff0000, v55
    v_lshlrev_b32 v86, 16, v56
    v_and_b32 v94, 0xffff0000, v56
    v_lshlrev_b32 v102, 16, v57
    v_and_b32 v110, 0xffff0000, v57
    v_lshlrev_b32 v87, 16, v58
    v_and_b32 v95, 0xffff0000, v58
    v_lshlrev_b32 v103, 16, v59
    v_and_b32 v111, 0xffff0000, v59
    s_waitcnt vmcnt(18)
    v_lshlrev_b32 v112, 16, v16
    v_and_b32 v113, 0xffff0000, v16
    v_lshlrev_b32 v114, 16, v17
    v_and_b32 v115, 0xffff0000, v17
    v_lshlrev_b32 v116, 16, v18
    v_and_b32 v117, 0xffff0000, v18
    v_lshlrev_b32 v118, 16, v19
    v_and_b32 v119, 0xffff0000, v19
    v_lshlrev_b32 v120, 16, v20
    v_and_b32 v121, 0xffff0000, v20
    v_lshlrev_b32 v122, 16, v21
    v_and_b32 v123, 0xffff0000, v21
    v_lshlrev_b32 v124, 16, v22
    v_and_b32 v125, 0xffff0000, v22
    v_lshlrev_b32 v126, 16, v23
    v_and_b32 v127, 0xffff0000, v23
    v_lshlrev_b32 v128, 16, v24
    v_and_b32 v129, 0xffff0000, v24
    v_lshlrev_b32 v130, 16, v25
    v_and_b32 v131, 0xffff0000, v25
    v_lshlrev_b32 v132, 16, v26
    v_and_b32 v133, 0xffff0000, v26
    v_lshlrev_b32 v134, 16, v27
    v_and_b32 v135, 0xffff0000, v27
    v_lshlrev_b32 v136, 16, v28
    v_and_b32 v137, 0xffff0000, v28
    v_lshlrev_b32 v138, 16, v29
    v_and_b32 v139, 0xffff0000, v29
    v_lshlrev_b32 v140, 16, v30
    v_and_b32 v141, 0xffff0000, v30
    v_lshlrev_b32 v142, 16, v31
    v_and_b32 v143, 0xffff0000, v31
    v_lshlrev_b32 v144, 16, v32
    v_and_b32 v145, 0xffff0000, v32
    v_lshlrev_b32 v146, 16, v33
    v_and_b32 v147, 0xffff0000, v33
    v_lshlrev_b32 v148, 16, v34
    v_and_b32 v149, 0xffff0000, v34
    v_lshlrev_b32 v150, 16, v35
    v_and_b32 v151, 0xffff0000, v35
    v_pk_mul_f32 v[152:153], v[112:113], v[104:105]
    v_pk_mul_f32 v[154:155], v[114:115], v[106:107]
    v_pk_mul_f32 v[156:157], v[116:117], v[108:109]
    v_pk_mul_f32 v[158:159], v[118:119], v[110:111]
    v_pk_mul_f32 v[160:161], v[120:121], v[104:105]
    v_pk_mul_f32 v[162:163], v[122:123], v[106:107]
    v_pk_mul_f32 v[164:165], v[124:125], v[108:109]
    v_pk_mul_f32 v[166:167], v[126:127], v[110:111]
    v_pk_fma_f32 v[152:153], v[120:121], v[96:97], v[152:153]
    v_pk_fma_f32 v[154:155], v[122:123], v[98:99], v[154:155]
    v_pk_fma_f32 v[156:157], v[124:125], v[100:101], v[156:157]
    v_pk_fma_f32 v[158:159], v[126:127], v[102:103], v[158:159]
    v_pk_fma_f32 v[160:161], v[128:129], v[96:97], v[160:161]
    v_pk_fma_f32 v[162:163], v[130:131], v[98:99], v[162:163]
    v_pk_fma_f32 v[164:165], v[132:133], v[100:101], v[164:165]
    v_pk_fma_f32 v[166:167], v[134:135], v[102:103], v[166:167]
    v_pk_fma_f32 v[152:153], v[128:129], v[88:89], v[152:153]
    v_pk_fma_f32 v[154:155], v[130:131], v[90:91], v[154:155]
    v_pk_fma_f32 v[156:157], v[132:133], v[92:93], v[156:157]
    v_pk_fma_f32 v[158:159], v[134:135], v[94:95], v[158:159]
    v_pk_fma_f32 v[160:161], v[136:137], v[88:89], v[160:161]
    v_pk_fma_f32 v[162:163], v[138:139], v[90:91], v[162:163]
    v_pk_fma_f32 v[164:165], v[140:141], v[92:93], v[164:165]
    v_pk_fma_f32 v[166:167], v[142:143], v[94:95], v[166:167]
    v_pk_fma_f32 v[152:153], v[136:137], v[80:81], v[152:153]
    v_pk_fma_f32 v[154:155], v[138:139], v[82:83], v[154:155]
    v_pk_fma_f32 v[156:157], v[140:141], v[84:85], v[156:157]
    v_pk_fma_f32 v[158:159], v[142:143], v[86:87], v[158:159]
    v_pk_fma_f32 v[160:161], v[144:145], v[80:81], v[160:161]
    v_pk_fma_f32 v[162:163], v[146:147], v[82:83], v[162:163]
    v_pk_fma_f32 v[164:165], v[148:149], v[84:85], v[164:165]
    v_pk_fma_f32 v[166:167], v[150:151], v[86:87], v[166:167]
    v_lshlrev_b32 v112, 16, v36
    v_and_b32 v113, 0xffff0000, v36
    v_lshlrev_b32 v114, 16, v37
    v_and_b32 v115, 0xffff0000, v37
    v_lshlrev_b32 v116, 16, v38
    v_and_b32 v117, 0xffff0000, v38
    v_lshlrev_b32 v118, 16, v39
    v_and_b32 v119, 0xffff0000, v39
    v_lshlrev_b32 v120, 16, v40
    v_and_b32 v121, 0xffff0000, v40
    v_lshlrev_b32 v122, 16, v41
    v_and_b32 v123, 0xffff0000, v41
    v_lshlrev_b32 v124, 16, v42
    v_and_b32 v125, 0xffff0000, v42
    v_lshlrev_b32 v126, 16, v43
    v_and_b32 v127, 0xffff0000, v43
    v_pk_mul_f32 v[152:153], v[152:153], v[112:113]
    v_pk_mul_f32 v[154:155], v[154:155], v[114:115]
    v_pk_mul_f32 v[156:157], v[156:157], v[116:117]
    v_pk_mul_f32 v[158:159], v[158:159], v[118:119]
    v_pk_mul_f32 v[160:161], v[160:161], v[120:121]
    v_pk_mul_f32 v[162:163], v[162:163], v[122:123]
    v_pk_mul_f32 v[164:165], v[164:165], v[124:125]
    v_pk_mul_f32 v[166:167], v[166:167], v[126:127]
    v_cvt_pk_bf16_f32 v80, v160, v152
    v_cvt_pk_bf16_f32 v81, v161, v153
    v_cvt_pk_bf16_f32 v82, v162, v154
    v_cvt_pk_bf16_f32 v83, v163, v155
    v_cvt_pk_bf16_f32 v84, v164, v156
    v_cvt_pk_bf16_f32 v85, v165, v157
    v_cvt_pk_bf16_f32 v86, v166, v158
    v_cvt_pk_bf16_f32 v87, v167, v159
    ds_write_b32 v11, v80 offset:0
    ds_write_b32 v11, v81 offset:128
    ds_write_b32 v11, v82 offset:256
    ds_write_b32 v11, v83 offset:384
    ds_write_b32 v11, v84 offset:512
    ds_write_b32 v11, v85 offset:640
    ds_write_b32 v11, v86 offset:768
    ds_write_b32 v11, v87 offset:896
    v_lshrrev_b32 v3, 6, v0
    v_xor_b32 v5, v1, v3
    v_lshlrev_b32 v5, 4, v5
    v_lshlrev_b32 v6, 7, v2
    v_add_u32 v5, v5, v6
    v_add_u32 v5, 65536, v5
    v_xor_b32 v7, 64, v5
    s_lshr_b32 s36, s2, 3
    s_and_b32 s36, s36, 7
    s_lshl_b32 s36, s36, 18
    s_lshr_b32 s37, s2, 6
    s_lshl_b32 s37, s37, 3
    s_and_b32 s38, s2, 7
    s_add_u32 s37, s37, s38
    s_lshl_b32 s37, s37, 7
    s_sub_u32 s4, s36, s37
    s_add_u32 s4, s4, 3968
    s_add_u32 s5, s36, s37
    s_add_u32 s5, s5, 2097152
    v_lshlrev_b32 v8, 12, v2
    v_lshlrev_b32 v15, 4, v1
    v_add_u32 v8, v8, v15
    v_add_u32 v15, 0x20000, v8
    s_waitcnt lgkmcnt(0)
    s_barrier
    ds_read_b128 v[16:19], v5
    ds_read_b128 v[20:23], v7 offset:4096
    s_waitcnt lgkmcnt(1)
    buffer_store_dwordx4 v[16:19], v8, s[28:31], s4 offen sc1
    s_waitcnt lgkmcnt(0)
    buffer_store_dwordx4 v[20:23], v15, s[28:31], s4 offen sc1
    s_waitcnt vmcnt(0)
    s_barrier
    s_cmp_lg_u32 s18, 0
    s_cbranch_scc1 sg1_1
    s_add_u32 s36, s3, 1
    v_mov_b32 v16, s36
    v_mov_b32 v17, s64
    s_mov_b64 exec, 1
    buffer_store_dword v16, v17, s[28:31], 0 offen sc1
    s_mov_b64 exec, -1
sg1_1:
    s_waitcnt vmcnt(13)
    s_barrier
    v_lshrrev_b32 v178, 4, v9
    v_bfe_u32 v179, v9, 2, 2
    v_and_b32 v180, 3, v9
    v_lshl_add_u32 v181, v178, 4, v179
    v_mul_u32_u24 v181, 96, v181
    v_and_b32 v182, 1, v180
    v_lshl_add_u32 v181, v182, 3, v181
    v_lshrrev_b32 v182, 1, v180
    v_mul_u32_u24 v182, 6176, v182
    v_add_u32 v181, v181, v182
    v_lshlrev_b32 v183, 4, v9
    s_mul_i32 s36, s18, 3
    s_add_u32 s36, s36, 0
    s_lshr_b32 s37, s36, 1
    s_and_b32 s36, s36, 1
    s_lshl_b32 s38, s37, 4
    s_mul_i32 s39, s36, 768
    s_add_u32 s38, s38, s39
    s_add_u32 s38, s38, 81920
    v_add_u32 v182, s38, v181
    ds_read_b64_tr_b16 v[144:145], v182
    ds_read_b64_tr_b16 v[146:147], v182 offset:384
    s_mul_i32 s38, s61, 6
    s_add_u32 s38, s38, s37
    s_lshl_b32 s39, s38, 14
    s_lshl_b32 s37, s60, 11
    s_add_u32 s39, s39, s37
    s_lshl_b32 s36, s36, 10
    s_add_u32 s39, s39, s36
    s_add_u32 s39, s39, 25165824
    s_cmp_lt_u32 s38, 172
    s_cselect_b32 s6, s39, 0x80000000
    s_mul_i32 s36, s18, 3
    s_add_u32 s36, s36, 1
    s_lshr_b32 s37, s36, 1
    s_and_b32 s36, s36, 1
    s_lshl_b32 s38, s37, 4
    s_mul_i32 s39, s36, 768
    s_add_u32 s38, s38, s39
    s_add_u32 s38, s38, 81920
    v_add_u32 v182, s38, v181
    ds_read_b64_tr_b16 v[148:149], v182
    ds_read_b64_tr_b16 v[150:151], v182 offset:384
    s_mul_i32 s38, s61, 6
    s_add_u32 s38, s38, s37
    s_lshl_b32 s39, s38, 14
    s_lshl_b32 s37, s60, 11
    s_add_u32 s39, s39, s37
    s_lshl_b32 s36, s36, 10
    s_add_u32 s39, s39, s36
    s_add_u32 s39, s39, 25165824
    s_cmp_lt_u32 s38, 172
    s_cselect_b32 s7, s39, 0x80000000
    s_mul_i32 s36, s18, 3
    s_add_u32 s36, s36, 2
    s_lshr_b32 s37, s36, 1
    s_and_b32 s36, s36, 1
    s_lshl_b32 s38, s37, 4
    s_mul_i32 s39, s36, 768
    s_add_u32 s38, s38, s39
    s_add_u32 s38, s38, 81920
    v_add_u32 v182, s38, v181
    ds_read_b64_tr_b16 v[152:153], v182
    ds_read_b64_tr_b16 v[154:155], v182 offset:384
    s_mul_i32 s38, s61, 6
    s_add_u32 s38, s38, s37
    s_lshl_b32 s39, s38, 14
    s_lshl_b32 s37, s60, 11
    s_add_u32 s39, s39, s37
    s_lshl_b32 s36, s36, 10
    s_add_u32 s39, s39, s36
    s_add_u32 s39, s39, 25165824
    s_cmp_lt_u32 s38, 172
    s_cselect_b32 s8, s39, 0x80000000
    v_lshl_add_u32 v181, v178, 2, v179
    v_lshlrev_b32 v181, 7, v181
    v_lshl_add_u32 v181, v180, 5, v181
    s_lshl_b32 s36, s18, 3
    s_add_u32 s36, s36, 94272
    v_add_u32 v181, s36, v181
    ds_read_b64_tr_b16 v[156:157], v181 offset:0
    ds_read_b64_tr_b16 v[158:159], v181 offset:2048
    s_lshr_b32 s36, s2, 6
    s_lshl_b32 s36, s36, 3
    s_and_b32 s37, s2, 7
    s_add_u32 s36, s36, s37
    s_add_u32 s36, s36, 0
    s_lshr_b32 s37, s2, 3
    s_and_b32 s37, s37, 7
    s_mul_i32 s37, s37, 43
    s_add_u32 s37, s37, s36
    s_lshl_b32 s37, s37, 12
    s_lshl_b32 s38, s18, 10
    s_add_u32 s37, s37, s38
    s_add_u32 s37, s37, 28311552
    s_cmp_lt_u32 s36, 43
    s_cselect_b32 s9, s37, 0x80000000
    ds_read_b64_tr_b16 v[160:161], v181 offset:4096
    ds_read_b64_tr_b16 v[162:163], v181 offset:6144
    s_lshr_b32 s36, s2, 6
    s_lshl_b32 s36, s36, 3
    s_and_b32 s37, s2, 7
    s_add_u32 s36, s36, s37
    s_add_u32 s36, s36, 32
    s_lshr_b32 s37, s2, 3
    s_and_b32 s37, s37, 7
    s_mul_i32 s37, s37, 43
    s_add_u32 s37, s37, s36
    s_lshl_b32 s37, s37, 12
    s_lshl_b32 s38, s18, 10
    s_add_u32 s37, s37, s38
    s_add_u32 s37, s37, 28311552
    s_cmp_lt_u32 s36, 43
    s_cselect_b32 s10, s37, 0x80000000
    s_waitcnt lgkmcnt(8)
    buffer_store_dwordx4 v[144:147], v183, s[28:31], s6 offen sc1
    s_waitcnt lgkmcnt(6)
    buffer_store_dwordx4 v[148:151], v183, s[28:31], s7 offen sc1
    s_waitcnt lgkmcnt(4)
    buffer_store_dwordx4 v[152:155], v183, s[28:31], s8 offen sc1
    s_waitcnt lgkmcnt(2)
    buffer_store_dwordx4 v[156:159], v183, s[28:31], s9 offen sc1
    s_waitcnt lgkmcnt(0)
    buffer_store_dwordx4 v[160:163], v183, s[28:31], s10 offen sc1
    s_waitcnt vmcnt(16)
    s_mov_b32 s36, 0x05040100
    s_mov_b32 s37, 0x07060302
    v_perm_b32 v88, v64, v60, s36
    v_perm_b32 v89, v64, v60, s37
    v_perm_b32 v90, v65, v61, s36
    v_perm_b32 v91, v65, v61, s37
    v_perm_b32 v92, v66, v62, s36
    v_perm_b32 v93, v66, v62, s37
    v_perm_b32 v94, v67, v63, s36
    v_perm_b32 v95, v67, v63, s37
    ds_write_b32 v12, v88 offset:0
    ds_write_b32 v12, v89 offset:128
    ds_write_b32 v12, v90 offset:256
    ds_write_b32 v12, v91 offset:384
    ds_write_b32 v12, v92 offset:512
    ds_write_b32 v12, v93 offset:640
    ds_write_b32 v12, v94 offset:768
    ds_write_b32 v12, v95 offset:896
    s_waitcnt vmcnt(14)
    v_mov_b32 v14, 0x3f803f80
    v_mov_b32 v96, 0
    v_mov_b32 v97, 0
    v_mov_b32 v98, 0
    v_mov_b32 v99, 0
    v_dot2_f32_bf16 v96, v68, v14, v96
    v_dot2_f32_bf16 v97, v68, v68, v97
    v_dot2_f32_bf16 v98, v72, v14, v98
    v_dot2_f32_bf16 v99, v72, v72, v99
    v_dot2_f32_bf16 v96, v69, v14, v96
    v_dot2_f32_bf16 v97, v69, v69, v97
    v_dot2_f32_bf16 v98, v73, v14, v98
    v_dot2_f32_bf16 v99, v73, v73, v99
    v_dot2_f32_bf16 v96, v70, v14, v96
    v_dot2_f32_bf16 v97, v70, v70, v97
    v_dot2_f32_bf16 v98, v74, v14, v98
    v_dot2_f32_bf16 v99, v74, v74, v99
    v_dot2_f32_bf16 v96, v71, v14, v96
    v_dot2_f32_bf16 v97, v71, v71, v97
    v_dot2_f32_bf16 v98, v75, v14, v98
    v_dot2_f32_bf16 v99, v75, v75, v99
    v_add_f32_dpp v96, v96, v96 row_ror:8 row_mask:0xf bank_mask:0xf
    v_add_f32_dpp v97, v97, v97 row_ror:8 row_mask:0xf bank_mask:0xf
    v_add_f32_dpp v98, v98, v98 row_ror:8 row_mask:0xf bank_mask:0xf
    v_add_f32_dpp v99, v99, v99 row_ror:8 row_mask:0xf bank_mask:0xf
    v_add_f32_dpp v96, v96, v96 row_ror:4 row_mask:0xf bank_mask:0xf
    v_add_f32_dpp v97, v97, v97 row_ror:4 row_mask:0xf bank_mask:0xf
    v_add_f32_dpp v98, v98, v98 row_ror:4 row_mask:0xf bank_mask:0xf
    v_add_f32_dpp v99, v99, v99 row_ror:4 row_mask:0xf bank_mask:0xf
    v_add_f32_dpp v96, v96, v96 row_ror:2 row_mask:0xf bank_mask:0xf
    v_add_f32_dpp v97, v97, v97 row_ror:2 row_mask:0xf bank_mask:0xf
    v_add_f32_dpp v98, v98, v98 row_ror:2 row_mask:0xf bank_mask:0xf
    v_add_f32_dpp v99, v99, v99 row_ror:2 row_mask:0xf bank_mask:0xf
    v_add_f32_dpp v96, v96, v96 row_ror:1 row_mask:0xf bank_mask:0xf
    v_add_f32_dpp v97, v97, v97 row_ror:1 row_mask:0xf bank_mask:0xf
    v_add_f32_dpp v98, v98, v98 row_ror:1 row_mask:0xf bank_mask:0xf
    v_add_f32_dpp v99, v99, v99 row_ror:1 row_mask:0xf bank_mask:0xf
    v_mov_b32 v100, v96
    v_mov_b32 v101, v97
    v_mov_b32 v102, v98
    v_mov_b32 v103, v99
    v_permlane16_swap_b32 v96, v100
    v_permlane16_swap_b32 v97, v101
    v_permlane16_swap_b32 v98, v102
    v_permlane16_swap_b32 v99, v103
    v_add_f32 v96, v96, v100
    v_add_f32 v97, v97, v101
    v_add_f32 v98, v98, v102
    v_add_f32 v99, v99, v103
    v_mov_b32 v100, v96
    v_mov_b32 v101, v97
    v_mov_b32 v102, v98
    v_mov_b32 v103, v99
    v_permlane32_swap_b32 v96, v100
    v_permlane32_swap_b32 v97, v101
    v_permlane32_swap_b32 v98, v102
    v_permlane32_swap_b32 v99, v103
    v_add_f32 v96, v96, v100
    v_add_f32 v97, v97, v101
    v_add_f32 v98, v98, v102
    v_add_f32 v99, v99, v103
    v_mul_f32 v96, 0x3b000000, v96
    v_mul_f32 v97, 0x3b000000, v97
    v_fma_f32 v97, -v96, v96, v97
    v_max_f32 v97, 0, v97
    v_cvt_pk_bf16_f32 v97, v97, v97
    v_and_b32 v97, 0xffff0000, v97
    v_add_f32 v97, 0x3727c5ac, v97
    v_cvt_pk_bf16_f32 v97, v97, v97
    v_and_b32 v97, 0xffff0000, v97
    v_sqrt_f32 v97, v97
    s_nop 0
    v_cvt_pk_bf16_f32 v97, v97, v97
    v_and_b32 v97, 0xffff0000, v97
    v_cvt_pk_bf16_f32 v96, v96, v96
    v_and_b32 v96, 0xffff0000, v96
    v_mul_f32 v98, 0x3b000000, v98
    v_mul_f32 v99, 0x3b000000, v99
    v_fma_f32 v99, -v98, v98, v99
    v_max_f32 v99, 0, v99
    v_cvt_pk_bf16_f32 v99, v99, v99
    v_and_b32 v99, 0xffff0000, v99
    v_add_f32 v99, 0x3727c5ac, v99
    v_cvt_pk_bf16_f32 v99, v99, v99
    v_and_b32 v99, 0xffff0000, v99
    v_sqrt_f32 v99, v99
    s_nop 0
    v_cvt_pk_bf16_f32 v99, v99, v99
    v_and_b32 v99, 0xffff0000, v99
    v_cvt_pk_bf16_f32 v98, v98, v98
    v_and_b32 v98, 0xffff0000, v98
    v_rcp_f32 v102, v97
    v_rcp_f32 v103, v99
    v_mul_f32 v104, -v96, v102
    v_mul_f32 v105, -v98, v103
    s_lshl_b32 s36, s2, 5
    s_lshl_b32 s37, s18, 3
    s_add_u32 s11, s36, s37
    s_add_u32 s11, s11, 4194304
    v_mov_b32 v101, s11
    s_mov_b32 s37, 8192
    s_mov_b64 exec, 1
    buffer_store_dwordx2 v[102:103], v101, s[28:31], 0 offen sc1
    buffer_store_dwordx2 v[104:105], v101, s[28:31], s37 offen sc1
    s_mov_b64 exec, -1
    s_waitcnt lgkmcnt(0)
    s_barrier
    ds_read_b128 v[72:75], v5 offset:8192
    ds_read_b128 v[76:79], v7 offset:12288
    s_waitcnt lgkmcnt(1)
    buffer_store_dwordx4 v[72:75], v8, s[28:31], s5 offen sc1
    s_waitcnt lgkmcnt(0)
    buffer_store_dwordx4 v[76:79], v15, s[28:31], s5 offen sc1
    s_waitcnt vmcnt(9)
    s_mul_i32 s62, s66, 21248
    v_lshlrev_b32 v4, 4, v9
    s_lshl_b32 s36, s67, 11
    s_add_u32 s36, s36, s62
    s_add_u32 s36, s36, 32
    v_add_u32 v4, s36, v4
    v_alignbit_b32 v112, v196, v192, 16
    v_alignbit_b32 v116, v200, v196, 16
    v_alignbit_b32 v113, v197, v193, 16
    v_alignbit_b32 v117, v201, v197, 16
    v_alignbit_b32 v114, v198, v194, 16
    v_alignbit_b32 v118, v202, v198, 16
    v_alignbit_b32 v115, v199, v195, 16
    v_alignbit_b32 v119, v203, v199, 16
    ds_write_b128 v4, v[192:195] offset:0
    ds_write_b128 v4, v[112:115] offset:4160
    ds_write_b128 v4, v[196:199] offset:8320
    ds_write_b128 v4, v[116:119] offset:12480
    v_alignbit_b32 v120, v208, v204, 16
    v_alignbit_b32 v124, v212, v208, 16
    v_alignbit_b32 v121, v209, v205, 16
    v_alignbit_b32 v125, v213, v209, 16
    v_alignbit_b32 v122, v210, v206, 16
    v_alignbit_b32 v126, v214, v210, 16
    v_alignbit_b32 v123, v211, v207, 16
    v_alignbit_b32 v127, v215, v211, 16
    ds_write_b128 v4, v[204:207] offset:1024
    ds_write_b128 v4, v[120:123] offset:5184
    ds_write_b128 v4, v[208:211] offset:9344
    ds_write_b128 v4, v[124:127] offset:13504
    v_lshl_or_b32 v216, v217, 16, v216
    v_mul_u32_u24 v13, 4160, v219
    v_lshl_add_u32 v13, v220, 2, v13
    v_add_u32 v13, s62, v13
    ds_write_b32 v13, v216
    v_lshlrev_b32 v20, 16, v218
    v_mov_b32 v92, 0
    v_mov_b32 v93, 0
    v_mov_b32 v94, 0
    v_mov_b32 v95, 0
    v_and_b32 v16, 31, v9
    v_lshlrev_b32 v16, 4, v16
    v_add_u32 v16, s62, v16
    ds_write_b128 v16, v[92:95] offset:20736
    s_waitcnt lgkmcnt(0)
    s_and_b32 s20, s61, 1
    s_lshl_b32 s36, s60, 1
    s_or_b32 s20, s20, s36
    s_lshr_b32 s21, s61, 1
    s_lshr_b32 s22, s21, 3
    s_and_b32 s23, s21, 7
    s_mul_i32 s36, s18, 3
    s_add_u32 s36, s36, 0
    s_mul_i32 s37, s21, 11
    s_add_u32 s37, s37, s36
    s_cmp_lt_u32 s36, 11
    s_cselect_b32 s38, s37, 0x7fff
    s_cmp_lt_u32 s38, 172
    s_cselect_b32 s39, 1, 0
    s_lshl_b32 s40, s37, 14
    s_add_u32 s40, s40, 25165824
    s_lshr_b32 s44, s37, 1
    s_lshl_b32 s44, s44, 9
    s_and_b32 s37, s37, 1
    s_lshl_b32 s37, s37, 8
    s_add_u32 s44, s44, s37
    s_cmp_eq_u32 s39, 1
    s_cselect_b32 s40, s40, 0x80000000
    s_cselect_b32 s44, s44, 0x80000000
    s_mul_i32 s36, s18, 3
    s_add_u32 s36, s36, 1
    s_mul_i32 s37, s21, 11
    s_add_u32 s37, s37, s36
    s_cmp_lt_u32 s36, 11
    s_cselect_b32 s38, s37, 0x7fff
    s_cmp_lt_u32 s38, 172
    s_cselect_b32 s39, 1, 0
    s_lshl_b32 s41, s37, 14
    s_add_u32 s41, s41, 25165824
    s_lshr_b32 s45, s37, 1
    s_lshl_b32 s45, s45, 9
    s_and_b32 s37, s37, 1
    s_lshl_b32 s37, s37, 8
    s_add_u32 s45, s45, s37
    s_cmp_eq_u32 s39, 1
    s_cselect_b32 s41, s41, 0x80000000
    s_cselect_b32 s45, s45, 0x80000000
    s_mul_i32 s36, s18, 3
    s_add_u32 s36, s36, 2
    s_mul_i32 s37, s21, 11
    s_add_u32 s37, s37, s36
    s_cmp_lt_u32 s36, 11
    s_cselect_b32 s38, s37, 0x7fff
    s_cmp_lt_u32 s38, 172
    s_cselect_b32 s39, 1, 0
    s_lshl_b32 s42, s37, 14
    s_add_u32 s42, s42, 25165824
    s_lshr_b32 s46, s37, 1
    s_lshl_b32 s46, s46, 9
    s_and_b32 s37, s37, 1
    s_lshl_b32 s37, s37, 8
    s_add_u32 s46, s46, s37
    s_cmp_eq_u32 s39, 1
    s_cselect_b32 s42, s42, 0x80000000
    s_cselect_b32 s46, s46, 0x80000000
    s_mul_i32 s36, s23, 43
    s_mul_i32 s37, s18, 11
    s_add_u32 s36, s36, s37
    s_lshl_b32 s48, s36, 12
    s_add_u32 s48, s48, 28311552
    s_cmp_eq_u32 s18, 3
    s_cselect_b32 s49, 0x80000000, s48
    v_and_b32 v31, 63, v0
    v_lshlrev_b32 v31, 4, v31
    v_and_b32 v1, 63, v0
    s_add_u32 s36, s3, 2
    v_mov_b32 v2, s36
    v_mov_b32 v3, s64
    s_waitcnt vmcnt(0)
    s_barrier
    s_cmp_lg_u32 s18, 0
    s_cbranch_scc1 sg_2
    s_mov_b64 exec, 1
    buffer_store_dword v2, v3, s[28:31], 0 offen sc1
    s_mov_b64 exec, -1
sg_2:
    s_cmp_lg_u32 s18, 0
    s_cbranch_scc1 ww_3
    v_and_b32 v2, 7, v1
    v_lshlrev_b32 v2, 5, v2
    v_bfe_u32 v3, v1, 3, 2
    v_lshl_add_u32 v2, v3, 3, v2
    v_add_u32 v2, s60, v2
    v_lshlrev_b32 v2, 6, v2
    v_add_u32 v2, 9961472, v2
    s_add_u32 s37, s3, 1
    s_mov_b32 s38, 0
wf_4:
    buffer_load_dword v64, v2, s[28:31], 0 offen sc1
    s_add_u32 s38, s38, 1
    s_waitcnt vmcnt(0)
    v_subrev_u32 v64, s37, v64
    v_cmp_gt_u32 vcc, 16, v64
    s_cmp_gt_u32 s38, 200000
    s_nop 2
    s_cbranch_scc1 wf_4_x
    s_cmp_eq_u64 vcc, -1
    s_cbranch_scc1 wf_4_x
    s_branch wf_4
wf_4_x:
ww_3:
    s_barrier
    v_lshlrev_b32 v10, 4, v1
    s_lshl_b32 s36, s67, 11
    s_add_u32 s37, s65, s36
    s_add_u32 s37, s37, 0
    s_add_u32 s38, s62, s36
    s_add_u32 s38, s38, 16640
    s_mov_b32 m0, s38
    s_nop 0
    buffer_load_dwordx4 v10, s[28:31], s37 offen sc1 lds
    s_add_u32 s38, s38, 1024
    s_add_u32 s37, s37, 1024
    s_mov_b32 m0, s38
    s_nop 0
    buffer_load_dwordx4 v10, s[28:31], s37 offen sc1 lds
    v_and_b32 v11, 15, v1
    v_lshrrev_b32 v12, 4, v1
    v_lshlrev_b32 v13, 4, v11
    v_lshl_add_u32 v13, v12, 2, v13
    s_lshl_b32 s36, s67, 10
    v_add_u32 v13, s36, v13
    v_lshlrev_b32 v14, 1, v13
    v_lshlrev_b32 v15, 2, v13
    v_lshlrev_b32 v22, 6, v1
    v_add_u32 v22, 9961472, v22
    v_add_u32 v17, 1, v11
    v_and_b32 v18, 3, v17
    v_mul_u32_u24 v18, 4160, v18
    v_lshrrev_b32 v17, 2, v17
    v_lshlrev_b32 v17, 3, v17
    v_lshl_add_u32 v17, v12, 4, v17
    v_add_u32 v17, v17, v18
    s_lshl_b32 s36, s67, 8
    s_add_u32 s37, s36, s62
    v_add_u32 v17, s37, v17
    v_lshlrev_b32 v18, 5, v11
    v_lshlrev_b32 v19, 4, v12
    v_sub_u32 v18, v19, v18
    s_add_u32 s37, s37, 17120
    v_add_u32 v18, s37, v18
    v_mov_b32 v32, 0
    v_mov_b32 v33, 0
    v_mov_b32 v34, 0
    v_mov_b32 v35, 0
    v_mov_b32 v36, 0
    v_mov_b32 v37, 0
    v_mov_b32 v38, 0
    v_mov_b32 v39, 0
    v_mov_b32 v40, 0
    v_mov_b32 v41, 0
    v_mov_b32 v42, 0
    v_mov_b32 v43, 0
    v_mov_b32 v44, 0
    v_mov_b32 v45, 0
    v_mov_b32 v46, 0
    v_mov_b32 v47, 0
    v_mov_b32 v48, 0
    v_mov_b32 v49, 0
    v_mov_b32 v50, 0
    v_mov_b32 v51, 0
    v_mov_b32 v52, 0
    v_mov_b32 v53, 0
    v_mov_b32 v54, 0
    v_mov_b32 v55, 0
    v_mov_b32 v56, 0
    v_mov_b32 v57, 0
    v_mov_b32 v58, 0
    v_mov_b32 v59, 0
    v_mov_b32 v60, 0
    v_mov_b32 v61, 0
    v_mov_b32 v62, 0
    v_mov_b32 v63, 0
    s_waitcnt vmcnt(0)
    s_barrier
    ds_read_b64 v[64:65], v17 offset:0
    ds_read_b64 v[66:67], v17 offset:8
    ds_read_b128 v[96:99], v18 offset:3584
    ds_read_b64 v[68:69], v17 offset:512
    ds_read_b64 v[70:71], v17 offset:520
    ds_read_b128 v[100:103], v18 offset:3072
    ds_read_b64 v[72:73], v17 offset:1024
    ds_read_b64 v[74:75], v17 offset:1032
    ds_read_b128 v[104:107], v18 offset:2560
    ds_read_b64 v[76:77], v17 offset:1536
    ds_read_b64 v[78:79], v17 offset:1544
    ds_read_b128 v[108:111], v18 offset:2048
    ds_read_b64 v[80:81], v17 offset:2048
    ds_read_b64 v[82:83], v17 offset:2056
    ds_read_b128 v[112:115], v18 offset:1536
    ds_read_b64 v[84:85], v17 offset:2560
    ds_read_b64 v[86:87], v17 offset:2568
    ds_read_b128 v[116:119], v18 offset:1024
    ds_read_b64 v[88:89], v17 offset:3072
    ds_read_b64 v[90:91], v17 offset:3080
    ds_read_b128 v[120:123], v18 offset:512
    ds_read_b64 v[92:93], v17 offset:3584
    ds_read_b64 v[94:95], v17 offset:3592
    ds_read_b128 v[124:127], v18 offset:0
    buffer_load_dword v24, v22, s[28:31], 0 offen sc1
    s_movk_i32 s39, 4096
    buffer_load_dword v25, v22, s[28:31], s39 offen sc1
    s_movk_i32 s39, 8192
    buffer_load_dword v26, v22, s[28:31], s39 offen sc1
    s_movk_i32 s39, 12288
    buffer_load_dword v27, v22, s[28:31], s39 offen sc1
    v_and_b32 v23, 15, v1
    v_add_u32 v23, 0, v23
    v_lshlrev_b32 v23, 1, v23
    s_lshr_b32 s36, s20, 1
    s_lshl_b32 s36, s36, 5
    s_and_b32 s37, s20, 1
    s_add_u32 s36, s36, s37
    v_add_u32 v23, s36, v23
    v_lshlrev_b32 v23, 6, v23
    v_add_u32 v23, 9961472, v23
    buffer_load_dword v28, v23, s[28:31], 0 offen offset:4 sc1
    s_waitcnt lgkmcnt(0)
    v_mfma_f32_16x16x32_bf16 v[32:35], v[64:67], v[96:99], v[32:35]
    ds_read_b64 v[128:129], v17 offset:64
    v_mfma_f32_16x16x32_bf16 v[36:39], v[64:67], v[100:103], v[36:39]
    ds_read_b64 v[130:131], v17 offset:72
    v_mfma_f32_16x16x32_bf16 v[40:43], v[64:67], v[104:107], v[40:43]
    ds_read_b128 v[160:163], v18 offset:3648
    v_mfma_f32_16x16x32_bf16 v[44:47], v[64:67], v[108:111], v[44:47]
    ds_read_b64 v[132:133], v17 offset:576
    v_mfma_f32_16x16x32_bf16 v[48:51], v[64:67], v[112:115], v[48:51]
    ds_read_b64 v[134:135], v17 offset:584
    v_mfma_f32_16x16x32_bf16 v[52:55], v[64:67], v[116:119], v[52:55]
    ds_read_b128 v[164:167], v18 offset:3136
    v_mfma_f32_16x16x32_bf16 v[56:59], v[64:67], v[120:123], v[56:59]
    ds_read_b64 v[136:137], v17 offset:1088
    v_mfma_f32_16x16x32_bf16 v[60:63], v[64:67], v[124:127], v[60:63]
    ds_read_b64 v[138:139], v17 offset:1096
    v_mfma_f32_16x16x32_bf16 v[36:39], v[68:71], v[96:99], v[36:39]
    ds_read_b128 v[168:171], v18 offset:2624
    v_mfma_f32_16x16x32_bf16 v[40:43], v[68:71], v[100:103], v[40:43]
    ds_read_b64 v[140:141], v17 offset:1600
    v_mfma_f32_16x16x32_bf16 v[44:47], v[68:71], v[104:107], v[44:47]
    ds_read_b64 v[142:143], v17 offset:1608
    v_mfma_f32_16x16x32_bf16 v[48:51], v[68:71], v[108:111], v[48:51]
    ds_read_b128 v[172:175], v18 offset:2112
    v_mfma_f32_16x16x32_bf16 v[52:55], v[68:71], v[112:115], v[52:55]
    ds_read_b64 v[144:145], v17 offset:2112
    v_mfma_f32_16x16x32_bf16 v[56:59], v[68:71], v[116:119], v[56:59]
    ds_read_b64 v[146:147], v17 offset:2120
    v_mfma_f32_16x16x32_bf16 v[60:63], v[68:71], v[120:123], v[60:63]
    ds_read_b128 v[176:179], v18 offset:1600
    v_mfma_f32_16x16x32_bf16 v[40:43], v[72:75], v[96:99], v[40:43]
    ds_read_b64 v[148:149], v17 offset:2624
    v_mfma_f32_16x16x32_bf16 v[44:47], v[72:75], v[100:103], v[44:47]
    ds_read_b64 v[150:151], v17 offset:2632
    v_mfma_f32_16x16x32_bf16 v[48:51], v[72:75], v[104:107], v[48:51]
    ds_read_b128 v[180:183], v18 offset:1088
    v_mfma_f32_16x16x32_bf16 v[52:55], v[72:75], v[108:111], v[52:55]
    ds_read_b64 v[152:153], v17 offset:3136
    v_mfma_f32_16x16x32_bf16 v[56:59], v[72:75], v[112:115], v[56:59]
    ds_read_b64 v[154:155], v17 offset:3144
    v_mfma_f32_16x16x32_bf16 v[60:63], v[72:75], v[116:119], v[60:63]
    ds_read_b128 v[184:187], v18 offset:576
    v_mfma_f32_16x16x32_bf16 v[44:47], v[76:79], v[96:99], v[44:47]
    ds_read_b64 v[156:157], v17 offset:3648
    v_mfma_f32_16x16x32_bf16 v[48:51], v[76:79], v[100:103], v[48:51]
    ds_read_b64 v[158:159], v17 offset:3656
    v_mfma_f32_16x16x32_bf16 v[52:55], v[76:79], v[104:107], v[52:55]
    ds_read_b128 v[188:191], v18 offset:64
    v_mfma_f32_16x16x32_bf16 v[56:59], v[76:79], v[108:111], v[56:59]
    v_mfma_f32_16x16x32_bf16 v[60:63], v[76:79], v[112:115], v[60:63]
    v_mfma_f32_16x16x32_bf16 v[48:51], v[80:83], v[96:99], v[48:51]
    v_mfma_f32_16x16x32_bf16 v[52:55], v[80:83], v[100:103], v[52:55]
    v_mfma_f32_16x16x32_bf16 v[56:59], v[80:83], v[104:107], v[56:59]
    v_mfma_f32_16x16x32_bf16 v[60:63], v[80:83], v[108:111], v[60:63]
    v_mfma_f32_16x16x32_bf16 v[52:55], v[84:87], v[96:99], v[52:55]
    v_mfma_f32_16x16x32_bf16 v[56:59], v[84:87], v[100:103], v[56:59]
    v_mfma_f32_16x16x32_bf16 v[60:63], v[84:87], v[104:107], v[60:63]
    v_mfma_f32_16x16x32_bf16 v[56:59], v[88:91], v[96:99], v[56:59]
    v_mfma_f32_16x16x32_bf16 v[60:63], v[88:91], v[100:103], v[60:63]
    v_mfma_f32_16x16x32_bf16 v[60:63], v[92:95], v[96:99], v[60:63]
    s_waitcnt lgkmcnt(0)
    v_mfma_f32_16x16x32_bf16 v[32:35], v[128:131], v[160:163], v[32:35]
    ds_read_b64 v[64:65], v17 offset:128
    v_mfma_f32_16x16x32_bf16 v[36:39], v[128:131], v[164:167], v[36:39]
    ds_read_b64 v[66:67], v17 offset:136
    v_mfma_f32_16x16x32_bf16 v[40:43], v[128:131], v[168:171], v[40:43]
    ds_read_b128 v[96:99], v18 offset:3712
    v_mfma_f32_16x16x32_bf16 v[44:47], v[128:131], v[172:175], v[44:47]
    ds_read_b64 v[68:69], v17 offset:640
    v_mfma_f32_16x16x32_bf16 v[48:51], v[128:131], v[176:179], v[48:51]
    ds_read_b64 v[70:71], v17 offset:648
    v_mfma_f32_16x16x32_bf16 v[52:55], v[128:131], v[180:183], v[52:55]
    ds_read_b128 v[100:103], v18 offset:3200
    v_mfma_f32_16x16x32_bf16 v[56:59], v[128:131], v[184:187], v[56:59]
    ds_read_b64 v[72:73], v17 offset:1152
    v_mfma_f32_16x16x32_bf16 v[60:63], v[128:131], v[188:191], v[60:63]
    ds_read_b64 v[74:75], v17 offset:1160
    v_mfma_f32_16x16x32_bf16 v[36:39], v[132:135], v[160:163], v[36:39]
    ds_read_b128 v[104:107], v18 offset:2688
    v_mfma_f32_16x16x32_bf16 v[40:43], v[132:135], v[164:167], v[40:43]
    ds_read_b64 v[76:77], v17 offset:1664
    v_mfma_f32_16x16x32_bf16 v[44:47], v[132:135], v[168:171], v[44:47]
    ds_read_b64 v[78:79], v17 offset:1672
    v_mfma_f32_16x16x32_bf16 v[48:51], v[132:135], v[172:175], v[48:51]
    ds_read_b128 v[108:111], v18 offset:2176
    v_mfma_f32_16x16x32_bf16 v[52:55], v[132:135], v[176:179], v[52:55]
    ds_read_b64 v[80:81], v17 offset:2176
    v_mfma_f32_16x16x32_bf16 v[56:59], v[132:135], v[180:183], v[56:59]
    ds_read_b64 v[82:83], v17 offset:2184
    v_mfma_f32_16x16x32_bf16 v[60:63], v[132:135], v[184:187], v[60:63]
    ds_read_b128 v[112:115], v18 offset:1664
    v_mfma_f32_16x16x32_bf16 v[40:43], v[136:139], v[160:163], v[40:43]
    ds_read_b64 v[84:85], v17 offset:2688
    v_mfma_f32_16x16x32_bf16 v[44:47], v[136:139], v[164:167], v[44:47]
    ds_read_b64 v[86:87], v17 offset:2696
    v_mfma_f32_16x16x32_bf16 v[48:51], v[136:139], v[168:171], v[48:51]
    ds_read_b128 v[116:119], v18 offset:1152
    v_mfma_f32_16x16x32_bf16 v[52:55], v[136:139], v[172:175], v[52:55]
    ds_read_b64 v[88:89], v17 offset:3200
    v_mfma_f32_16x16x32_bf16 v[56:59], v[136:139], v[176:179], v[56:59]
    ds_read_b64 v[90:91], v17 offset:3208
    v_mfma_f32_16x16x32_bf16 v[60:63], v[136:139], v[180:183], v[60:63]
    ds_read_b128 v[120:123], v18 offset:640
    v_mfma_f32_16x16x32_bf16 v[44:47], v[140:143], v[160:163], v[44:47]
    ds_read_b64 v[92:93], v17 offset:3712
    v_mfma_f32_16x16x32_bf16 v[48:51], v[140:143], v[164:167], v[48:51]
    ds_read_b64 v[94:95], v17 offset:3720
    v_mfma_f32_16x16x32_bf16 v[52:55], v[140:143], v[168:171], v[52:55]
    ds_read_b128 v[124:127], v18 offset:128
    v_mfma_f32_16x16x32_bf16 v[56:59], v[140:143], v[172:175], v[56:59]
    v_mfma_f32_16x16x32_bf16 v[60:63], v[140:143], v[176:179], v[60:63]
    v_mfma_f32_16x16x32_bf16 v[48:51], v[144:147], v[160:163], v[48:51]
    v_mfma_f32_16x16x32_bf16 v[52:55], v[144:147], v[164:167], v[52:55]
    v_mfma_f32_16x16x32_bf16 v[56:59], v[144:147], v[168:171], v[56:59]
    v_mfma_f32_16x16x32_bf16 v[60:63], v[144:147], v[172:175], v[60:63]
    v_mfma_f32_16x16x32_bf16 v[52:55], v[148:151], v[160:163], v[52:55]
    v_mfma_f32_16x16x32_bf16 v[56:59], v[148:151], v[164:167], v[56:59]
    v_mfma_f32_16x16x32_bf16 v[60:63], v[148:151], v[168:171], v[60:63]
    v_mfma_f32_16x16x32_bf16 v[56:59], v[152:155], v[160:163], v[56:59]
    v_mfma_f32_16x16x32_bf16 v[60:63], v[152:155], v[164:167], v[60:63]
    v_mfma_f32_16x16x32_bf16 v[60:63], v[156:159], v[160:163], v[60:63]
    s_waitcnt vmcnt(0)
    v_cmp_eq_u32 vcc, s16, v28
    s_nop 1
    s_cmp_eq_u64 vcc, -1
    s_cselect_b32 s17, 1, 0
    s_add_u32 s37, s3, 2
    v_subrev_u32 v29, s37, v24
    v_subrev_u32 v30, s37, v25
    v_max_u32 v29, v29, v30
    v_subrev_u32 v30, s37, v26
    v_max_u32 v29, v29, v30
    v_subrev_u32 v30, s37, v27
    v_max_u32 v29, v29, v30
    v_cmp_gt_u32 vcc, 16, v29
    s_nop 1
    s_cmp_eq_u64 vcc, -1
    s_nop 0
    s_cbranch_scc1 L_c_ok1
    s_mov_b32 s38, 0
L_c_ok1_p:
    buffer_load_dword v24, v22, s[28:31], 0 offen offset:0 sc1
    s_movk_i32 s39, 4096
    buffer_load_dword v25, v22, s[28:31], s39 offen offset:0 sc1
    s_movk_i32 s39, 8192
    buffer_load_dword v26, v22, s[28:31], s39 offen offset:0 sc1
    s_movk_i32 s39, 12288
    buffer_load_dword v27, v22, s[28:31], s39 offen offset:0 sc1
    s_add_u32 s38, s38, 1
    s_waitcnt vmcnt(0)
    v_subrev_u32 v29, s37, v24
    v_subrev_u32 v30, s37, v25
    v_max_u32 v29, v29, v30
    v_subrev_u32 v30, s37, v26
    v_max_u32 v29, v29, v30
    v_subrev_u32 v30, s37, v27
    v_max_u32 v29, v29, v30
    v_cmp_gt_u32 vcc, 16, v29
    s_cmp_gt_u32 s38, 200000
    s_nop 2
    s_cbranch_scc1 L_c_ok1
    s_cmp_eq_u64 vcc, -1
    s_cbranch_scc0 L_c_ok1_p
L_c_ok1:
    s_mov_b32 s8, 4194304
    s_mov_b32 s9, 4202496
    s_add_u32 s10, s65, 2097152
    s_waitcnt lgkmcnt(0)
    v_mfma_f32_16x16x32_bf16 v[32:35], v[64:67], v[96:99], v[32:35]
    ds_read_b64 v[128:129], v17 offset:192
    buffer_load_dwordx2 v[192:193], v14, s[28:31], s10 offen offset:0 sc1
    v_mfma_f32_16x16x32_bf16 v[36:39], v[64:67], v[100:103], v[36:39]
    ds_read_b64 v[130:131], v17 offset:200
    buffer_load_dwordx2 v[194:195], v14, s[28:31], s10 offen offset:512 sc1
    v_mfma_f32_16x16x32_bf16 v[40:43], v[64:67], v[104:107], v[40:43]
    ds_read_b128 v[160:163], v18 offset:3776
    buffer_load_dwordx2 v[196:197], v14, s[28:31], s10 offen offset:1024 sc1
    v_mfma_f32_16x16x32_bf16 v[44:47], v[64:67], v[108:111], v[44:47]
    ds_read_b64 v[132:133], v17 offset:704
    buffer_load_dwordx2 v[198:199], v14, s[28:31], s10 offen offset:1536 sc1
    v_mfma_f32_16x16x32_bf16 v[48:51], v[64:67], v[112:115], v[48:51]
    ds_read_b64 v[134:135], v17 offset:712
    buffer_load_dwordx4 v[200:203], v15, s[28:31], s8 offen offset:0 sc1
    v_mfma_f32_16x16x32_bf16 v[52:55], v[64:67], v[116:119], v[52:55]
    ds_read_b128 v[164:167], v18 offset:3264
    buffer_load_dwordx4 v[216:219], v15, s[28:31], s9 offen offset:0 sc1
    v_mfma_f32_16x16x32_bf16 v[56:59], v[64:67], v[120:123], v[56:59]
    ds_read_b64 v[136:137], v17 offset:1216
    buffer_load_dwordx4 v[204:207], v15, s[28:31], s8 offen offset:1024 sc1
    v_mfma_f32_16x16x32_bf16 v[60:63], v[64:67], v[124:127], v[60:63]
    ds_read_b64 v[138:139], v17 offset:1224
    buffer_load_dwordx4 v[220:223], v15, s[28:31], s9 offen offset:1024 sc1
    v_mfma_f32_16x16x32_bf16 v[36:39], v[68:71], v[96:99], v[36:39]
    ds_read_b128 v[168:171], v18 offset:2752
    buffer_load_dwordx4 v[208:211], v15, s[28:31], s8 offen offset:2048 sc1
    v_mfma_f32_16x16x32_bf16 v[40:43], v[68:71], v[100:103], v[40:43]
    ds_read_b64 v[140:141], v17 offset:1728
    buffer_load_dwordx4 v[224:227], v15, s[28:31], s9 offen offset:2048 sc1
    v_mfma_f32_16x16x32_bf16 v[44:47], v[68:71], v[104:107], v[44:47]
    ds_read_b64 v[142:143], v17 offset:1736
    buffer_load_dwordx4 v[212:215], v15, s[28:31], s8 offen offset:3072 sc1
    v_mfma_f32_16x16x32_bf16 v[48:51], v[68:71], v[108:111], v[48:51]
    ds_read_b128 v[172:175], v18 offset:2240
    buffer_load_dwordx4 v[228:231], v15, s[28:31], s9 offen offset:3072 sc1
    v_mfma_f32_16x16x32_bf16 v[52:55], v[68:71], v[112:115], v[52:55]
    ds_read_b64 v[144:145], v17 offset:2240
    v_mfma_f32_16x16x32_bf16 v[56:59], v[68:71], v[116:119], v[56:59]
    ds_read_b64 v[146:147], v17 offset:2248
    v_mfma_f32_16x16x32_bf16 v[60:63], v[68:71], v[120:123], v[60:63]
    ds_read_b128 v[176:179], v18 offset:1728
    s_add_u32 s36, s40, 0
    buffer_load_dwordx4 a[0:3], v31, s[28:31], s36 offen sc1
    v_mfma_f32_16x16x32_bf16 v[40:43], v[72:75], v[96:99], v[40:43]
    ds_read_b64 v[148:149], v17 offset:2752
    v_mfma_f32_16x16x32_bf16 v[44:47], v[72:75], v[100:103], v[44:47]
    ds_read_b64 v[150:151], v17 offset:2760
    v_mfma_f32_16x16x32_bf16 v[48:51], v[72:75], v[104:107], v[48:51]
    ds_read_b128 v[180:183], v18 offset:1216
    v_mfma_f32_16x16x32_bf16 v[52:55], v[72:75], v[108:111], v[52:55]
    ds_read_b64 v[152:153], v17 offset:3264
    v_mfma_f32_16x16x32_bf16 v[56:59], v[72:75], v[112:115], v[56:59]
    ds_read_b64 v[154:155], v17 offset:3272
    s_add_u32 s36, s41, 0
    buffer_load_dwordx4 a[4:7], v31, s[28:31], s36 offen sc1
    v_mfma_f32_16x16x32_bf16 v[60:63], v[72:75], v[116:119], v[60:63]
    ds_read_b128 v[184:187], v18 offset:704
    v_mfma_f32_16x16x32_bf16 v[44:47], v[76:79], v[96:99], v[44:47]
    ds_read_b64 v[156:157], v17 offset:3776
    v_mfma_f32_16x16x32_bf16 v[48:51], v[76:79], v[100:103], v[48:51]
    ds_read_b64 v[158:159], v17 offset:3784
    v_mfma_f32_16x16x32_bf16 v[52:55], v[76:79], v[104:107], v[52:55]
    ds_read_b128 v[188:191], v18 offset:192
    v_mfma_f32_16x16x32_bf16 v[56:59], v[76:79], v[108:111], v[56:59]
    s_add_u32 s36, s42, 0
    buffer_load_dwordx4 a[8:11], v31, s[28:31], s36 offen sc1
    v_mfma_f32_16x16x32_bf16 v[60:63], v[76:79], v[112:115], v[60:63]
    v_mfma_f32_16x16x32_bf16 v[48:51], v[80:83], v[96:99], v[48:51]
    v_mfma_f32_16x16x32_bf16 v[52:55], v[80:83], v[100:103], v[52:55]
    v_mfma_f32_16x16x32_bf16 v[56:59], v[80:83], v[104:107], v[56:59]
    v_mfma_f32_16x16x32_bf16 v[60:63], v[80:83], v[108:111], v[60:63]
    s_add_u32 s36, s40, 1024
    buffer_load_dwordx4 a[12:15], v31, s[28:31], s36 offen sc1
    v_mfma_f32_16x16x32_bf16 v[52:55], v[84:87], v[96:99], v[52:55]
    v_mfma_f32_16x16x32_bf16 v[56:59], v[84:87], v[100:103], v[56:59]
    v_mfma_f32_16x16x32_bf16 v[60:63], v[84:87], v[104:107], v[60:63]
    v_mfma_f32_16x16x32_bf16 v[56:59], v[88:91], v[96:99], v[56:59]
    v_mfma_f32_16x16x32_bf16 v[60:63], v[88:91], v[100:103], v[60:63]
    s_add_u32 s36, s41, 1024
    buffer_load_dwordx4 a[16:19], v31, s[28:31], s36 offen sc1
    v_mfma_f32_16x16x32_bf16 v[60:63], v[92:95], v[96:99], v[60:63]
    s_waitcnt lgkmcnt(0)
    v_mfma_f32_16x16x32_bf16 v[32:35], v[128:131], v[160:163], v[32:35]
    v_mfma_f32_16x16x32_bf16 v[36:39], v[128:131], v[164:167], v[36:39]
    v_mfma_f32_16x16x32_bf16 v[40:43], v[128:131], v[168:171], v[40:43]
    v_mfma_f32_16x16x32_bf16 v[44:47], v[128:131], v[172:175], v[44:47]
    v_mfma_f32_16x16x32_bf16 v[48:51], v[128:131], v[176:179], v[48:51]
    s_add_u32 s36, s42, 1024
    buffer_load_dwordx4 a[20:23], v31, s[28:31], s36 offen sc1
    v_mfma_f32_16x16x32_bf16 v[52:55], v[128:131], v[180:183], v[52:55]
    v_mfma_f32_16x16x32_bf16 v[56:59], v[128:131], v[184:187], v[56:59]
    v_mfma_f32_16x16x32_bf16 v[60:63], v[128:131], v[188:191], v[60:63]
    v_mfma_f32_16x16x32_bf16 v[36:39], v[132:135], v[160:163], v[36:39]
    v_mfma_f32_16x16x32_bf16 v[40:43], v[132:135], v[164:167], v[40:43]
    s_add_u32 s36, s40, 2048
    buffer_load_dwordx4 a[24:27], v31, s[28:31], s36 offen sc1
    v_mfma_f32_16x16x32_bf16 v[44:47], v[132:135], v[168:171], v[44:47]
    v_mfma_f32_16x16x32_bf16 v[48:51], v[132:135], v[172:175], v[48:51]
    v_mfma_f32_16x16x32_bf16 v[52:55], v[132:135], v[176:179], v[52:55]
    v_mfma_f32_16x16x32_bf16 v[56:59], v[132:135], v[180:183], v[56:59]
    v_mfma_f32_16x16x32_bf16 v[60:63], v[132:135], v[184:187], v[60:63]
    s_add_u32 s36, s41, 2048
    buffer_load_dwordx4 a[28:31], v31, s[28:31], s36 offen sc1
    v_mfma_f32_16x16x32_bf16 v[40:43], v[136:139], v[160:163], v[40:43]
    v_mfma_f32_16x16x32_bf16 v[44:47], v[136:139], v[164:167], v[44:47]
    v_mfma_f32_16x16x32_bf16 v[48:51], v[136:139], v[168:171], v[48:51]
    v_mfma_f32_16x16x32_bf16 v[52:55], v[136:139], v[172:175], v[52:55]
    v_mfma_f32_16x16x32_bf16 v[56:59], v[136:139], v[176:179], v[56:59]
    s_add_u32 s36, s42, 2048
    buffer_load_dwordx4 a[32:35], v31, s[28:31], s36 offen sc1
    v_mfma_f32_16x16x32_bf16 v[60:63], v[136:139], v[180:183], v[60:63]
    v_mfma_f32_16x16x32_bf16 v[44:47], v[140:143], v[160:163], v[44:47]
    v_mfma_f32_16x16x32_bf16 v[48:51], v[140:143], v[164:167], v[48:51]
    v_mfma_f32_16x16x32_bf16 v[52:55], v[140:143], v[168:171], v[52:55]
    v_mfma_f32_16x16x32_bf16 v[56:59], v[140:143], v[172:175], v[56:59]
    s_add_u32 s36, s40, 3072
    buffer_load_dwordx4 a[36:39], v31, s[28:31], s36 offen sc1
    v_mfma_f32_16x16x32_bf16 v[60:63], v[140:143], v[176:179], v[60:63]
    v_mfma_f32_16x16x32_bf16 v[48:51], v[144:147], v[160:163], v[48:51]
    v_mfma_f32_16x16x32_bf16 v[52:55], v[144:147], v[164:167], v[52:55]
    v_mfma_f32_16x16x32_bf16 v[56:59], v[144:147], v[168:171], v[56:59]
    v_mfma_f32_16x16x32_bf16 v[60:63], v[144:147], v[172:175], v[60:63]
    s_add_u32 s36, s41, 3072
    buffer_load_dwordx4 a[40:43], v31, s[28:31], s36 offen sc1
    v_mfma_f32_16x16x32_bf16 v[52:55], v[148:151], v[160:163], v[52:55]
    v_mfma_f32_16x16x32_bf16 v[56:59], v[148:151], v[164:167], v[56:59]
    v_mfma_f32_16x16x32_bf16 v[60:63], v[148:151], v[168:171], v[60:63]
    v_mfma_f32_16x16x32_bf16 v[56:59], v[152:155], v[160:163], v[56:59]
    v_mfma_f32_16x16x32_bf16 v[60:63], v[152:155], v[164:167], v[60:63]
    s_add_u32 s36, s42, 3072
    buffer_load_dwordx4 a[44:47], v31, s[28:31], s36 offen sc1
    v_mfma_f32_16x16x32_bf16 v[60:63], v[156:159], v[160:163], v[60:63]
    v_lshlrev_b32 v4, 4, v1
    s_lshl_b32 s36, s18, 12
    s_add_u32 s36, s36, 49152
    v_add_u32 v5, s36, v4
    s_xor_b32 s36, s36, 4096
    v_add_u32 v6, s36, v4
    s_cmp_eq_u32 s67, 0
    s_cbranch_scc0 L_c_x1
    ds_write_b128 v5, v[48:51] offset:0
    ds_write_b128 v5, v[52:55] offset:1024
    ds_write_b128 v5, v[56:59] offset:2048
    ds_write_b128 v5, v[60:63] offset:3072
    s_waitcnt lgkmcnt(0)
    s_barrier
    ds_read_b128 v[80:83], v6 offset:0
    ds_read_b128 v[84:87], v6 offset:1024
    ds_read_b128 v[88:91], v6 offset:2048
    ds_read_b128 v[92:95], v6 offset:3072
    s_waitcnt lgkmcnt(0)
    v_pk_add_f32 v[64:65], v[32:33], v[80:81]
    v_pk_add_f32 v[66:67], v[34:35], v[82:83]
    v_pk_add_f32 v[68:69], v[36:37], v[84:85]
    v_pk_add_f32 v[70:71], v[38:39], v[86:87]
    v_pk_add_f32 v[72:73], v[40:41], v[88:89]
    v_pk_add_f32 v[74:75], v[42:43], v[90:91]
    v_pk_add_f32 v[76:77], v[44:45], v[92:93]
    v_pk_add_f32 v[78:79], v[46:47], v[94:95]
    s_nop 0
    s_branch L_c_x2
L_c_x1:
    ds_write_b128 v5, v[32:35] offset:0
    ds_write_b128 v5, v[36:39] offset:1024
    ds_write_b128 v5, v[40:43] offset:2048
    ds_write_b128 v5, v[44:47] offset:3072
    s_waitcnt lgkmcnt(0)
    s_barrier
    ds_read_b128 v[80:83], v6 offset:0
    ds_read_b128 v[84:87], v6 offset:1024
    ds_read_b128 v[88:91], v6 offset:2048
    ds_read_b128 v[92:95], v6 offset:3072
    s_waitcnt lgkmcnt(0)
    v_pk_add_f32 v[64:65], v[48:49], v[80:81]
    v_pk_add_f32 v[66:67], v[50:51], v[82:83]
    v_pk_add_f32 v[68:69], v[52:53], v[84:85]
    v_pk_add_f32 v[70:71], v[54:55], v[86:87]
    v_pk_add_f32 v[72:73], v[56:57], v[88:89]
    v_pk_add_f32 v[74:75], v[58:59], v[90:91]
    v_pk_add_f32 v[76:77], v[60:61], v[92:93]
    v_pk_add_f32 v[78:79], v[62:63], v[94:95]
    s_nop 1
L_c_x2:
    v_lshlrev_b32 v7, 5, v11
    v_lshl_add_u32 v7, v12, 3, v7
    s_lshl_b32 s36, s67, 11
    s_sub_u32 s37, s62, s36
    s_add_u32 s37, s37, 19192
    v_sub_u32 v7, s37, v7
    ds_read_b64 v[96:97], v7 offset:1536
    ds_read_b64 v[98:99], v7 offset:1024
    ds_read_b64 v[100:101], v7 offset:512
    ds_read_b64 v[102:103], v7 offset:0
    s_lshr_b32 s39, s65, 12
    s_mul_i32 s39, s39, 4352
    s_add_u32 s38, s39, 5242880
    s_add_u32 s39, s39, 7602176
    s_waitcnt vmcnt(12) lgkmcnt(0)
    v_and_b32 v104, 0xffff0000, v97
    v_lshlrev_b32 v105, 16, v97
    v_and_b32 v106, 0xffff0000, v96
    v_lshlrev_b32 v107, 16, v96
    v_and_b32 v114, 0xffff0000, v99
    v_lshlrev_b32 v115, 16, v99
    v_and_b32 v116, 0xffff0000, v98
    v_lshlrev_b32 v117, 16, v98
    v_and_b32 v124, 0xffff0000, v101
    v_lshlrev_b32 v125, 16, v101
    v_and_b32 v126, 0xffff0000, v100
    v_lshlrev_b32 v127, 16, v100
    v_and_b32 v134, 0xffff0000, v103
    v_lshlrev_b32 v135, 16, v103
    v_and_b32 v136, 0xffff0000, v102
    v_lshlrev_b32 v137, 16, v102
    v_pk_fma_f32 v[64:65], v[104:105], v[20:21], v[64:65] op_sel_hi:[1,0,1]
    v_pk_fma_f32 v[66:67], v[106:107], v[20:21], v[66:67] op_sel_hi:[1,0,1]
    v_pk_fma_f32 v[68:69], v[114:115], v[20:21], v[68:69] op_sel_hi:[1,0,1]
    v_pk_fma_f32 v[70:71], v[116:117], v[20:21], v[70:71] op_sel_hi:[1,0,1]
    v_pk_fma_f32 v[72:73], v[124:125], v[20:21], v[72:73] op_sel_hi:[1,0,1]
    v_pk_fma_f32 v[74:75], v[126:127], v[20:21], v[74:75] op_sel_hi:[1,0,1]
    v_pk_fma_f32 v[76:77], v[134:135], v[20:21], v[76:77] op_sel_hi:[1,0,1]
    v_pk_fma_f32 v[78:79], v[136:137], v[20:21], v[78:79] op_sel_hi:[1,0,1]
    v_cvt_pk_bf16_f32 v108, v64, v65
    v_cvt_pk_bf16_f32 v109, v66, v67
    v_cvt_pk_bf16_f32 v118, v68, v69
    v_cvt_pk_bf16_f32 v119, v70, v71
    v_cvt_pk_bf16_f32 v128, v72, v73
    v_cvt_pk_bf16_f32 v129, v74, v75
    v_cvt_pk_bf16_f32 v138, v76, v77
    v_cvt_pk_bf16_f32 v139, v78, v79
    v_lshlrev_b32 v104, 16, v192
    v_and_b32 v105, 0xffff0000, v192
    v_lshlrev_b32 v106, 16, v193
    v_and_b32 v107, 0xffff0000, v193
    buffer_store_dwordx2 v[108:109], v14, s[28:31], s38 offen offset:0 sc1
    v_lshlrev_b32 v114, 16, v194
    v_and_b32 v115, 0xffff0000, v194
    v_lshlrev_b32 v116, 16, v195
    v_and_b32 v117, 0xffff0000, v195
    buffer_store_dwordx2 v[118:119], v14, s[28:31], s38 offen offset:512 sc1
    v_lshlrev_b32 v124, 16, v196
    v_and_b32 v125, 0xffff0000, v196
    v_lshlrev_b32 v126, 16, v197
    v_and_b32 v127, 0xffff0000, v197
    buffer_store_dwordx2 v[128:129], v14, s[28:31], s38 offen offset:1024 sc1
    v_lshlrev_b32 v134, 16, v198
    v_and_b32 v135, 0xffff0000, v198
    v_lshlrev_b32 v136, 16, v199
    v_and_b32 v137, 0xffff0000, v199
    buffer_store_dwordx2 v[138:139], v14, s[28:31], s38 offen offset:1536 sc1
    v_lshlrev_b32 v64, 16, v108
    v_and_b32 v65, 0xffff0000, v108
    v_lshlrev_b32 v66, 16, v109
    v_and_b32 v67, 0xffff0000, v109
    v_pk_fma_f32 v[110:111], v[104:105], v[200:201], v[216:217]
    v_pk_fma_f32 v[112:113], v[106:107], v[202:203], v[218:219]
    v_lshlrev_b32 v68, 16, v118
    v_and_b32 v69, 0xffff0000, v118
    v_lshlrev_b32 v70, 16, v119
    v_and_b32 v71, 0xffff0000, v119
    v_pk_fma_f32 v[120:121], v[114:115], v[204:205], v[220:221]
    v_pk_fma_f32 v[122:123], v[116:117], v[206:207], v[222:223]
    v_lshlrev_b32 v72, 16, v128
    v_and_b32 v73, 0xffff0000, v128
    v_lshlrev_b32 v74, 16, v129
    v_and_b32 v75, 0xffff0000, v129
    v_pk_fma_f32 v[130:131], v[124:125], v[208:209], v[224:225]
    v_pk_fma_f32 v[132:133], v[126:127], v[210:211], v[226:227]
    v_lshlrev_b32 v76, 16, v138
    v_and_b32 v77, 0xffff0000, v138
    v_lshlrev_b32 v78, 16, v139
    v_and_b32 v79, 0xffff0000, v139
    v_pk_fma_f32 v[140:141], v[134:135], v[212:213], v[228:229]
    v_pk_fma_f32 v[142:143], v[136:137], v[214:215], v[230:231]
    v_pk_fma_f32 v[110:111], v[110:111], v[64:65], v[104:105]
    v_pk_fma_f32 v[112:113], v[112:113], v[66:67], v[106:107]
    v_pk_fma_f32 v[120:121], v[120:121], v[68:69], v[114:115]
    v_pk_fma_f32 v[122:123], v[122:123], v[70:71], v[116:117]
    v_pk_fma_f32 v[130:131], v[130:131], v[72:73], v[124:125]
    v_pk_fma_f32 v[132:133], v[132:133], v[74:75], v[126:127]
    v_pk_fma_f32 v[140:141], v[140:141], v[76:77], v[134:135]
    v_pk_fma_f32 v[142:143], v[142:143], v[78:79], v[136:137]
    v_cvt_pk_bf16_f32 v64, v110, v111
    v_cvt_pk_bf16_f32 v65, v112, v113
    buffer_store_dwordx2 v[64:65], v14, s[28:31], s39 offen offset:0 sc1
    v_cvt_pk_bf16_f32 v68, v120, v121
    v_cvt_pk_bf16_f32 v69, v122, v123
    buffer_store_dwordx2 v[68:69], v14, s[28:31], s39 offen offset:512 sc1
    v_cvt_pk_bf16_f32 v72, v130, v131
    v_cvt_pk_bf16_f32 v73, v132, v133
    buffer_store_dwordx2 v[72:73], v14, s[28:31], s39 offen offset:1024 sc1
    v_cvt_pk_bf16_f32 v76, v140, v141
    v_cvt_pk_bf16_f32 v77, v142, v143
    buffer_store_dwordx2 v[76:77], v14, s[28:31], s39 offen offset:1536 sc1
    s_add_u32 s36, s3, 3
    v_mov_b32 v2, s36
    v_mov_b32 v3, s64
    s_waitcnt vmcnt(0)
    s_barrier
    s_cmp_lg_u32 s18, 0
    s_cbranch_scc1 sg_5
    s_mov_b64 exec, 1
    buffer_store_dword v2, v3, s[28:31], 0 offen sc1
    s_mov_b64 exec, -1
sg_5:
    v_and_b32 v1, 63, v0
    s_add_u32 s36, s40, 4096
    buffer_load_dwordx4 a[48:51], v31, s[28:31], s36 offen sc1
    s_add_u32 s36, s41, 4096
    buffer_load_dwordx4 a[52:55], v31, s[28:31], s36 offen sc1
    s_add_u32 s36, s42, 4096
    buffer_load_dwordx4 a[56:59], v31, s[28:31], s36 offen sc1
    s_add_u32 s36, s40, 5120
    buffer_load_dwordx4 a[60:63], v31, s[28:31], s36 offen sc1
    s_add_u32 s36, s41, 5120
    buffer_load_dwordx4 a[64:67], v31, s[28:31], s36 offen sc1
    s_add_u32 s36, s42, 5120
    buffer_load_dwordx4 a[68:71], v31, s[28:31], s36 offen sc1
    s_add_u32 s36, s40, 6144
    buffer_load_dwordx4 a[72:75], v31, s[28:31], s36 offen sc1
    s_add_u32 s36, s41, 6144
    buffer_load_dwordx4 a[76:79], v31, s[28:31], s36 offen sc1
    s_add_u32 s36, s42, 6144
    buffer_load_dwordx4 a[80:83], v31, s[28:31], s36 offen sc1
    s_add_u32 s36, s40, 7168
    buffer_load_dwordx4 a[84:87], v31, s[28:31], s36 offen sc1
    s_add_u32 s36, s41, 7168
    buffer_load_dwordx4 a[88:91], v31, s[28:31], s36 offen sc1
    s_add_u32 s36, s42, 7168
    buffer_load_dwordx4 a[92:95], v31, s[28:31], s36 offen sc1
    s_add_u32 s36, s40, 8192
    buffer_load_dwordx4 a[96:99], v31, s[28:31], s36 offen sc1
    s_add_u32 s36, s41, 8192
    buffer_load_dwordx4 a[100:103], v31, s[28:31], s36 offen sc1
    s_add_u32 s36, s42, 8192
    buffer_load_dwordx4 a[104:107], v31, s[28:31], s36 offen sc1
    s_add_u32 s36, s40, 9216
    buffer_load_dwordx4 a[108:111], v31, s[28:31], s36 offen sc1
    s_add_u32 s36, s41, 9216
    buffer_load_dwordx4 a[112:115], v31, s[28:31], s36 offen sc1
    s_add_u32 s36, s42, 9216
    buffer_load_dwordx4 a[116:119], v31, s[28:31], s36 offen sc1
    s_add_u32 s36, s40, 10240
    buffer_load_dwordx4 a[120:123], v31, s[28:31], s36 offen sc1
    s_add_u32 s36, s41, 10240
    buffer_load_dwordx4 a[124:127], v31, s[28:31], s36 offen sc1
    s_add_u32 s36, s42, 10240
    buffer_load_dwordx4 a[128:131], v31, s[28:31], s36 offen sc1
    s_add_u32 s36, s40, 11264
    buffer_load_dwordx4 a[132:135], v31, s[28:31], s36 offen sc1
    s_add_u32 s36, s41, 11264
    buffer_load_dwordx4 a[136:139], v31, s[28:31], s36 offen sc1
    s_add_u32 s36, s42, 11264
    buffer_load_dwordx4 a[140:143], v31, s[28:31], s36 offen sc1
    s_add_u32 s36, s40, 12288
    buffer_load_dwordx4 a[144:147], v31, s[28:31], s36 offen sc1
    s_add_u32 s36, s41, 12288
    buffer_load_dwordx4 a[148:151], v31, s[28:31], s36 offen sc1
    s_add_u32 s36, s42, 12288
    buffer_load_dwordx4 a[152:155], v31, s[28:31], s36 offen sc1
    v_mov_b32 v100, 0x3f803f80
    v_mov_b32 v101, 0x3f803f80
    v_mov_b32 v102, 0x3f803f80
    v_mov_b32 v103, 0x3f803f80
    s_nop 1
    v_mfma_f32_16x16x32_bf16 v[32:35], a[0:3], v[100:103], 0
    v_mfma_f32_16x16x32_bf16 v[36:39], a[4:7], v[100:103], 0
    v_mfma_f32_16x16x32_bf16 v[40:43], a[8:11], v[100:103], 0
    v_mfma_f32_16x16x32_bf16 v[32:35], a[12:15], v[100:103], v[32:35]
    v_mfma_f32_16x16x32_bf16 v[36:39], a[16:19], v[100:103], v[36:39]
    v_mfma_f32_16x16x32_bf16 v[40:43], a[20:23], v[100:103], v[40:43]
    v_mfma_f32_16x16x32_bf16 v[32:35], a[24:27], v[100:103], v[32:35]
    v_mfma_f32_16x16x32_bf16 v[36:39], a[28:31], v[100:103], v[36:39]
    v_mfma_f32_16x16x32_bf16 v[40:43], a[32:35], v[100:103], v[40:43]
    v_mfma_f32_16x16x32_bf16 v[32:35], a[36:39], v[100:103], v[32:35]
    v_mfma_f32_16x16x32_bf16 v[36:39], a[40:43], v[100:103], v[36:39]
    v_mfma_f32_16x16x32_bf16 v[40:43], a[44:47], v[100:103], v[40:43]
    v_lshrrev_b32 v2, 3, v1
    v_bfe_u32 v3, v1, 1, 2
    v_bfe_u32 v6, v1, 4, 1
    v_xor_b32 v3, v3, v6
    s_and_b32 s36, s18, 2
    v_xor_b32 v3, s36, v3
    v_and_b32 v6, 1, v1
    v_lshlrev_b32 v6, 4, v6
    v_mul_u32_u24 v2, 4352, v2
    v_add_u32 v6, v2, v6
    v_lshl_add_u32 v27, v3, 5, v6
    v_and_b32 v2, 15, v1
    v_lshrrev_b32 v3, 4, v1
    s_add_u32 s36, s18, 0
    s_and_b32 s36, s36, 3
    v_bfe_u32 v4, v1, 2, 2
    v_lshl_add_u32 v5, v3, 4, v4
    v_lshlrev_b32 v5, 7, v5
    v_lshrrev_b32 v4, 1, v4
    v_and_b32 v6, 1, v3
    v_lshl_or_b32 v4, v6, 1, v4
    v_xor_b32 v4, s36, v4
    v_lshl_add_u32 v5, v4, 5, v5
    v_and_b32 v6, 3, v1
    v_lshl_add_u32 v8, v6, 3, v5
    s_lshl_b32 s37, s36, 8
    s_add_u32 s37, s37, 147456
    v_lshl_add_u32 v15, v2, 4, s37
    s_add_u32 s36, s18, 1
    s_and_b32 s36, s36, 3
    v_bfe_u32 v4, v1, 2, 2
    v_lshl_add_u32 v5, v3, 4, v4
    v_lshlrev_b32 v5, 7, v5
    v_lshrrev_b32 v4, 1, v4
    v_and_b32 v6, 1, v3
    v_lshl_or_b32 v4, v6, 1, v4
    v_xor_b32 v4, s36, v4
    v_lshl_add_u32 v5, v4, 5, v5
    v_and_b32 v6, 3, v1
    v_lshl_add_u32 v9, v6, 3, v5
    s_lshl_b32 s37, s36, 8
    s_add_u32 s37, s37, 147456
    v_lshl_add_u32 v16, v2, 4, s37
    s_add_u32 s36, s18, 2
    s_and_b32 s36, s36, 3
    v_bfe_u32 v4, v1, 2, 2
    v_lshl_add_u32 v5, v3, 4, v4
    v_lshlrev_b32 v5, 7, v5
    v_lshrrev_b32 v4, 1, v4
    v_and_b32 v6, 1, v3
    v_lshl_or_b32 v4, v6, 1, v4
    v_xor_b32 v4, s36, v4
    v_lshl_add_u32 v5, v4, 5, v5
    v_and_b32 v6, 3, v1
    v_lshl_add_u32 v10, v6, 3, v5
    s_lshl_b32 s37, s36, 8
    s_add_u32 s37, s37, 147456
    v_lshl_add_u32 v17, v2, 4, s37
    s_add_u32 s36, s18, 3
    s_and_b32 s36, s36, 3
    v_bfe_u32 v4, v1, 2, 2
    v_lshl_add_u32 v5, v3, 4, v4
    v_lshlrev_b32 v5, 7, v5
    v_lshrrev_b32 v4, 1, v4
    v_and_b32 v6, 1, v3
    v_lshl_or_b32 v4, v6, 1, v4
    v_xor_b32 v4, s36, v4
    v_lshl_add_u32 v5, v4, 5, v5
    v_and_b32 v6, 3, v1
    v_lshl_add_u32 v11, v6, 3, v5
    s_lshl_b32 s37, s36, 8
    s_add_u32 s37, s37, 147456
    v_lshl_add_u32 v18, v2, 4, s37
    v_lshrrev_b32 v4, 5, v1
    v_add_u32 v4, s18, v4
    v_add_u32 v4, 0, v4
    v_and_b32 v4, 3, v4
    v_mul_u32_u24 v5, 44032, v4
    v_bfe_u32 v6, v1, 4, 1
    v_lshl_add_u32 v5, v6, 7, v5
    v_lshl_add_u32 v12, v2, 3, v5
    v_lshlrev_b32 v4, 8, v4
    v_lshl_add_u32 v4, v2, 4, v4
    v_add_u32 v19, 147456, v4
    v_lshrrev_b32 v4, 5, v1
    v_add_u32 v4, s18, v4
    v_add_u32 v4, 2, v4
    v_and_b32 v4, 3, v4
    v_mul_u32_u24 v5, 44032, v4
    v_bfe_u32 v6, v1, 4, 1
    v_lshl_add_u32 v5, v6, 7, v5
    v_lshl_add_u32 v13, v2, 3, v5
    v_lshlrev_b32 v4, 8, v4
    v_lshl_add_u32 v4, v2, 4, v4
    v_add_u32 v20, 147456, v4
    s_mul_i32 s36, s20, 352256
    s_add_u32 s36, s36, 10485760
    s_add_u32 s52, s44, s36
    s_add_u32 s53, s45, s36
    s_add_u32 s54, s46, s36
    s_cmp_lg_u32 s18, 3
    s_cbranch_scc1 ww_6
    v_lshlrev_b32 v14, 6, v1
    v_add_u32 v14, 9961472, v14
    s_add_u32 s37, s3, 3
    s_mov_b32 s38, 0
wf_7:
    buffer_load_dword v116, v14, s[28:31], 0 offen sc1
    s_movk_i32 s39, 4096
    buffer_load_dword v117, v14, s[28:31], s39 offen sc1
    s_movk_i32 s39, 8192
    buffer_load_dword v118, v14, s[28:31], s39 offen sc1
    s_movk_i32 s39, 12288
    buffer_load_dword v119, v14, s[28:31], s39 offen sc1
    s_add_u32 s38, s38, 1
    s_waitcnt vmcnt(0)
    v_subrev_u32 v116, s37, v116
    v_subrev_u32 v117, s37, v117
    v_subrev_u32 v118, s37, v118
    v_subrev_u32 v119, s37, v119
    v_max_u32 v116, v116, v117
    v_max_u32 v116, v116, v118
    v_max_u32 v116, v116, v119
    v_cmp_gt_u32 vcc, 16, v116
    s_cmp_gt_u32 s38, 200000
    s_nop 2
    s_cbranch_scc1 wf_7_x
    s_cmp_eq_u64 vcc, -1
    s_cbranch_scc1 wf_7_x
    s_branch wf_7
wf_7_x:
ww_6:
    s_barrier
    s_mul_i32 s56, s18, 34816
    s_lshl_b32 s57, s20, 8
    s_add_u32 s56, s56, s57
    s_add_u32 s56, s56, 7602176
    s_lshl_b32 s57, s18, 10
    s_add_u32 s57, s57, 0
    s_add_u32 m0, s57, 0
    s_nop 0
    buffer_load_dwordx4 v27, s[28:31], s56 offen sc1 lds
    s_add_u32 s56, s56, 139264
    s_add_u32 m0, s57, 4096
    s_nop 0
    buffer_load_dwordx4 v27, s[28:31], s56 offen sc1 lds
    s_add_u32 s56, s56, 139264
    s_add_u32 m0, s57, 8192
    s_nop 0
    buffer_load_dwordx4 v27, s[28:31], s56 offen sc1 lds
    s_add_u32 s56, s56, 139264
    s_add_u32 m0, s57, 12288
    s_nop 0
    buffer_load_dwordx4 v27, s[28:31], s56 offen sc1 lds
    s_add_u32 s56, s56, 139264
    s_add_u32 m0, s57, 16384
    s_nop 0
    buffer_load_dwordx4 v27, s[28:31], s56 offen sc1 lds
    s_add_u32 s56, s56, 139264
    s_add_u32 m0, s57, 20480
    s_nop 0
    buffer_load_dwordx4 v27, s[28:31], s56 offen sc1 lds
    s_add_u32 s56, s56, 139264
    s_add_u32 m0, s57, 24576
    s_nop 0
    buffer_load_dwordx4 v27, s[28:31], s56 offen sc1 lds
    s_add_u32 s56, s56, 139264
    s_add_u32 m0, s57, 28672
    s_nop 0
    buffer_load_dwordx4 v27, s[28:31], s56 offen sc1 lds
    s_add_u32 s56, s56, 139264
    s_add_u32 m0, s57, 32768
    s_nop 0
    buffer_load_dwordx4 v27, s[28:31], s56 offen sc1 lds
    s_add_u32 s56, s56, 139264
    s_add_u32 m0, s57, 36864
    s_nop 0
    buffer_load_dwordx4 v27, s[28:31], s56 offen sc1 lds
    s_add_u32 s56, s56, 139264
    s_add_u32 m0, s57, 40960
    s_nop 0
    buffer_load_dwordx4 v27, s[28:31], s56 offen sc1 lds
    s_add_u32 s56, s56, 139264
    s_add_u32 m0, s57, 45056
    s_nop 0
    buffer_load_dwordx4 v27, s[28:31], s56 offen sc1 lds
    s_add_u32 s56, s56, 139264
    s_add_u32 m0, s57, 49152
    s_nop 0
    buffer_load_dwordx4 v27, s[28:31], s56 offen sc1 lds
    s_add_u32 s56, s56, 139264
    s_add_u32 m0, s57, 53248
    s_nop 0
    buffer_load_dwordx4 v27, s[28:31], s56 offen sc1 lds
    s_add_u32 s56, s56, 139264
    s_add_u32 m0, s57, 57344
    s_nop 0
    buffer_load_dwordx4 v27, s[28:31], s56 offen sc1 lds
    s_add_u32 s56, s56, 139264
    s_add_u32 m0, s57, 61440
    s_nop 0
    buffer_load_dwordx4 v27, s[28:31], s56 offen sc1 lds
    s_add_u32 s56, s56, 139264
    s_waitcnt vmcnt(16)
    v_mov_b32 v100, 0x3f803f80
    v_mov_b32 v101, 0x3f803f80
    v_mov_b32 v102, 0x3f803f80
    v_mov_b32 v103, 0x3f803f80
    s_nop 1
    v_mfma_f32_16x16x32_bf16 v[32:35], a[48:51], v[100:103], v[32:35]
    v_mfma_f32_16x16x32_bf16 v[36:39], a[52:55], v[100:103], v[36:39]
    v_mfma_f32_16x16x32_bf16 v[40:43], a[56:59], v[100:103], v[40:43]
    v_mfma_f32_16x16x32_bf16 v[32:35], a[60:63], v[100:103], v[32:35]
    v_mfma_f32_16x16x32_bf16 v[36:39], a[64:67], v[100:103], v[36:39]
    v_mfma_f32_16x16x32_bf16 v[40:43], a[68:71], v[100:103], v[40:43]
    v_mfma_f32_16x16x32_bf16 v[32:35], a[72:75], v[100:103], v[32:35]
    v_mfma_f32_16x16x32_bf16 v[36:39], a[76:79], v[100:103], v[36:39]
    v_mfma_f32_16x16x32_bf16 v[40:43], a[80:83], v[100:103], v[40:43]
    v_mfma_f32_16x16x32_bf16 v[32:35], a[84:87], v[100:103], v[32:35]
    v_mfma_f32_16x16x32_bf16 v[36:39], a[88:91], v[100:103], v[36:39]
    v_mfma_f32_16x16x32_bf16 v[40:43], a[92:95], v[100:103], v[40:43]
    v_mfma_f32_16x16x32_bf16 v[32:35], a[96:99], v[100:103], v[32:35]
    v_mfma_f32_16x16x32_bf16 v[36:39], a[100:103], v[100:103], v[36:39]
    v_mfma_f32_16x16x32_bf16 v[40:43], a[104:107], v[100:103], v[40:43]
    v_mfma_f32_16x16x32_bf16 v[32:35], a[108:111], v[100:103], v[32:35]
    v_mfma_f32_16x16x32_bf16 v[36:39], a[112:115], v[100:103], v[36:39]
    v_mfma_f32_16x16x32_bf16 v[40:43], a[116:119], v[100:103], v[40:43]
    v_mfma_f32_16x16x32_bf16 v[32:35], a[120:123], v[100:103], v[32:35]
    v_mfma_f32_16x16x32_bf16 v[36:39], a[124:127], v[100:103], v[36:39]
    v_mfma_f32_16x16x32_bf16 v[40:43], a[128:131], v[100:103], v[40:43]
    v_mfma_f32_16x16x32_bf16 v[32:35], a[132:135], v[100:103], v[32:35]
    v_mfma_f32_16x16x32_bf16 v[36:39], a[136:139], v[100:103], v[36:39]
    v_mfma_f32_16x16x32_bf16 v[40:43], a[140:143], v[100:103], v[40:43]
    v_mfma_f32_16x16x32_bf16 v[32:35], a[144:147], v[100:103], v[32:35]
    v_mfma_f32_16x16x32_bf16 v[36:39], a[148:151], v[100:103], v[36:39]
    v_mfma_f32_16x16x32_bf16 v[40:43], a[152:155], v[100:103], v[40:43]
    s_waitcnt vmcnt(8)
    s_barrier
    v_mov_b32 v116, 0x3f803f80
    v_mov_b32 v117, 0x3f803f80
    v_mov_b32 v118, 0x3f803f80
    v_mov_b32 v119, 0x3f803f80
    ds_read_b64_tr_b16 v[100:101], v8 offset:0
    ds_read_b64_tr_b16 v[102:103], v8 offset:512
    ds_read_b64_tr_b16 v[104:105], v9 offset:0
    ds_read_b64_tr_b16 v[106:107], v9 offset:512
    ds_read_b64_tr_b16 v[108:109], v8 offset:1024
    ds_read_b64_tr_b16 v[110:111], v8 offset:1536
    s_add_u32 s36, s40, 13312
    buffer_load_dwordx4 a[156:159], v31, s[28:31], s36 offen sc1
    s_add_u32 s36, s41, 13312
    buffer_load_dwordx4 a[160:163], v31, s[28:31], s36 offen sc1
    s_add_u32 s36, s42, 13312
    buffer_load_dwordx4 a[164:167], v31, s[28:31], s36 offen sc1
    s_waitcnt lgkmcnt(4)
    v_mfma_f32_16x16x32_bf16 v[52:55], a[0:3], v[100:103], 0
    ds_read_b64_tr_b16 v[112:113], v9 offset:1024
    ds_read_b64_tr_b16 v[114:115], v9 offset:1536
    v_mfma_f32_16x16x32_bf16 v[56:59], a[4:7], v[100:103], 0
    v_mfma_f32_16x16x32_bf16 v[60:63], a[8:11], v[100:103], 0
    v_mfma_f32_16x16x32_bf16 v[120:123], v[116:119], v[100:103], 0
    v_mfma_f32_16x16x32_bf16 v[124:127], v[100:103], v[100:103], 0
    s_waitcnt lgkmcnt(4)
    v_mfma_f32_16x16x32_bf16 v[64:67], a[0:3], v[104:107], 0
    ds_read_b64_tr_b16 v[100:101], v8 offset:8192
    ds_read_b64_tr_b16 v[102:103], v8 offset:8704
    v_mfma_f32_16x16x32_bf16 v[68:71], a[4:7], v[104:107], 0
    v_mfma_f32_16x16x32_bf16 v[72:75], a[8:11], v[104:107], 0
    s_add_u32 s36, s40, 14336
    buffer_load_dwordx4 a[168:171], v31, s[28:31], s36 offen sc1
    s_add_u32 s36, s41, 14336
    buffer_load_dwordx4 a[172:175], v31, s[28:31], s36 offen sc1
    s_add_u32 s36, s42, 14336
    buffer_load_dwordx4 a[176:179], v31, s[28:31], s36 offen sc1
    s_waitcnt lgkmcnt(4)
    v_mfma_f32_16x16x32_bf16 v[52:55], a[12:15], v[108:111], v[52:55]
    ds_read_b64_tr_b16 v[104:105], v9 offset:8192
    ds_read_b64_tr_b16 v[106:107], v9 offset:8704
    v_mfma_f32_16x16x32_bf16 v[56:59], a[16:19], v[108:111], v[56:59]
    v_mfma_f32_16x16x32_bf16 v[60:63], a[20:23], v[108:111], v[60:63]
    v_mfma_f32_16x16x32_bf16 v[120:123], v[116:119], v[108:111], v[120:123]
    v_mfma_f32_16x16x32_bf16 v[124:127], v[108:111], v[108:111], v[124:127]
    s_waitcnt lgkmcnt(4)
    v_mfma_f32_16x16x32_bf16 v[64:67], a[12:15], v[112:115], v[64:67]
    ds_read_b64_tr_b16 v[108:109], v8 offset:9216
    ds_read_b64_tr_b16 v[110:111], v8 offset:9728
    v_mfma_f32_16x16x32_bf16 v[68:71], a[16:19], v[112:115], v[68:71]
    v_mfma_f32_16x16x32_bf16 v[72:75], a[20:23], v[112:115], v[72:75]
    s_add_u32 s36, s40, 15360
    buffer_load_dwordx4 a[180:183], v31, s[28:31], s36 offen sc1
    s_add_u32 s36, s41, 15360
    buffer_load_dwordx4 a[184:187], v31, s[28:31], s36 offen sc1
    s_add_u32 s36, s42, 15360
    buffer_load_dwordx4 a[188:191], v31, s[28:31], s36 offen sc1
    s_waitcnt lgkmcnt(4)
    v_mfma_f32_16x16x32_bf16 v[52:55], a[24:27], v[100:103], v[52:55]
    ds_read_b64_tr_b16 v[112:113], v9 offset:9216
    ds_read_b64_tr_b16 v[114:115], v9 offset:9728
    v_mfma_f32_16x16x32_bf16 v[56:59], a[28:31], v[100:103], v[56:59]
    v_mfma_f32_16x16x32_bf16 v[60:63], a[32:35], v[100:103], v[60:63]
    v_mfma_f32_16x16x32_bf16 v[120:123], v[116:119], v[100:103], v[120:123]
    v_mfma_f32_16x16x32_bf16 v[124:127], v[100:103], v[100:103], v[124:127]
    s_waitcnt lgkmcnt(4)
    v_mfma_f32_16x16x32_bf16 v[64:67], a[24:27], v[104:107], v[64:67]
    ds_read_b64_tr_b16 v[100:101], v8 offset:16384
    ds_read_b64_tr_b16 v[102:103], v8 offset:16896
    v_mfma_f32_16x16x32_bf16 v[68:71], a[28:31], v[104:107], v[68:71]
    v_mfma_f32_16x16x32_bf16 v[72:75], a[32:35], v[104:107], v[72:75]
    s_waitcnt lgkmcnt(4)
    v_mfma_f32_16x16x32_bf16 v[52:55], a[36:39], v[108:111], v[52:55]
    ds_read_b64_tr_b16 v[104:105], v9 offset:16384
    ds_read_b64_tr_b16 v[106:107], v9 offset:16896
    v_mfma_f32_16x16x32_bf16 v[56:59], a[40:43], v[108:111], v[56:59]
    v_mfma_f32_16x16x32_bf16 v[60:63], a[44:47], v[108:111], v[60:63]
    v_mfma_f32_16x16x32_bf16 v[120:123], v[116:119], v[108:111], v[120:123]
    v_mfma_f32_16x16x32_bf16 v[124:127], v[108:111], v[108:111], v[124:127]
    s_waitcnt lgkmcnt(4)
    v_mfma_f32_16x16x32_bf16 v[64:67], a[36:39], v[112:115], v[64:67]
    ds_read_b64_tr_b16 v[108:109], v8 offset:17408
    ds_read_b64_tr_b16 v[110:111], v8 offset:17920
    v_mfma_f32_16x16x32_bf16 v[68:71], a[40:43], v[112:115], v[68:71]
    v_mfma_f32_16x16x32_bf16 v[72:75], a[44:47], v[112:115], v[72:75]
    s_mul_i32 s56, s18, 34816
    s_lshl_b32 s57, s20, 8
    s_add_u32 s56, s56, s57
    s_add_u32 s56, s56, 7602304
    s_lshl_b32 s57, s18, 10
    s_add_u32 s57, s57, 65536
    s_add_u32 m0, s57, 0
    s_nop 0
    buffer_load_dwordx4 v27, s[28:31], s56 offen sc1 lds
    s_add_u32 s56, s56, 139264
    s_add_u32 m0, s57, 4096
    s_nop 0
    buffer_load_dwordx4 v27, s[28:31], s56 offen sc1 lds
    s_add_u32 s56, s56, 139264
    s_waitcnt lgkmcnt(4)
    v_mfma_f32_16x16x32_bf16 v[52:55], a[48:51], v[100:103], v[52:55]
    ds_read_b64_tr_b16 v[112:113], v9 offset:17408
    ds_read_b64_tr_b16 v[114:115], v9 offset:17920
    v_mfma_f32_16x16x32_bf16 v[56:59], a[52:55], v[100:103], v[56:59]
    v_mfma_f32_16x16x32_bf16 v[60:63], a[56:59], v[100:103], v[60:63]
    v_mfma_f32_16x16x32_bf16 v[120:123], v[116:119], v[100:103], v[120:123]
    v_mfma_f32_16x16x32_bf16 v[124:127], v[100:103], v[100:103], v[124:127]
    s_waitcnt lgkmcnt(4)
    v_mfma_f32_16x16x32_bf16 v[64:67], a[48:51], v[104:107], v[64:67]
    ds_read_b64_tr_b16 v[100:101], v8 offset:24576
    ds_read_b64_tr_b16 v[102:103], v8 offset:25088
    v_mfma_f32_16x16x32_bf16 v[68:71], a[52:55], v[104:107], v[68:71]
    v_mfma_f32_16x16x32_bf16 v[72:75], a[56:59], v[104:107], v[72:75]
    s_add_u32 m0, s57, 8192
    s_nop 0
    buffer_load_dwordx4 v27, s[28:31], s56 offen sc1 lds
    s_add_u32 s56, s56, 139264
    s_add_u32 m0, s57, 12288
    s_nop 0
    buffer_load_dwordx4 v27, s[28:31], s56 offen sc1 lds
    s_add_u32 s56, s56, 139264
    s_waitcnt lgkmcnt(4)
    v_mfma_f32_16x16x32_bf16 v[52:55], a[60:63], v[108:111], v[52:55]
    ds_read_b64_tr_b16 v[104:105], v9 offset:24576
    ds_read_b64_tr_b16 v[106:107], v9 offset:25088
    v_mfma_f32_16x16x32_bf16 v[56:59], a[64:67], v[108:111], v[56:59]
    v_mfma_f32_16x16x32_bf16 v[60:63], a[68:71], v[108:111], v[60:63]
    v_mfma_f32_16x16x32_bf16 v[120:123], v[116:119], v[108:111], v[120:123]
    v_mfma_f32_16x16x32_bf16 v[124:127], v[108:111], v[108:111], v[124:127]
    s_waitcnt lgkmcnt(4)
    v_mfma_f32_16x16x32_bf16 v[64:67], a[60:63], v[112:115], v[64:67]
    ds_read_b64_tr_b16 v[108:109], v8 offset:25600
    ds_read_b64_tr_b16 v[110:111], v8 offset:26112
    v_mfma_f32_16x16x32_bf16 v[68:71], a[64:67], v[112:115], v[68:71]
    v_mfma_f32_16x16x32_bf16 v[72:75], a[68:71], v[112:115], v[72:75]
    s_waitcnt vmcnt(13)
    s_barrier
    s_add_u32 m0, s57, 16384
    s_nop 0
    buffer_load_dwordx4 v27, s[28:31], s56 offen sc1 lds
    s_add_u32 s56, s56, 139264
    s_add_u32 m0, s57, 20480
    s_nop 0
    buffer_load_dwordx4 v27, s[28:31], s56 offen sc1 lds
    s_add_u32 s56, s56, 139264
    s_waitcnt lgkmcnt(4)
    v_mfma_f32_16x16x32_bf16 v[52:55], a[72:75], v[100:103], v[52:55]
    ds_read_b64_tr_b16 v[112:113], v9 offset:25600
    ds_read_b64_tr_b16 v[114:115], v9 offset:26112
    v_mfma_f32_16x16x32_bf16 v[56:59], a[76:79], v[100:103], v[56:59]
    v_mfma_f32_16x16x32_bf16 v[60:63], a[80:83], v[100:103], v[60:63]
    v_mfma_f32_16x16x32_bf16 v[120:123], v[116:119], v[100:103], v[120:123]
    v_mfma_f32_16x16x32_bf16 v[124:127], v[100:103], v[100:103], v[124:127]
    s_waitcnt lgkmcnt(4)
    v_mfma_f32_16x16x32_bf16 v[64:67], a[72:75], v[104:107], v[64:67]
    ds_read_b64_tr_b16 v[100:101], v8 offset:32768
    ds_read_b64_tr_b16 v[102:103], v8 offset:33280
    v_mfma_f32_16x16x32_bf16 v[68:71], a[76:79], v[104:107], v[68:71]
    v_mfma_f32_16x16x32_bf16 v[72:75], a[80:83], v[104:107], v[72:75]
    s_add_u32 m0, s57, 24576
    s_nop 0
    buffer_load_dwordx4 v27, s[28:31], s56 offen sc1 lds
    s_add_u32 s56, s56, 139264
    s_add_u32 m0, s57, 28672
    s_nop 0
    buffer_load_dwordx4 v27, s[28:31], s56 offen sc1 lds
    s_add_u32 s56, s56, 139264
    s_waitcnt lgkmcnt(4)
    v_mfma_f32_16x16x32_bf16 v[52:55], a[84:87], v[108:111], v[52:55]
    ds_read_b64_tr_b16 v[104:105], v9 offset:32768
    ds_read_b64_tr_b16 v[106:107], v9 offset:33280
    v_mfma_f32_16x16x32_bf16 v[56:59], a[88:91], v[108:111], v[56:59]
    v_mfma_f32_16x16x32_bf16 v[60:63], a[92:95], v[108:111], v[60:63]
    v_mfma_f32_16x16x32_bf16 v[120:123], v[116:119], v[108:111], v[120:123]
    v_mfma_f32_16x16x32_bf16 v[124:127], v[108:111], v[108:111], v[124:127]
    s_waitcnt lgkmcnt(4)
    v_mfma_f32_16x16x32_bf16 v[64:67], a[84:87], v[112:115], v[64:67]
    ds_read_b64_tr_b16 v[108:109], v8 offset:33792
    ds_read_b64_tr_b16 v[110:111], v8 offset:34304
    v_mfma_f32_16x16x32_bf16 v[68:71], a[88:91], v[112:115], v[68:71]
    v_mfma_f32_16x16x32_bf16 v[72:75], a[92:95], v[112:115], v[72:75]
    s_add_u32 m0, s57, 32768
    s_nop 0
    buffer_load_dwordx4 v27, s[28:31], s56 offen sc1 lds
    s_add_u32 s56, s56, 139264
    s_add_u32 m0, s57, 36864
    s_nop 0
    buffer_load_dwordx4 v27, s[28:31], s56 offen sc1 lds
    s_add_u32 s56, s56, 139264
    s_waitcnt lgkmcnt(4)
    v_mfma_f32_16x16x32_bf16 v[52:55], a[96:99], v[100:103], v[52:55]
    ds_read_b64_tr_b16 v[112:113], v9 offset:33792
    ds_read_b64_tr_b16 v[114:115], v9 offset:34304
    v_mfma_f32_16x16x32_bf16 v[56:59], a[100:103], v[100:103], v[56:59]
    v_mfma_f32_16x16x32_bf16 v[60:63], a[104:107], v[100:103], v[60:63]
    v_mfma_f32_16x16x32_bf16 v[120:123], v[116:119], v[100:103], v[120:123]
    v_mfma_f32_16x16x32_bf16 v[124:127], v[100:103], v[100:103], v[124:127]
    s_waitcnt lgkmcnt(4)
    v_mfma_f32_16x16x32_bf16 v[64:67], a[96:99], v[104:107], v[64:67]
    ds_read_b64_tr_b16 v[100:101], v8 offset:40960
    ds_read_b64_tr_b16 v[102:103], v8 offset:41472
    v_mfma_f32_16x16x32_bf16 v[68:71], a[100:103], v[104:107], v[68:71]
    v_mfma_f32_16x16x32_bf16 v[72:75], a[104:107], v[104:107], v[72:75]
    s_add_u32 m0, s57, 40960
    s_nop 0
    buffer_load_dwordx4 v27, s[28:31], s56 offen sc1 lds
    s_add_u32 s56, s56, 139264
    s_add_u32 m0, s57, 45056
    s_nop 0
    buffer_load_dwordx4 v27, s[28:31], s56 offen sc1 lds
    s_add_u32 s56, s56, 139264
    s_waitcnt lgkmcnt(4)
    v_mfma_f32_16x16x32_bf16 v[52:55], a[108:111], v[108:111], v[52:55]
    ds_read_b64_tr_b16 v[104:105], v9 offset:40960
    ds_read_b64_tr_b16 v[106:107], v9 offset:41472
    v_mfma_f32_16x16x32_bf16 v[56:59], a[112:115], v[108:111], v[56:59]
    v_mfma_f32_16x16x32_bf16 v[60:63], a[116:119], v[108:111], v[60:63]
    v_mfma_f32_16x16x32_bf16 v[120:123], v[116:119], v[108:111], v[120:123]
    v_mfma_f32_16x16x32_bf16 v[124:127], v[108:111], v[108:111], v[124:127]
    s_waitcnt lgkmcnt(4)
    v_mfma_f32_16x16x32_bf16 v[64:67], a[108:111], v[112:115], v[64:67]
    ds_read_b64_tr_b16 v[108:109], v8 offset:41984
    ds_read_b64_tr_b16 v[110:111], v8 offset:42496
    v_mfma_f32_16x16x32_bf16 v[68:71], a[112:115], v[112:115], v[68:71]
    v_mfma_f32_16x16x32_bf16 v[72:75], a[116:119], v[112:115], v[72:75]
    s_add_u32 m0, s57, 49152
    s_nop 0
    buffer_load_dwordx4 v27, s[28:31], s56 offen sc1 lds
    s_add_u32 s56, s56, 139264
    s_add_u32 m0, s57, 53248
    s_nop 0
    buffer_load_dwordx4 v27, s[28:31], s56 offen sc1 lds
    s_add_u32 s56, s56, 139264
    s_waitcnt lgkmcnt(4)
    v_mfma_f32_16x16x32_bf16 v[52:55], a[120:123], v[100:103], v[52:55]
    ds_read_b64_tr_b16 v[112:113], v9 offset:41984
    ds_read_b64_tr_b16 v[114:115], v9 offset:42496
    v_mfma_f32_16x16x32_bf16 v[56:59], a[124:127], v[100:103], v[56:59]
    v_mfma_f32_16x16x32_bf16 v[60:63], a[128:131], v[100:103], v[60:63]
    v_mfma_f32_16x16x32_bf16 v[120:123], v[116:119], v[100:103], v[120:123]
    v_mfma_f32_16x16x32_bf16 v[124:127], v[100:103], v[100:103], v[124:127]
    s_waitcnt lgkmcnt(4)
    v_mfma_f32_16x16x32_bf16 v[64:67], a[120:123], v[104:107], v[64:67]
    ds_read_b64_tr_b16 v[100:101], v8 offset:49152
    ds_read_b64_tr_b16 v[102:103], v8 offset:49664
    v_mfma_f32_16x16x32_bf16 v[68:71], a[124:127], v[104:107], v[68:71]
    v_mfma_f32_16x16x32_bf16 v[72:75], a[128:131], v[104:107], v[72:75]
    s_add_u32 m0, s57, 57344
    s_nop 0
    buffer_load_dwordx4 v27, s[28:31], s56 offen sc1 lds
    s_add_u32 s56, s56, 139264
    s_add_u32 m0, s57, 61440
    s_nop 0
    buffer_load_dwordx4 v27, s[28:31], s56 offen sc1 lds
    s_add_u32 s56, s56, 139264
    s_waitcnt lgkmcnt(4)
    v_mfma_f32_16x16x32_bf16 v[52:55], a[132:135], v[108:111], v[52:55]
    ds_read_b64_tr_b16 v[104:105], v9 offset:49152
    ds_read_b64_tr_b16 v[106:107], v9 offset:49664
    v_mfma_f32_16x16x32_bf16 v[56:59], a[136:139], v[108:111], v[56:59]
    v_mfma_f32_16x16x32_bf16 v[60:63], a[140:143], v[108:111], v[60:63]
    v_mfma_f32_16x16x32_bf16 v[120:123], v[116:119], v[108:111], v[120:123]
    v_mfma_f32_16x16x32_bf16 v[124:127], v[108:111], v[108:111], v[124:127]
    s_waitcnt lgkmcnt(4)
    v_mfma_f32_16x16x32_bf16 v[64:67], a[132:135], v[112:115], v[64:67]
    ds_read_b64_tr_b16 v[108:109], v8 offset:50176
    ds_read_b64_tr_b16 v[110:111], v8 offset:50688
    v_mfma_f32_16x16x32_bf16 v[68:71], a[136:139], v[112:115], v[68:71]
    v_mfma_f32_16x16x32_bf16 v[72:75], a[140:143], v[112:115], v[72:75]
    s_waitcnt lgkmcnt(4)
    v_mfma_f32_16x16x32_bf16 v[52:55], a[144:147], v[100:103], v[52:55]
    ds_read_b64_tr_b16 v[112:113], v9 offset:50176
    ds_read_b64_tr_b16 v[114:115], v9 offset:50688
    v_mfma_f32_16x16x32_bf16 v[56:59], a[148:151], v[100:103], v[56:59]
    v_mfma_f32_16x16x32_bf16 v[60:63], a[152:155], v[100:103], v[60:63]
    v_mfma_f32_16x16x32_bf16 v[120:123], v[116:119], v[100:103], v[120:123]
    v_mfma_f32_16x16x32_bf16 v[124:127], v[100:103], v[100:103], v[124:127]
    s_waitcnt lgkmcnt(4)
    v_mfma_f32_16x16x32_bf16 v[64:67], a[144:147], v[104:107], v[64:67]
    ds_read_b64_tr_b16 v[100:101], v8 offset:57344
    ds_read_b64_tr_b16 v[102:103], v8 offset:57856
    v_mfma_f32_16x16x32_bf16 v[68:71], a[148:151], v[104:107], v[68:71]
    v_mfma_f32_16x16x32_bf16 v[72:75], a[152:155], v[104:107], v[72:75]
    s_waitcnt vmcnt(22)
    s_waitcnt lgkmcnt(4)
    v_mfma_f32_16x16x32_bf16 v[52:55], a[156:159], v[108:111], v[52:55]
    ds_read_b64_tr_b16 v[104:105], v9 offset:57344
    ds_read_b64_tr_b16 v[106:107], v9 offset:57856
    v_mfma_f32_16x16x32_bf16 v[56:59], a[160:163], v[108:111], v[56:59]
    v_mfma_f32_16x16x32_bf16 v[60:63], a[164:167], v[108:111], v[60:63]
    v_mfma_f32_16x16x32_bf16 v[120:123], v[116:119], v[108:111], v[120:123]
    v_mfma_f32_16x16x32_bf16 v[124:127], v[108:111], v[108:111], v[124:127]
    s_waitcnt lgkmcnt(4)
    v_mfma_f32_16x16x32_bf16 v[64:67], a[156:159], v[112:115], v[64:67]
    ds_read_b64_tr_b16 v[108:109], v8 offset:58368
    ds_read_b64_tr_b16 v[110:111], v8 offset:58880
    v_mfma_f32_16x16x32_bf16 v[68:71], a[160:163], v[112:115], v[68:71]
    v_mfma_f32_16x16x32_bf16 v[72:75], a[164:167], v[112:115], v[72:75]
    v_mfma_f32_16x16x32_bf16 v[32:35], a[156:159], v[116:119], v[32:35]
    v_mfma_f32_16x16x32_bf16 v[36:39], a[160:163], v[116:119], v[36:39]
    v_mfma_f32_16x16x32_bf16 v[40:43], a[164:167], v[116:119], v[40:43]
    s_waitcnt vmcnt(19)
    s_waitcnt lgkmcnt(4)
    v_mfma_f32_16x16x32_bf16 v[52:55], a[168:171], v[100:103], v[52:55]
    ds_read_b64_tr_b16 v[112:113], v9 offset:58368
    ds_read_b64_tr_b16 v[114:115], v9 offset:58880
    v_mfma_f32_16x16x32_bf16 v[56:59], a[172:175], v[100:103], v[56:59]
    v_mfma_f32_16x16x32_bf16 v[60:63], a[176:179], v[100:103], v[60:63]
    v_mfma_f32_16x16x32_bf16 v[120:123], v[116:119], v[100:103], v[120:123]
    v_mfma_f32_16x16x32_bf16 v[124:127], v[100:103], v[100:103], v[124:127]
    s_waitcnt lgkmcnt(4)
    v_mfma_f32_16x16x32_bf16 v[64:67], a[168:171], v[104:107], v[64:67]
    ds_read_b64_tr_b16 v[100:101], v10 offset:0
    ds_read_b64_tr_b16 v[102:103], v10 offset:512
    v_mfma_f32_16x16x32_bf16 v[68:71], a[172:175], v[104:107], v[68:71]
    v_mfma_f32_16x16x32_bf16 v[72:75], a[176:179], v[104:107], v[72:75]
    v_mfma_f32_16x16x32_bf16 v[32:35], a[168:171], v[116:119], v[32:35]
    v_mfma_f32_16x16x32_bf16 v[36:39], a[172:175], v[116:119], v[36:39]
    v_mfma_f32_16x16x32_bf16 v[40:43], a[176:179], v[116:119], v[40:43]
    s_waitcnt vmcnt(16)
    s_waitcnt lgkmcnt(4)
    v_mfma_f32_16x16x32_bf16 v[52:55], a[180:183], v[108:111], v[52:55]
    ds_read_b64_tr_b16 v[104:105], v11 offset:0
    ds_read_b64_tr_b16 v[106:107], v11 offset:512
    v_mfma_f32_16x16x32_bf16 v[56:59], a[184:187], v[108:111], v[56:59]
    v_mfma_f32_16x16x32_bf16 v[60:63], a[188:191], v[108:111], v[60:63]
    v_mfma_f32_16x16x32_bf16 v[120:123], v[116:119], v[108:111], v[120:123]
    v_mfma_f32_16x16x32_bf16 v[124:127], v[108:111], v[108:111], v[124:127]
    s_waitcnt lgkmcnt(4)
    v_mfma_f32_16x16x32_bf16 v[64:67], a[180:183], v[112:115], v[64:67]
    ds_read_b64_tr_b16 v[108:109], v10 offset:1024
    ds_read_b64_tr_b16 v[110:111], v10 offset:1536
    v_mfma_f32_16x16x32_bf16 v[68:71], a[184:187], v[112:115], v[68:71]
    v_mfma_f32_16x16x32_bf16 v[72:75], a[188:191], v[112:115], v[72:75]
    v_mfma_f32_16x16x32_bf16 v[32:35], a[180:183], v[116:119], v[32:35]
    v_mfma_f32_16x16x32_bf16 v[36:39], a[184:187], v[116:119], v[36:39]
    v_mfma_f32_16x16x32_bf16 v[40:43], a[188:191], v[116:119], v[40:43]
    v_and_b32 v4, 3, v2
    v_cmp_eq_u32 vcc, 1, v4
    s_nop 1
    v_cndmask_b32 v29, v124, v125, vcc
    v_cmp_eq_u32 vcc, 2, v4
    s_nop 1
    v_cndmask_b32 v29, v29, v126, vcc
    v_cmp_eq_u32 vcc, 3, v4
    s_nop 1
    v_cndmask_b32 v29, v29, v127, vcc
    v_mov_b32 v28, v120
    v_mul_f32 v28, 0x3b000000, v28
    v_mul_f32 v29, 0x3b000000, v29
    v_fma_f32 v29, -v28, v28, v29
    v_max_f32 v29, 0, v29
    v_cvt_pk_bf16_f32 v29, v29, v29
    v_and_b32 v29, 0xffff0000, v29
    v_add_f32 v29, 0x3727c5ac, v29
    v_cvt_pk_bf16_f32 v29, v29, v29
    v_and_b32 v29, 0xffff0000, v29
    v_sqrt_f32 v29, v29
    s_nop 0
    v_cvt_pk_bf16_f32 v29, v29, v29
    v_and_b32 v29, 0xffff0000, v29
    v_cvt_pk_bf16_f32 v28, v28, v28
    v_and_b32 v28, 0xffff0000, v28
    v_rcp_f32 v5, v29
    v_mul_f32 v121, v29, v29
    v_sub_f32 v122, 0, v28
    v_mul_f32 v120, 0xbfb8aa3b, v5
    v_mov_b32 v123, 0
    s_lshl_b32 s36, s18, 8
    s_add_u32 s36, s36, 147456
    v_lshl_add_u32 v6, v2, 4, s36
    v_lshrrev_b32 v4, 2, v2
    v_cmp_eq_u32 vcc, v4, v3
    s_nop 1
    s_and_saveexec_b64 s[38:39], vcc
    ds_write_b128 v6, v[120:123]
    s_mov_b64 exec, s[38:39]
    s_waitcnt lgkmcnt(0)
    s_barrier
    v_lshrrev_b32 v2, 3, v1
    v_and_b32 v3, 7, v1
    v_mul_u32_u24 v2, 4352, v2
    v_lshl_add_u32 v2, v3, 4, v2
    s_mul_i32 s36, s23, 278528
    s_mul_i32 s37, s18, 69632
    s_add_u32 s36, s36, s37
    s_lshl_b32 s37, s20, 8
    s_add_u32 s36, s36, s37
    s_lshl_b32 s37, s22, 7
    s_add_u32 s36, s36, s37
    s_lshl_b32 s38, s18, 11
    s_add_u32 s37, s36, 7602176
    s_add_u32 m0, s38, 131072
    s_nop 0
    buffer_load_dwordx4 v2, s[28:31], s37 offen sc1 lds
    s_add_u32 s37, s36, 7636992
    s_add_u32 m0, s38, 132096
    s_nop 0
    buffer_load_dwordx4 v2, s[28:31], s37 offen sc1 lds
    s_add_u32 s37, s36, 5242880
    s_add_u32 m0, s38, 139264
    s_nop 0
    buffer_load_dwordx4 v2, s[28:31], s37 offen sc1 lds
    s_add_u32 s37, s36, 5277696
    s_add_u32 m0, s38, 140288
    s_nop 0
    buffer_load_dwordx4 v2, s[28:31], s37 offen sc1 lds
    v_and_b32 v2, 15, v1
    v_lshrrev_b32 v3, 4, v1
    s_waitcnt lgkmcnt(4)
    v_mfma_f32_16x16x32_bf16 v[76:79], a[0:3], v[100:103], 0
    ds_read_b64_tr_b16 v[112:113], v11 offset:1024
    ds_read_b64_tr_b16 v[114:115], v11 offset:1536
    v_add_u32 v8, 0x10000, v8
    v_add_u32 v9, 0x10000, v9
    v_mfma_f32_16x16x32_bf16 v[80:83], a[4:7], v[100:103], 0
    ds_read_b32 v22, v15 offset:8
    ds_read_b32 v24, v16 offset:8
    v_mfma_f32_16x16x32_bf16 v[84:87], a[8:11], v[100:103], 0
    ds_read_b64 v[26:27], v19 offset:0
    s_waitcnt lgkmcnt(4)
    v_mfma_f32_16x16x32_bf16 v[88:91], a[0:3], v[104:107], 0
    ds_read_b64_tr_b16 v[100:101], v10 offset:8192
    ds_read_b64_tr_b16 v[102:103], v10 offset:8704
    v_mfma_f32_16x16x32_bf16 v[92:95], a[4:7], v[104:107], 0
    v_mfma_f32_16x16x32_bf16 v[96:99], a[8:11], v[104:107], 0
    s_waitcnt lgkmcnt(4)
    v_mfma_f32_16x16x32_bf16 v[76:79], a[12:15], v[108:111], v[76:79]
    ds_read_b64_tr_b16 v[104:105], v11 offset:8192
    ds_read_b64_tr_b16 v[106:107], v11 offset:8704
    v_mfma_f32_16x16x32_bf16 v[80:83], a[16:19], v[108:111], v[80:83]
    v_mfma_f32_16x16x32_bf16 v[84:87], a[20:23], v[108:111], v[84:87]
    v_fma_f32 v52, v32, v22, v52
    v_fma_f32 v53, v33, v22, v53
    s_waitcnt lgkmcnt(4)
    v_mfma_f32_16x16x32_bf16 v[88:91], a[12:15], v[112:115], v[88:91]
    ds_read_b64_tr_b16 v[108:109], v10 offset:9216
    ds_read_b64_tr_b16 v[110:111], v10 offset:9728
    v_fma_f32 v54, v34, v22, v54
    v_mfma_f32_16x16x32_bf16 v[92:95], a[16:19], v[112:115], v[92:95]
    v_fma_f32 v55, v35, v22, v55
    v_fma_f32 v64, v32, v24, v64
    v_mfma_f32_16x16x32_bf16 v[96:99], a[20:23], v[112:115], v[96:99]
    v_fma_f32 v65, v33, v24, v65
    v_fma_f32 v66, v34, v24, v66
    s_add_u32 s36, s48, 0
    buffer_load_dwordx4 a[192:195], v31, s[28:31], s36 offen sc1
    s_waitcnt lgkmcnt(4)
    v_mfma_f32_16x16x32_bf16 v[76:79], a[24:27], v[100:103], v[76:79]
    ds_read_b64_tr_b16 v[112:113], v11 offset:9216
    ds_read_b64_tr_b16 v[114:115], v11 offset:9728
    v_fma_f32 v67, v35, v24, v67
    v_fma_f32 v56, v36, v22, v56
    v_mfma_f32_16x16x32_bf16 v[80:83], a[28:31], v[100:103], v[80:83]
    v_fma_f32 v57, v37, v22, v57
    v_fma_f32 v58, v38, v22, v58
    v_mfma_f32_16x16x32_bf16 v[84:87], a[32:35], v[100:103], v[84:87]
    v_fma_f32 v59, v39, v22, v59
    v_fma_f32 v68, v36, v24, v68
    s_waitcnt lgkmcnt(4)
    v_mfma_f32_16x16x32_bf16 v[88:91], a[24:27], v[104:107], v[88:91]
    ds_read_b64_tr_b16 v[100:101], v10 offset:16384
    ds_read_b64_tr_b16 v[102:103], v10 offset:16896
    v_fma_f32 v69, v37, v24, v69
    v_mfma_f32_16x16x32_bf16 v[92:95], a[28:31], v[104:107], v[92:95]
    v_fma_f32 v70, v38, v24, v70
    v_fma_f32 v71, v39, v24, v71
    v_mfma_f32_16x16x32_bf16 v[96:99], a[32:35], v[104:107], v[96:99]
    v_fma_f32 v60, v40, v22, v60
    v_fma_f32 v61, v41, v22, v61
    s_add_u32 s36, s48, 1024
    buffer_load_dwordx4 a[196:199], v31, s[28:31], s36 offen sc1
    s_waitcnt lgkmcnt(4)
    v_mfma_f32_16x16x32_bf16 v[76:79], a[36:39], v[108:111], v[76:79]
    ds_read_b64_tr_b16 v[104:105], v11 offset:16384
    ds_read_b64_tr_b16 v[106:107], v11 offset:16896
    v_fma_f32 v62, v42, v22, v62
    v_fma_f32 v63, v43, v22, v63
    v_mfma_f32_16x16x32_bf16 v[80:83], a[40:43], v[108:111], v[80:83]
    v_fma_f32 v72, v40, v24, v72
    v_fma_f32 v73, v41, v24, v73
    v_mfma_f32_16x16x32_bf16 v[84:87], a[44:47], v[108:111], v[84:87]
    v_fma_f32 v74, v42, v24, v74
    v_fma_f32 v75, v43, v24, v75
    s_waitcnt lgkmcnt(4)
    v_mfma_f32_16x16x32_bf16 v[88:91], a[36:39], v[112:115], v[88:91]
    ds_read_b64_tr_b16 v[108:109], v10 offset:17408
    ds_read_b64_tr_b16 v[110:111], v10 offset:17920
    v_mfma_f32_16x16x32_bf16 v[92:95], a[40:43], v[112:115], v[92:95]
    v_permlane32_swap_b32 v52, v64
    v_mfma_f32_16x16x32_bf16 v[96:99], a[44:47], v[112:115], v[96:99]
    v_permlane32_swap_b32 v53, v65
    s_add_u32 s36, s48, 2048
    buffer_load_dwordx4 a[200:203], v31, s[28:31], s36 offen sc1
    s_waitcnt lgkmcnt(4)
    v_mfma_f32_16x16x32_bf16 v[76:79], a[48:51], v[100:103], v[76:79]
    ds_read_b64_tr_b16 v[112:113], v11 offset:17408
    ds_read_b64_tr_b16 v[114:115], v11 offset:17920
    v_permlane32_swap_b32 v54, v66
    v_mfma_f32_16x16x32_bf16 v[80:83], a[52:55], v[100:103], v[80:83]
    v_permlane32_swap_b32 v55, v67
    v_mfma_f32_16x16x32_bf16 v[84:87], a[56:59], v[100:103], v[84:87]
    v_permlane32_swap_b32 v56, v68
    s_waitcnt lgkmcnt(4)
    v_mfma_f32_16x16x32_bf16 v[88:91], a[48:51], v[104:107], v[88:91]
    ds_read_b64_tr_b16 v[100:101], v10 offset:24576
    ds_read_b64_tr_b16 v[102:103], v10 offset:25088
    v_permlane32_swap_b32 v57, v69
    v_mfma_f32_16x16x32_bf16 v[92:95], a[52:55], v[104:107], v[92:95]
    v_permlane32_swap_b32 v58, v70
    v_mfma_f32_16x16x32_bf16 v[96:99], a[56:59], v[104:107], v[96:99]
    v_permlane32_swap_b32 v59, v71
    s_add_u32 s36, s48, 3072
    buffer_load_dwordx4 a[204:207], v31, s[28:31], s36 offen sc1
    s_waitcnt lgkmcnt(4)
    v_mfma_f32_16x16x32_bf16 v[76:79], a[60:63], v[108:111], v[76:79]
    ds_read_b64_tr_b16 v[104:105], v11 offset:24576
    ds_read_b64_tr_b16 v[106:107], v11 offset:25088
    v_permlane32_swap_b32 v60, v72
    v_mfma_f32_16x16x32_bf16 v[80:83], a[64:67], v[108:111], v[80:83]
    v_permlane32_swap_b32 v61, v73
    v_mfma_f32_16x16x32_bf16 v[84:87], a[68:71], v[108:111], v[84:87]
    v_permlane32_swap_b32 v62, v74
    s_waitcnt lgkmcnt(4)
    v_mfma_f32_16x16x32_bf16 v[88:91], a[60:63], v[112:115], v[88:91]
    ds_read_b64_tr_b16 v[108:109], v10 offset:25600
    ds_read_b64_tr_b16 v[110:111], v10 offset:26112
    v_mfma_f32_16x16x32_bf16 v[92:95], a[64:67], v[112:115], v[92:95]
    v_permlane32_swap_b32 v63, v75
    v_mul_f32 v128, v52, v26
    v_mfma_f32_16x16x32_bf16 v[96:99], a[68:71], v[112:115], v[96:99]
    v_mul_f32 v129, v53, v26
    v_mul_f32 v130, v54, v26
    s_add_u32 s36, s48, 4096
    buffer_load_dwordx4 a[208:211], v31, s[28:31], s36 offen sc1
    s_waitcnt lgkmcnt(4)
    v_mfma_f32_16x16x32_bf16 v[76:79], a[72:75], v[100:103], v[76:79]
    ds_read_b64_tr_b16 v[112:113], v11 offset:25600
    ds_read_b64_tr_b16 v[114:115], v11 offset:26112
    v_mul_f32 v131, v55, v26
    v_mul_f32 v132, v56, v26
    v_mfma_f32_16x16x32_bf16 v[80:83], a[76:79], v[100:103], v[80:83]
    v_mul_f32 v133, v57, v26
    v_mul_f32 v134, v58, v26
    v_mfma_f32_16x16x32_bf16 v[84:87], a[80:83], v[100:103], v[84:87]
    v_mul_f32 v135, v59, v26
    v_mul_f32 v136, v60, v26
    s_waitcnt lgkmcnt(4)
    v_mfma_f32_16x16x32_bf16 v[88:91], a[72:75], v[104:107], v[88:91]
    ds_read_b64_tr_b16 v[100:101], v10 offset:32768
    ds_read_b64_tr_b16 v[102:103], v10 offset:33280
    v_mul_f32 v137, v61, v26
    v_mfma_f32_16x16x32_bf16 v[92:95], a[76:79], v[104:107], v[92:95]
    v_mul_f32 v138, v62, v26
    v_mul_f32 v139, v63, v26
    v_mfma_f32_16x16x32_bf16 v[96:99], a[80:83], v[104:107], v[96:99]
    v_exp_f32 v128, v128
    s_add_u32 s36, s48, 5120
    buffer_load_dwordx4 a[212:215], v31, s[28:31], s36 offen sc1
    s_waitcnt lgkmcnt(4)
    v_mfma_f32_16x16x32_bf16 v[76:79], a[84:87], v[108:111], v[76:79]
    ds_read_b64_tr_b16 v[104:105], v11 offset:32768
    ds_read_b64_tr_b16 v[106:107], v11 offset:33280
    v_exp_f32 v129, v129
    v_mfma_f32_16x16x32_bf16 v[80:83], a[88:91], v[108:111], v[80:83]
    v_exp_f32 v130, v130
    v_mfma_f32_16x16x32_bf16 v[84:87], a[92:95], v[108:111], v[84:87]
    v_exp_f32 v131, v131
    s_waitcnt lgkmcnt(4)
    v_mfma_f32_16x16x32_bf16 v[88:91], a[84:87], v[112:115], v[88:91]
    ds_read_b64_tr_b16 v[108:109], v10 offset:33792
    ds_read_b64_tr_b16 v[110:111], v10 offset:34304
    v_mul_f32 v52, v52, v64
    v_mfma_f32_16x16x32_bf16 v[92:95], a[88:91], v[112:115], v[92:95]
    v_mul_f32 v53, v53, v65
    v_mul_f32 v54, v54, v66
    v_mfma_f32_16x16x32_bf16 v[96:99], a[92:95], v[112:115], v[96:99]
    v_mul_f32 v55, v55, v67
    s_add_u32 s36, s48, 6144
    buffer_load_dwordx4 a[216:219], v31, s[28:31], s36 offen sc1
    s_waitcnt lgkmcnt(4)
    v_mfma_f32_16x16x32_bf16 v[76:79], a[96:99], v[100:103], v[76:79]
    ds_read_b64_tr_b16 v[112:113], v11 offset:33792
    ds_read_b64_tr_b16 v[114:115], v11 offset:34304
    v_exp_f32 v132, v132
    v_mfma_f32_16x16x32_bf16 v[80:83], a[100:103], v[100:103], v[80:83]
    v_exp_f32 v133, v133
    v_mfma_f32_16x16x32_bf16 v[84:87], a[104:107], v[100:103], v[84:87]
    v_exp_f32 v134, v134
    s_waitcnt lgkmcnt(4)
    v_mfma_f32_16x16x32_bf16 v[88:91], a[96:99], v[104:107], v[88:91]
    ds_read_b64_tr_b16 v[100:101], v10 offset:40960
    ds_read_b64_tr_b16 v[102:103], v10 offset:41472
    v_exp_f32 v135, v135
    v_mul_f32 v56, v56, v68
    v_mfma_f32_16x16x32_bf16 v[92:95], a[100:103], v[104:107], v[92:95]
    v_mul_f32 v57, v57, v69
    v_mfma_f32_16x16x32_bf16 v[96:99], a[104:107], v[104:107], v[96:99]
    v_mul_f32 v58, v58, v70
    v_mul_f32 v59, v59, v71
    s_add_u32 s36, s48, 7168
    buffer_load_dwordx4 a[220:223], v31, s[28:31], s36 offen sc1
    s_waitcnt lgkmcnt(4)
    v_mfma_f32_16x16x32_bf16 v[76:79], a[108:111], v[108:111], v[76:79]
    ds_read_b64_tr_b16 v[104:105], v11 offset:40960
    ds_read_b64_tr_b16 v[106:107], v11 offset:41472
    v_exp_f32 v136, v136
    v_mfma_f32_16x16x32_bf16 v[80:83], a[112:115], v[108:111], v[80:83]
    v_exp_f32 v137, v137
    v_mfma_f32_16x16x32_bf16 v[84:87], a[116:119], v[108:111], v[84:87]
    v_exp_f32 v138, v138
    s_waitcnt lgkmcnt(4)
    v_mfma_f32_16x16x32_bf16 v[88:91], a[108:111], v[112:115], v[88:91]
    ds_read_b64_tr_b16 v[108:109], v10 offset:41984
    ds_read_b64_tr_b16 v[110:111], v10 offset:42496
    v_exp_f32 v139, v139
    v_mfma_f32_16x16x32_bf16 v[92:95], a[112:115], v[112:115], v[92:95]
    v_mul_f32 v60, v60, v72
    v_mfma_f32_16x16x32_bf16 v[96:99], a[116:119], v[112:115], v[96:99]
    v_mul_f32 v61, v61, v73
    v_mul_f32 v62, v62, v74
    s_add_u32 s36, s48, 8192
    buffer_load_dwordx4 a[224:227], v31, s[28:31], s36 offen sc1
    s_waitcnt lgkmcnt(4)
    v_mfma_f32_16x16x32_bf16 v[76:79], a[120:123], v[100:103], v[76:79]
    ds_read_b64_tr_b16 v[112:113], v11 offset:41984
    ds_read_b64_tr_b16 v[114:115], v11 offset:42496
    v_mul_f32 v63, v63, v75
    v_fma_f32 v128, v128, v27, v27
    v_mfma_f32_16x16x32_bf16 v[80:83], a[124:127], v[100:103], v[80:83]
    v_fma_f32 v129, v129, v27, v27
    v_fma_f32 v130, v130, v27, v27
    v_mfma_f32_16x16x32_bf16 v[84:87], a[128:131], v[100:103], v[84:87]
    v_fma_f32 v131, v131, v27, v27
    v_fma_f32 v132, v132, v27, v27
    s_waitcnt lgkmcnt(4)
    v_mfma_f32_16x16x32_bf16 v[88:91], a[120:123], v[104:107], v[88:91]
    ds_read_b64_tr_b16 v[100:101], v10 offset:49152
    ds_read_b64_tr_b16 v[102:103], v10 offset:49664
    v_fma_f32 v133, v133, v27, v27
    v_fma_f32 v134, v134, v27, v27
    v_mfma_f32_16x16x32_bf16 v[92:95], a[124:127], v[104:107], v[92:95]
    v_fma_f32 v135, v135, v27, v27
    v_mfma_f32_16x16x32_bf16 v[96:99], a[128:131], v[104:107], v[96:99]
    v_fma_f32 v136, v136, v27, v27
    v_fma_f32 v137, v137, v27, v27
    s_add_u32 s36, s48, 9216
    buffer_load_dwordx4 a[228:231], v31, s[28:31], s36 offen sc1
    s_waitcnt lgkmcnt(4)
    v_mfma_f32_16x16x32_bf16 v[76:79], a[132:135], v[108:111], v[76:79]
    ds_read_b64_tr_b16 v[104:105], v11 offset:49152
    ds_read_b64_tr_b16 v[106:107], v11 offset:49664
    v_fma_f32 v138, v138, v27, v27
    v_fma_f32 v139, v139, v27, v27
    v_mfma_f32_16x16x32_bf16 v[80:83], a[136:139], v[108:111], v[80:83]
    v_rcp_f32 v128, v128
    v_mfma_f32_16x16x32_bf16 v[84:87], a[140:143], v[108:111], v[84:87]
    v_rcp_f32 v129, v129
    s_waitcnt lgkmcnt(4)
    v_mfma_f32_16x16x32_bf16 v[88:91], a[132:135], v[112:115], v[88:91]
    ds_read_b64_tr_b16 v[108:109], v10 offset:50176
    ds_read_b64_tr_b16 v[110:111], v10 offset:50688
    v_rcp_f32 v130, v130
    v_mfma_f32_16x16x32_bf16 v[92:95], a[136:139], v[112:115], v[92:95]
    v_mfma_f32_16x16x32_bf16 v[96:99], a[140:143], v[112:115], v[96:99]
    v_rcp_f32 v131, v131
    s_add_u32 s36, s48, 10240
    buffer_load_dwordx4 a[232:235], v31, s[28:31], s36 offen sc1
    s_waitcnt lgkmcnt(4)
    v_mfma_f32_16x16x32_bf16 v[76:79], a[144:147], v[100:103], v[76:79]
    ds_read_b64_tr_b16 v[112:113], v11 offset:50176
    ds_read_b64_tr_b16 v[114:115], v11 offset:50688
    v_rcp_f32 v132, v132
    v_mfma_f32_16x16x32_bf16 v[80:83], a[148:151], v[100:103], v[80:83]
    v_rcp_f32 v133, v133
    v_mfma_f32_16x16x32_bf16 v[84:87], a[152:155], v[100:103], v[84:87]
    v_rcp_f32 v134, v134
    s_waitcnt lgkmcnt(4)
    v_mfma_f32_16x16x32_bf16 v[88:91], a[144:147], v[104:107], v[88:91]
    ds_read_b64_tr_b16 v[100:101], v10 offset:57344
    ds_read_b64_tr_b16 v[102:103], v10 offset:57856
    v_rcp_f32 v135, v135
    v_mfma_f32_16x16x32_bf16 v[92:95], a[148:151], v[104:107], v[92:95]
    v_rcp_f32 v136, v136
    v_mfma_f32_16x16x32_bf16 v[96:99], a[152:155], v[104:107], v[96:99]
    v_rcp_f32 v137, v137
    s_waitcnt vmcnt(15)
    s_barrier
    s_add_u32 s36, s48, 11264
    buffer_load_dwordx4 a[236:239], v31, s[28:31], s36 offen sc1
    s_waitcnt lgkmcnt(4)
    v_mfma_f32_16x16x32_bf16 v[76:79], a[156:159], v[108:111], v[76:79]
    ds_read_b64_tr_b16 v[104:105], v11 offset:57344
    ds_read_b64_tr_b16 v[106:107], v11 offset:57856
    v_rcp_f32 v138, v138
    v_mfma_f32_16x16x32_bf16 v[80:83], a[160:163], v[108:111], v[80:83]
    v_rcp_f32 v139, v139
    v_mfma_f32_16x16x32_bf16 v[84:87], a[164:167], v[108:111], v[84:87]
    v_mul_f32 v52, v52, v128
    v_mul_f32 v53, v53, v129
    s_waitcnt lgkmcnt(4)
    v_mfma_f32_16x16x32_bf16 v[88:91], a[156:159], v[112:115], v[88:91]
    ds_read_b64_tr_b16 v[108:109], v10 offset:58368
    ds_read_b64_tr_b16 v[110:111], v10 offset:58880
    v_mul_f32 v54, v54, v130
    v_mul_f32 v55, v55, v131
    v_mfma_f32_16x16x32_bf16 v[92:95], a[160:163], v[112:115], v[92:95]
    v_mul_f32 v56, v56, v132
    v_mfma_f32_16x16x32_bf16 v[96:99], a[164:167], v[112:115], v[96:99]
    v_mul_f32 v57, v57, v133
    v_mul_f32 v58, v58, v134
    s_add_u32 s36, s48, 12288
    buffer_load_dwordx4 a[240:243], v31, s[28:31], s36 offen sc1
    s_waitcnt lgkmcnt(4)
    v_mfma_f32_16x16x32_bf16 v[76:79], a[168:171], v[100:103], v[76:79]
    ds_read_b64_tr_b16 v[112:113], v11 offset:58368
    ds_read_b64_tr_b16 v[114:115], v11 offset:58880
    v_mul_f32 v59, v59, v135
    v_mul_f32 v60, v60, v136
    v_mfma_f32_16x16x32_bf16 v[80:83], a[172:175], v[100:103], v[80:83]
    v_mul_f32 v61, v61, v137
    v_mul_f32 v62, v62, v138
    v_mfma_f32_16x16x32_bf16 v[84:87], a[176:179], v[100:103], v[84:87]
    v_mul_f32 v63, v63, v139
    v_cvt_pk_bf16_f32 v64, v52, v53
    s_waitcnt lgkmcnt(4)
    v_mfma_f32_16x16x32_bf16 v[88:91], a[168:171], v[104:107], v[88:91]
    ds_read_b64_tr_b16 v[100:101], v8 offset:0
    ds_read_b64_tr_b16 v[102:103], v8 offset:512
    v_cvt_pk_bf16_f32 v65, v54, v55
    v_cvt_pk_bf16_f32 v68, v56, v57
    v_mfma_f32_16x16x32_bf16 v[92:95], a[172:175], v[104:107], v[92:95]
    v_cvt_pk_bf16_f32 v69, v58, v59
    v_mfma_f32_16x16x32_bf16 v[96:99], a[176:179], v[104:107], v[96:99]
    v_cvt_pk_bf16_f32 v72, v60, v61
    v_cvt_pk_bf16_f32 v73, v62, v63
    s_add_u32 s36, s48, 13312
    buffer_load_dwordx4 a[244:247], v31, s[28:31], s36 offen sc1
    s_waitcnt lgkmcnt(4)
    v_mfma_f32_16x16x32_bf16 v[76:79], a[180:183], v[108:111], v[76:79]
    ds_read_b64_tr_b16 v[104:105], v9 offset:0
    ds_read_b64_tr_b16 v[106:107], v9 offset:512
    buffer_store_dwordx2 v[64:65], v12, s[28:31], s52 offen sc1
    buffer_store_dwordx2 v[68:69], v12, s[28:31], s53 offen sc1
    v_mfma_f32_16x16x32_bf16 v[80:83], a[184:187], v[108:111], v[80:83]
    buffer_store_dwordx2 v[72:73], v12, s[28:31], s54 offen sc1
    v_add_u32 v12, 176128, v12
    v_mfma_f32_16x16x32_bf16 v[84:87], a[188:191], v[108:111], v[84:87]
    s_waitcnt lgkmcnt(4)
    v_mfma_f32_16x16x32_bf16 v[88:91], a[180:183], v[112:115], v[88:91]
    ds_read_b64_tr_b16 v[108:109], v8 offset:1024
    ds_read_b64_tr_b16 v[110:111], v8 offset:1536
    v_mfma_f32_16x16x32_bf16 v[92:95], a[184:187], v[112:115], v[92:95]
    v_mfma_f32_16x16x32_bf16 v[96:99], a[188:191], v[112:115], v[96:99]
    s_add_u32 s36, s48, 14336
    buffer_load_dwordx4 a[248:251], v31, s[28:31], s36 offen sc1
    s_waitcnt lgkmcnt(4)
    v_mfma_f32_16x16x32_bf16 v[52:55], a[0:3], v[100:103], 0
    ds_read_b64_tr_b16 v[112:113], v9 offset:1024
    ds_read_b64_tr_b16 v[114:115], v9 offset:1536
    ds_read_b32 v22, v17 offset:8
    ds_read_b32 v24, v18 offset:8
    v_mfma_f32_16x16x32_bf16 v[56:59], a[4:7], v[100:103], 0
    ds_read_b64 v[26:27], v20 offset:0
    v_mfma_f32_16x16x32_bf16 v[60:63], a[8:11], v[100:103], 0
    v_mfma_f32_16x16x32_bf16 v[120:123], v[116:119], v[100:103], 0
    v_mfma_f32_16x16x32_bf16 v[124:127], v[100:103], v[100:103], 0
    s_waitcnt lgkmcnt(4)
    v_mfma_f32_16x16x32_bf16 v[64:67], a[0:3], v[104:107], 0
    ds_read_b64_tr_b16 v[100:101], v8 offset:8192
    ds_read_b64_tr_b16 v[102:103], v8 offset:8704
    v_mfma_f32_16x16x32_bf16 v[68:71], a[4:7], v[104:107], 0
    v_mfma_f32_16x16x32_bf16 v[72:75], a[8:11], v[104:107], 0
    s_add_u32 s36, s48, 15360
    buffer_load_dwordx4 a[252:255], v31, s[28:31], s36 offen sc1
    s_waitcnt lgkmcnt(4)
    v_mfma_f32_16x16x32_bf16 v[52:55], a[12:15], v[108:111], v[52:55]
    ds_read_b64_tr_b16 v[104:105], v9 offset:8192
    ds_read_b64_tr_b16 v[106:107], v9 offset:8704
    v_mfma_f32_16x16x32_bf16 v[56:59], a[16:19], v[108:111], v[56:59]
    v_fma_f32 v76, v32, v22, v76
    v_fma_f32 v77, v33, v22, v77
    v_mfma_f32_16x16x32_bf16 v[60:63], a[20:23], v[108:111], v[60:63]
    v_fma_f32 v78, v34, v22, v78
    v_mfma_f32_16x16x32_bf16 v[120:123], v[116:119], v[108:111], v[120:123]
    v_mfma_f32_16x16x32_bf16 v[124:127], v[108:111], v[108:111], v[124:127]
    s_waitcnt lgkmcnt(4)
    v_mfma_f32_16x16x32_bf16 v[64:67], a[12:15], v[112:115], v[64:67]
    ds_read_b64_tr_b16 v[108:109], v8 offset:9216
    ds_read_b64_tr_b16 v[110:111], v8 offset:9728
    v_fma_f32 v79, v35, v22, v79
    v_fma_f32 v88, v32, v24, v88
    v_mfma_f32_16x16x32_bf16 v[68:71], a[16:19], v[112:115], v[68:71]
    v_fma_f32 v89, v33, v24, v89
    v_fma_f32 v90, v34, v24, v90
    v_mfma_f32_16x16x32_bf16 v[72:75], a[20:23], v[112:115], v[72:75]
    v_fma_f32 v91, v35, v24, v91
    v_fma_f32 v80, v36, v22, v80
    s_add_u32 s36, s48, 16384
    buffer_load_dwordx4 v[144:147], v31, s[28:31], s36 offen sc1
    v_add_u32 v10, 0x10000, v10
    v_add_u32 v11, 0x10000, v11
    s_waitcnt lgkmcnt(4)
    v_mfma_f32_16x16x32_bf16 v[52:55], a[24:27], v[100:103], v[52:55]
    ds_read_b64_tr_b16 v[112:113], v9 offset:9216
    ds_read_b64_tr_b16 v[114:115], v9 offset:9728
    v_fma_f32 v81, v37, v22, v81
    v_fma_f32 v82, v38, v22, v82
    v_mfma_f32_16x16x32_bf16 v[56:59], a[28:31], v[100:103], v[56:59]
    v_fma_f32 v83, v39, v22, v83
    v_mfma_f32_16x16x32_bf16 v[60:63], a[32:35], v[100:103], v[60:63]
    v_fma_f32 v92, v36, v24, v92
    v_fma_f32 v93, v37, v24, v93
    v_mfma_f32_16x16x32_bf16 v[120:123], v[116:119], v[100:103], v[120:123]
    v_mfma_f32_16x16x32_bf16 v[124:127], v[100:103], v[100:103], v[124:127]
    s_waitcnt lgkmcnt(4)
    v_mfma_f32_16x16x32_bf16 v[64:67], a[24:27], v[104:107], v[64:67]
    ds_read_b64_tr_b16 v[100:101], v8 offset:16384
    ds_read_b64_tr_b16 v[102:103], v8 offset:16896
    v_fma_f32 v94, v38, v24, v94
    v_fma_f32 v95, v39, v24, v95
    v_mfma_f32_16x16x32_bf16 v[68:71], a[28:31], v[104:107], v[68:71]
    v_fma_f32 v84, v40, v22, v84
    v_fma_f32 v85, v41, v22, v85
    v_mfma_f32_16x16x32_bf16 v[72:75], a[32:35], v[104:107], v[72:75]
    v_fma_f32 v86, v42, v22, v86
    v_fma_f32 v87, v43, v22, v87
    s_add_u32 s36, s48, 17408
    buffer_load_dwordx4 v[148:151], v31, s[28:31], s36 offen sc1
    s_waitcnt lgkmcnt(4)
    v_mfma_f32_16x16x32_bf16 v[52:55], a[36:39], v[108:111], v[52:55]
    ds_read_b64_tr_b16 v[104:105], v9 offset:16384
    ds_read_b64_tr_b16 v[106:107], v9 offset:16896
    v_fma_f32 v96, v40, v24, v96
    v_mfma_f32_16x16x32_bf16 v[56:59], a[40:43], v[108:111], v[56:59]
    v_fma_f32 v97, v41, v24, v97
    v_fma_f32 v98, v42, v24, v98
    v_mfma_f32_16x16x32_bf16 v[60:63], a[44:47], v[108:111], v[60:63]
    v_fma_f32 v99, v43, v24, v99
    v_mfma_f32_16x16x32_bf16 v[120:123], v[116:119], v[108:111], v[120:123]
    v_mfma_f32_16x16x32_bf16 v[124:127], v[108:111], v[108:111], v[124:127]
    s_waitcnt lgkmcnt(4)
    v_mfma_f32_16x16x32_bf16 v[64:67], a[36:39], v[112:115], v[64:67]
    ds_read_b64_tr_b16 v[108:109], v8 offset:17408
    ds_read_b64_tr_b16 v[110:111], v8 offset:17920
    v_permlane32_swap_b32 v76, v88
    v_mfma_f32_16x16x32_bf16 v[68:71], a[40:43], v[112:115], v[68:71]
    v_permlane32_swap_b32 v77, v89
    v_mfma_f32_16x16x32_bf16 v[72:75], a[44:47], v[112:115], v[72:75]
    v_permlane32_swap_b32 v78, v90
    s_add_u32 s36, s48, 18432
    buffer_load_dwordx4 v[152:155], v31, s[28:31], s36 offen sc1
    s_waitcnt lgkmcnt(4)
    v_mfma_f32_16x16x32_bf16 v[52:55], a[48:51], v[100:103], v[52:55]
    ds_read_b64_tr_b16 v[112:113], v9 offset:17408
    ds_read_b64_tr_b16 v[114:115], v9 offset:17920
    v_permlane32_swap_b32 v79, v91
    v_mfma_f32_16x16x32_bf16 v[56:59], a[52:55], v[100:103], v[56:59]
    v_permlane32_swap_b32 v80, v92
    v_mfma_f32_16x16x32_bf16 v[60:63], a[56:59], v[100:103], v[60:63]
    v_permlane32_swap_b32 v81, v93
    v_mfma_f32_16x16x32_bf16 v[120:123], v[116:119], v[100:103], v[120:123]
    v_mfma_f32_16x16x32_bf16 v[124:127], v[100:103], v[100:103], v[124:127]
    s_waitcnt lgkmcnt(4)
    v_mfma_f32_16x16x32_bf16 v[64:67], a[48:51], v[104:107], v[64:67]
    ds_read_b64_tr_b16 v[100:101], v8 offset:24576
    ds_read_b64_tr_b16 v[102:103], v8 offset:25088
    v_permlane32_swap_b32 v82, v94
    v_mfma_f32_16x16x32_bf16 v[68:71], a[52:55], v[104:107], v[68:71]
    v_permlane32_swap_b32 v83, v95
    v_mfma_f32_16x16x32_bf16 v[72:75], a[56:59], v[104:107], v[72:75]
    s_add_u32 s36, s48, 19456
    buffer_load_dwordx4 v[156:159], v31, s[28:31], s36 offen sc1
    s_waitcnt lgkmcnt(4)
    v_mfma_f32_16x16x32_bf16 v[52:55], a[60:63], v[108:111], v[52:55]
    ds_read_b64_tr_b16 v[104:105], v9 offset:24576
    ds_read_b64_tr_b16 v[106:107], v9 offset:25088
    v_permlane32_swap_b32 v84, v96
    v_mfma_f32_16x16x32_bf16 v[56:59], a[64:67], v[108:111], v[56:59]
    v_permlane32_swap_b32 v85, v97
    v_mfma_f32_16x16x32_bf16 v[60:63], a[68:71], v[108:111], v[60:63]
    v_permlane32_swap_b32 v86, v98
    v_mfma_f32_16x16x32_bf16 v[120:123], v[116:119], v[108:111], v[120:123]
    v_mfma_f32_16x16x32_bf16 v[124:127], v[108:111], v[108:111], v[124:127]
    s_waitcnt lgkmcnt(4)
    v_mfma_f32_16x16x32_bf16 v[64:67], a[60:63], v[112:115], v[64:67]
    ds_read_b64_tr_b16 v[108:109], v8 offset:25600
    ds_read_b64_tr_b16 v[110:111], v8 offset:26112
    v_permlane32_swap_b32 v87, v99
    v_mul_f32 v128, v76, v26
    v_mfma_f32_16x16x32_bf16 v[68:71], a[64:67], v[112:115], v[68:71]
    v_mul_f32 v129, v77, v26
    v_mul_f32 v130, v78, v26
    v_mfma_f32_16x16x32_bf16 v[72:75], a[68:71], v[112:115], v[72:75]
    v_mul_f32 v131, v79, v26
    s_add_u32 s36, s48, 20480
    buffer_load_dwordx4 v[160:163], v31, s[28:31], s36 offen sc1
    s_waitcnt lgkmcnt(4)
    v_mfma_f32_16x16x32_bf16 v[52:55], a[72:75], v[100:103], v[52:55]
    ds_read_b64_tr_b16 v[112:113], v9 offset:25600
    ds_read_b64_tr_b16 v[114:115], v9 offset:26112
    v_mul_f32 v132, v80, v26
    v_mul_f32 v133, v81, v26
    v_mfma_f32_16x16x32_bf16 v[56:59], a[76:79], v[100:103], v[56:59]
    v_mul_f32 v134, v82, v26
    v_mul_f32 v135, v83, v26
    v_mfma_f32_16x16x32_bf16 v[60:63], a[80:83], v[100:103], v[60:63]
    v_mul_f32 v136, v84, v26
    v_mul_f32 v137, v85, v26
    v_mfma_f32_16x16x32_bf16 v[120:123], v[116:119], v[100:103], v[120:123]
    v_mfma_f32_16x16x32_bf16 v[124:127], v[100:103], v[100:103], v[124:127]
    s_waitcnt lgkmcnt(4)
    v_mfma_f32_16x16x32_bf16 v[64:67], a[72:75], v[104:107], v[64:67]
    ds_read_b64_tr_b16 v[100:101], v8 offset:32768
    ds_read_b64_tr_b16 v[102:103], v8 offset:33280
    v_mul_f32 v138, v86, v26
    v_mul_f32 v139, v87, v26
    v_mfma_f32_16x16x32_bf16 v[68:71], a[76:79], v[104:107], v[68:71]
    v_mfma_f32_16x16x32_bf16 v[72:75], a[80:83], v[104:107], v[72:75]
    v_exp_f32 v128, v128
    s_add_u32 s36, s48, 21504
    buffer_load_dwordx4 v[164:167], v31, s[28:31], s36 offen sc1
    s_waitcnt lgkmcnt(4)
    v_mfma_f32_16x16x32_bf16 v[52:55], a[84:87], v[108:111], v[52:55]
    ds_read_b64_tr_b16 v[104:105], v9 offset:32768
    ds_read_b64_tr_b16 v[106:107], v9 offset:33280
    v_exp_f32 v129, v129
    v_mfma_f32_16x16x32_bf16 v[56:59], a[88:91], v[108:111], v[56:59]
    v_exp_f32 v130, v130
    v_mfma_f32_16x16x32_bf16 v[60:63], a[92:95], v[108:111], v[60:63]
    v_exp_f32 v131, v131
    v_mul_f32 v76, v76, v88
    v_mfma_f32_16x16x32_bf16 v[120:123], v[116:119], v[108:111], v[120:123]
    v_mfma_f32_16x16x32_bf16 v[124:127], v[108:111], v[108:111], v[124:127]
    s_waitcnt lgkmcnt(4)
    v_mfma_f32_16x16x32_bf16 v[64:67], a[84:87], v[112:115], v[64:67]
    ds_read_b64_tr_b16 v[108:109], v8 offset:33792
    ds_read_b64_tr_b16 v[110:111], v8 offset:34304
    v_mul_f32 v77, v77, v89
    v_mfma_f32_16x16x32_bf16 v[68:71], a[88:91], v[112:115], v[68:71]
    v_mul_f32 v78, v78, v90
    v_mul_f32 v79, v79, v91
    v_mfma_f32_16x16x32_bf16 v[72:75], a[92:95], v[112:115], v[72:75]
    v_exp_f32 v132, v132
    s_add_u32 s36, s48, 22528
    buffer_load_dwordx4 v[168:171], v31, s[28:31], s36 offen sc1
    s_waitcnt lgkmcnt(4)
    v_mfma_f32_16x16x32_bf16 v[52:55], a[96:99], v[100:103], v[52:55]
    ds_read_b64_tr_b16 v[112:113], v9 offset:33792
    ds_read_b64_tr_b16 v[114:115], v9 offset:34304
    v_exp_f32 v133, v133
    v_mfma_f32_16x16x32_bf16 v[56:59], a[100:103], v[100:103], v[56:59]
    v_exp_f32 v134, v134
    v_mfma_f32_16x16x32_bf16 v[60:63], a[104:107], v[100:103], v[60:63]
    v_exp_f32 v135, v135
    v_mfma_f32_16x16x32_bf16 v[120:123], v[116:119], v[100:103], v[120:123]
    v_mfma_f32_16x16x32_bf16 v[124:127], v[100:103], v[100:103], v[124:127]
    s_waitcnt lgkmcnt(4)
    v_mfma_f32_16x16x32_bf16 v[64:67], a[96:99], v[104:107], v[64:67]
    ds_read_b64_tr_b16 v[100:101], v8 offset:40960
    ds_read_b64_tr_b16 v[102:103], v8 offset:41472
    v_mul_f32 v80, v80, v92
    v_mfma_f32_16x16x32_bf16 v[68:71], a[100:103], v[104:107], v[68:71]
    v_mul_f32 v81, v81, v93
    v_mul_f32 v82, v82, v94
    v_mfma_f32_16x16x32_bf16 v[72:75], a[104:107], v[104:107], v[72:75]
    v_mul_f32 v83, v83, v95
    s_add_u32 s36, s48, 23552
    buffer_load_dwordx4 v[172:175], v31, s[28:31], s36 offen sc1
    s_waitcnt lgkmcnt(4)
    v_mfma_f32_16x16x32_bf16 v[52:55], a[108:111], v[108:111], v[52:55]
    ds_read_b64_tr_b16 v[104:105], v9 offset:40960
    ds_read_b64_tr_b16 v[106:107], v9 offset:41472
    v_exp_f32 v136, v136
    v_mfma_f32_16x16x32_bf16 v[56:59], a[112:115], v[108:111], v[56:59]
    v_exp_f32 v137, v137
    v_mfma_f32_16x16x32_bf16 v[60:63], a[116:119], v[108:111], v[60:63]
    v_exp_f32 v138, v138
    v_mfma_f32_16x16x32_bf16 v[120:123], v[116:119], v[108:111], v[120:123]
    v_mfma_f32_16x16x32_bf16 v[124:127], v[108:111], v[108:111], v[124:127]
    s_waitcnt lgkmcnt(4)
    v_mfma_f32_16x16x32_bf16 v[64:67], a[108:111], v[112:115], v[64:67]
    ds_read_b64_tr_b16 v[108:109], v8 offset:41984
    ds_read_b64_tr_b16 v[110:111], v8 offset:42496
    v_exp_f32 v139, v139
    v_mfma_f32_16x16x32_bf16 v[68:71], a[112:115], v[112:115], v[68:71]
    v_mul_f32 v84, v84, v96
    v_mul_f32 v85, v85, v97
    v_mfma_f32_16x16x32_bf16 v[72:75], a[116:119], v[112:115], v[72:75]
    v_mul_f32 v86, v86, v98
    v_mul_f32 v87, v87, v99
    s_add_u32 s36, s48, 24576
    buffer_load_dwordx4 v[176:179], v31, s[28:31], s36 offen sc1
    s_waitcnt lgkmcnt(4)
    v_mfma_f32_16x16x32_bf16 v[52:55], a[120:123], v[100:103], v[52:55]
    ds_read_b64_tr_b16 v[112:113], v9 offset:41984
    ds_read_b64_tr_b16 v[114:115], v9 offset:42496
    v_fma_f32 v128, v128, v27, v27
    v_fma_f32 v129, v129, v27, v27
    v_mfma_f32_16x16x32_bf16 v[56:59], a[124:127], v[100:103], v[56:59]
    v_fma_f32 v130, v130, v27, v27
    v_fma_f32 v131, v131, v27, v27
    v_mfma_f32_16x16x32_bf16 v[60:63], a[128:131], v[100:103], v[60:63]
    v_fma_f32 v132, v132, v27, v27
    v_mfma_f32_16x16x32_bf16 v[120:123], v[116:119], v[100:103], v[120:123]
    v_mfma_f32_16x16x32_bf16 v[124:127], v[100:103], v[100:103], v[124:127]
    s_waitcnt lgkmcnt(4)
    v_mfma_f32_16x16x32_bf16 v[64:67], a[120:123], v[104:107], v[64:67]
    ds_read_b64_tr_b16 v[100:101], v8 offset:49152
    ds_read_b64_tr_b16 v[102:103], v8 offset:49664
    v_fma_f32 v133, v133, v27, v27
    v_fma_f32 v134, v134, v27, v27
    v_mfma_f32_16x16x32_bf16 v[68:71], a[124:127], v[104:107], v[68:71]
    v_fma_f32 v135, v135, v27, v27
    v_fma_f32 v136, v136, v27, v27
    v_mfma_f32_16x16x32_bf16 v[72:75], a[128:131], v[104:107], v[72:75]
    v_fma_f32 v137, v137, v27, v27
    v_fma_f32 v138, v138, v27, v27
    s_add_u32 s36, s48, 25600
    buffer_load_dwordx4 v[180:183], v31, s[28:31], s36 offen sc1
    s_waitcnt lgkmcnt(4)
    v_mfma_f32_16x16x32_bf16 v[52:55], a[132:135], v[108:111], v[52:55]
    ds_read_b64_tr_b16 v[104:105], v9 offset:49152
    ds_read_b64_tr_b16 v[106:107], v9 offset:49664
    v_fma_f32 v139, v139, v27, v27
    v_mfma_f32_16x16x32_bf16 v[56:59], a[136:139], v[108:111], v[56:59]
    v_rcp_f32 v128, v128
    v_mfma_f32_16x16x32_bf16 v[60:63], a[140:143], v[108:111], v[60:63]
    v_rcp_f32 v129, v129
    v_mfma_f32_16x16x32_bf16 v[120:123], v[116:119], v[108:111], v[120:123]
    v_mfma_f32_16x16x32_bf16 v[124:127], v[108:111], v[108:111], v[124:127]
    s_waitcnt lgkmcnt(4)
    v_mfma_f32_16x16x32_bf16 v[64:67], a[132:135], v[112:115], v[64:67]
    ds_read_b64_tr_b16 v[108:109], v8 offset:50176
    ds_read_b64_tr_b16 v[110:111], v8 offset:50688
    v_rcp_f32 v130, v130
    v_mfma_f32_16x16x32_bf16 v[68:71], a[136:139], v[112:115], v[68:71]
    v_rcp_f32 v131, v131
    v_mfma_f32_16x16x32_bf16 v[72:75], a[140:143], v[112:115], v[72:75]
    v_rcp_f32 v132, v132
    s_add_u32 s36, s48, 26624
    buffer_load_dwordx4 v[184:187], v31, s[28:31], s36 offen sc1
    s_waitcnt lgkmcnt(4)
    v_mfma_f32_16x16x32_bf16 v[52:55], a[144:147], v[100:103], v[52:55]
    ds_read_b64_tr_b16 v[112:113], v9 offset:50176
    ds_read_b64_tr_b16 v[114:115], v9 offset:50688
    v_rcp_f32 v133, v133
    v_mfma_f32_16x16x32_bf16 v[56:59], a[148:151], v[100:103], v[56:59]
    v_mfma_f32_16x16x32_bf16 v[60:63], a[152:155], v[100:103], v[60:63]
    v_rcp_f32 v134, v134
    v_mfma_f32_16x16x32_bf16 v[120:123], v[116:119], v[100:103], v[120:123]
    v_mfma_f32_16x16x32_bf16 v[124:127], v[100:103], v[100:103], v[124:127]
    s_waitcnt lgkmcnt(4)
    v_mfma_f32_16x16x32_bf16 v[64:67], a[144:147], v[104:107], v[64:67]
    ds_read_b64_tr_b16 v[100:101], v8 offset:57344
    ds_read_b64_tr_b16 v[102:103], v8 offset:57856
    v_rcp_f32 v135, v135
    v_mfma_f32_16x16x32_bf16 v[68:71], a[148:151], v[104:107], v[68:71]
    v_rcp_f32 v136, v136
    v_mfma_f32_16x16x32_bf16 v[72:75], a[152:155], v[104:107], v[72:75]
    v_rcp_f32 v137, v137
    s_add_u32 s36, s48, 27648
    buffer_load_dwordx4 v[188:191], v31, s[28:31], s36 offen sc1
    s_waitcnt lgkmcnt(4)
    v_mfma_f32_16x16x32_bf16 v[52:55], a[156:159], v[108:111], v[52:55]
    ds_read_b64_tr_b16 v[104:105], v9 offset:57344
    ds_read_b64_tr_b16 v[106:107], v9 offset:57856
    v_rcp_f32 v138, v138
    v_mfma_f32_16x16x32_bf16 v[56:59], a[160:163], v[108:111], v[56:59]
    v_rcp_f32 v139, v139
    v_mfma_f32_16x16x32_bf16 v[60:63], a[164:167], v[108:111], v[60:63]
    v_mul_f32 v76, v76, v128
    v_mul_f32 v77, v77, v129
    v_mfma_f32_16x16x32_bf16 v[120:123], v[116:119], v[108:111], v[120:123]
    v_mfma_f32_16x16x32_bf16 v[124:127], v[108:111], v[108:111], v[124:127]
    s_waitcnt lgkmcnt(4)
    v_mfma_f32_16x16x32_bf16 v[64:67], a[156:159], v[112:115], v[64:67]
    ds_read_b64_tr_b16 v[108:109], v8 offset:58368
    ds_read_b64_tr_b16 v[110:111], v8 offset:58880
    v_mul_f32 v78, v78, v130
    v_mul_f32 v79, v79, v131
    v_mfma_f32_16x16x32_bf16 v[68:71], a[160:163], v[112:115], v[68:71]
    v_mul_f32 v80, v80, v132
    v_mul_f32 v81, v81, v133
    v_mfma_f32_16x16x32_bf16 v[72:75], a[164:167], v[112:115], v[72:75]
    v_mul_f32 v82, v82, v134
    s_add_u32 s36, s48, 28672
    buffer_load_dwordx4 v[192:195], v31, s[28:31], s36 offen sc1
    s_waitcnt lgkmcnt(4)
    v_mfma_f32_16x16x32_bf16 v[52:55], a[168:171], v[100:103], v[52:55]
    ds_read_b64_tr_b16 v[112:113], v9 offset:58368
    ds_read_b64_tr_b16 v[114:115], v9 offset:58880
    v_mul_f32 v83, v83, v135
    v_mul_f32 v84, v84, v136
    v_mfma_f32_16x16x32_bf16 v[56:59], a[172:175], v[100:103], v[56:59]
    v_mul_f32 v85, v85, v137
    v_mul_f32 v86, v86, v138
    v_mfma_f32_16x16x32_bf16 v[60:63], a[176:179], v[100:103], v[60:63]
    v_mul_f32 v87, v87, v139
    v_cvt_pk_bf16_f32 v88, v76, v77
    v_mfma_f32_16x16x32_bf16 v[120:123], v[116:119], v[100:103], v[120:123]
    v_mfma_f32_16x16x32_bf16 v[124:127], v[100:103], v[100:103], v[124:127]
    s_waitcnt lgkmcnt(4)
    v_mfma_f32_16x16x32_bf16 v[64:67], a[168:171], v[104:107], v[64:67]
    ds_read_b64_tr_b16 v[100:101], v10 offset:0
    ds_read_b64_tr_b16 v[102:103], v10 offset:512
    v_cvt_pk_bf16_f32 v89, v78, v79
    v_cvt_pk_bf16_f32 v92, v80, v81
    v_mfma_f32_16x16x32_bf16 v[68:71], a[172:175], v[104:107], v[68:71]
    v_cvt_pk_bf16_f32 v93, v82, v83
    v_cvt_pk_bf16_f32 v96, v84, v85
    v_mfma_f32_16x16x32_bf16 v[72:75], a[176:179], v[104:107], v[72:75]
    v_cvt_pk_bf16_f32 v97, v86, v87
    s_add_u32 s36, s48, 29696
    buffer_load_dwordx4 v[196:199], v31, s[28:31], s36 offen sc1
    s_waitcnt lgkmcnt(4)
    v_mfma_f32_16x16x32_bf16 v[52:55], a[180:183], v[108:111], v[52:55]
    ds_read_b64_tr_b16 v[104:105], v11 offset:0
    ds_read_b64_tr_b16 v[106:107], v11 offset:512
    buffer_store_dwordx2 v[88:89], v13, s[28:31], s52 offen sc1
    buffer_store_dwordx2 v[92:93], v13, s[28:31], s53 offen sc1
    v_mfma_f32_16x16x32_bf16 v[56:59], a[184:187], v[108:111], v[56:59]
    buffer_store_dwordx2 v[96:97], v13, s[28:31], s54 offen sc1
    v_add_u32 v13, 176128, v13
    v_mfma_f32_16x16x32_bf16 v[60:63], a[188:191], v[108:111], v[60:63]
    v_mfma_f32_16x16x32_bf16 v[120:123], v[116:119], v[108:111], v[120:123]
    v_mfma_f32_16x16x32_bf16 v[124:127], v[108:111], v[108:111], v[124:127]
    s_waitcnt lgkmcnt(4)
    v_mfma_f32_16x16x32_bf16 v[64:67], a[180:183], v[112:115], v[64:67]
    ds_read_b64_tr_b16 v[108:109], v10 offset:1024
    ds_read_b64_tr_b16 v[110:111], v10 offset:1536
    v_mfma_f32_16x16x32_bf16 v[68:71], a[184:187], v[112:115], v[68:71]
    v_mfma_f32_16x16x32_bf16 v[72:75], a[188:191], v[112:115], v[72:75]
    v_and_b32 v4, 3, v2
    v_cmp_eq_u32 vcc, 1, v4
    s_nop 1
    v_cndmask_b32 v29, v124, v125, vcc
    v_cmp_eq_u32 vcc, 2, v4
    s_nop 1
    v_cndmask_b32 v29, v29, v126, vcc
    v_cmp_eq_u32 vcc, 3, v4
    s_nop 1
    v_cndmask_b32 v29, v29, v127, vcc
    v_mov_b32 v28, v120
    v_mul_f32 v28, 0x3b000000, v28
    v_mul_f32 v29, 0x3b000000, v29
    v_fma_f32 v29, -v28, v28, v29
    v_max_f32 v29, 0, v29
    v_cvt_pk_bf16_f32 v29, v29, v29
    v_and_b32 v29, 0xffff0000, v29
    v_add_f32 v29, 0x3727c5ac, v29
    v_cvt_pk_bf16_f32 v29, v29, v29
    v_and_b32 v29, 0xffff0000, v29
    v_sqrt_f32 v29, v29
    s_nop 0
    v_cvt_pk_bf16_f32 v29, v29, v29
    v_and_b32 v29, 0xffff0000, v29
    v_cvt_pk_bf16_f32 v28, v28, v28
    v_and_b32 v28, 0xffff0000, v28
    v_rcp_f32 v5, v29
    v_mul_f32 v121, v29, v29
    v_sub_f32 v122, 0, v28
    v_mul_f32 v120, 0xbfb8aa3b, v5
    v_mov_b32 v123, 0
    s_lshl_b32 s36, s18, 8
    s_add_u32 s36, s36, 148480
    v_lshl_add_u32 v6, v2, 4, s36
    v_lshrrev_b32 v4, 2, v2
    v_cmp_eq_u32 vcc, v4, v3
    s_nop 1
    s_and_saveexec_b64 s[38:39], vcc
    ds_write_b128 v6, v[120:123]
    s_mov_b64 exec, s[38:39]
    s_waitcnt lgkmcnt(0)
    s_barrier
    s_add_u32 s36, s48, 30720
    buffer_load_dwordx4 v[200:203], v31, s[28:31], s36 offen sc1
    s_waitcnt lgkmcnt(4)
    v_mfma_f32_16x16x32_bf16 v[76:79], a[0:3], v[100:103], 0
    ds_read_b64_tr_b16 v[112:113], v11 offset:1024
    ds_read_b64_tr_b16 v[114:115], v11 offset:1536
    ds_read_b32 v22, v15 offset:1032
    ds_read_b32 v24, v16 offset:1032
    v_mfma_f32_16x16x32_bf16 v[80:83], a[4:7], v[100:103], 0
    ds_read_b64 v[26:27], v19 offset:1024
    v_mfma_f32_16x16x32_bf16 v[84:87], a[8:11], v[100:103], 0
    s_waitcnt lgkmcnt(4)
    v_mfma_f32_16x16x32_bf16 v[88:91], a[0:3], v[104:107], 0
    ds_read_b64_tr_b16 v[100:101], v10 offset:8192
    ds_read_b64_tr_b16 v[102:103], v10 offset:8704
    v_mfma_f32_16x16x32_bf16 v[92:95], a[4:7], v[104:107], 0
    v_mfma_f32_16x16x32_bf16 v[96:99], a[8:11], v[104:107], 0
    s_add_u32 s36, s48, 31744
    buffer_load_dwordx4 v[204:207], v31, s[28:31], s36 offen sc1
    s_waitcnt lgkmcnt(4)
    v_mfma_f32_16x16x32_bf16 v[76:79], a[12:15], v[108:111], v[76:79]
    ds_read_b64_tr_b16 v[104:105], v11 offset:8192
    ds_read_b64_tr_b16 v[106:107], v11 offset:8704
    v_mfma_f32_16x16x32_bf16 v[80:83], a[16:19], v[108:111], v[80:83]
    v_fma_f32 v52, v32, v22, v52
    v_fma_f32 v53, v33, v22, v53
    v_mfma_f32_16x16x32_bf16 v[84:87], a[20:23], v[108:111], v[84:87]
    v_fma_f32 v54, v34, v22, v54
    s_waitcnt lgkmcnt(4)
    v_mfma_f32_16x16x32_bf16 v[88:91], a[12:15], v[112:115], v[88:91]
    ds_read_b64_tr_b16 v[108:109], v10 offset:9216
    ds_read_b64_tr_b16 v[110:111], v10 offset:9728
    v_fma_f32 v55, v35, v22, v55
    v_fma_f32 v64, v32, v24, v64
    v_mfma_f32_16x16x32_bf16 v[92:95], a[16:19], v[112:115], v[92:95]
    v_fma_f32 v65, v33, v24, v65
    v_fma_f32 v66, v34, v24, v66
    v_mfma_f32_16x16x32_bf16 v[96:99], a[20:23], v[112:115], v[96:99]
    v_fma_f32 v67, v35, v24, v67
    v_fma_f32 v56, v36, v22, v56
    s_add_u32 s36, s48, 32768
    buffer_load_dwordx4 v[208:211], v31, s[28:31], s36 offen sc1
    s_waitcnt lgkmcnt(4)
    v_mfma_f32_16x16x32_bf16 v[76:79], a[24:27], v[100:103], v[76:79]
    ds_read_b64_tr_b16 v[112:113], v11 offset:9216
    ds_read_b64_tr_b16 v[114:115], v11 offset:9728
    v_fma_f32 v57, v37, v22, v57
    v_fma_f32 v58, v38, v22, v58
    v_mfma_f32_16x16x32_bf16 v[80:83], a[28:31], v[100:103], v[80:83]
    v_fma_f32 v59, v39, v22, v59
    v_mfma_f32_16x16x32_bf16 v[84:87], a[32:35], v[100:103], v[84:87]
    v_fma_f32 v68, v36, v24, v68
    v_fma_f32 v69, v37, v24, v69
    s_waitcnt lgkmcnt(4)
    v_mfma_f32_16x16x32_bf16 v[88:91], a[24:27], v[104:107], v[88:91]
    ds_read_b64_tr_b16 v[100:101], v10 offset:16384
    ds_read_b64_tr_b16 v[102:103], v10 offset:16896
    v_fma_f32 v70, v38, v24, v70
    v_fma_f32 v71, v39, v24, v71
    v_mfma_f32_16x16x32_bf16 v[92:95], a[28:31], v[104:107], v[92:95]
    v_fma_f32 v60, v40, v22, v60
    v_fma_f32 v61, v41, v22, v61
    v_mfma_f32_16x16x32_bf16 v[96:99], a[32:35], v[104:107], v[96:99]
    v_fma_f32 v62, v42, v22, v62
    v_fma_f32 v63, v43, v22, v63
    s_add_u32 s36, s48, 33792
    buffer_load_dwordx4 v[212:215], v31, s[28:31], s36 offen sc1
    s_waitcnt lgkmcnt(4)
    v_mfma_f32_16x16x32_bf16 v[76:79], a[36:39], v[108:111], v[76:79]
    ds_read_b64_tr_b16 v[104:105], v11 offset:16384
    ds_read_b64_tr_b16 v[106:107], v11 offset:16896
    v_fma_f32 v72, v40, v24, v72
    v_mfma_f32_16x16x32_bf16 v[80:83], a[40:43], v[108:111], v[80:83]
    v_fma_f32 v73, v41, v24, v73
    v_fma_f32 v74, v42, v24, v74
    v_mfma_f32_16x16x32_bf16 v[84:87], a[44:47], v[108:111], v[84:87]
    v_fma_f32 v75, v43, v24, v75
    s_waitcnt lgkmcnt(4)
    v_mfma_f32_16x16x32_bf16 v[88:91], a[36:39], v[112:115], v[88:91]
    ds_read_b64_tr_b16 v[108:109], v10 offset:17408
    ds_read_b64_tr_b16 v[110:111], v10 offset:17920
    v_permlane32_swap_b32 v52, v64
    v_mfma_f32_16x16x32_bf16 v[92:95], a[40:43], v[112:115], v[92:95]
    v_permlane32_swap_b32 v53, v65
    v_mfma_f32_16x16x32_bf16 v[96:99], a[44:47], v[112:115], v[96:99]
    v_permlane32_swap_b32 v54, v66
    s_add_u32 s36, s48, 34816
    buffer_load_dwordx4 v[216:219], v31, s[28:31], s36 offen sc1
    s_waitcnt lgkmcnt(4)
    v_mfma_f32_16x16x32_bf16 v[76:79], a[48:51], v[100:103], v[76:79]
    ds_read_b64_tr_b16 v[112:113], v11 offset:17408
    ds_read_b64_tr_b16 v[114:115], v11 offset:17920
    v_permlane32_swap_b32 v55, v67
    v_mfma_f32_16x16x32_bf16 v[80:83], a[52:55], v[100:103], v[80:83]
    v_permlane32_swap_b32 v56, v68
    v_mfma_f32_16x16x32_bf16 v[84:87], a[56:59], v[100:103], v[84:87]
    v_permlane32_swap_b32 v57, v69
    s_waitcnt lgkmcnt(4)
    v_mfma_f32_16x16x32_bf16 v[88:91], a[48:51], v[104:107], v[88:91]
    ds_read_b64_tr_b16 v[100:101], v10 offset:24576
    ds_read_b64_tr_b16 v[102:103], v10 offset:25088
    v_permlane32_swap_b32 v58, v70
    v_mfma_f32_16x16x32_bf16 v[92:95], a[52:55], v[104:107], v[92:95]
    v_permlane32_swap_b32 v59, v71
    v_mfma_f32_16x16x32_bf16 v[96:99], a[56:59], v[104:107], v[96:99]
    s_add_u32 s36, s48, 35840
    buffer_load_dwordx4 v[220:223], v31, s[28:31], s36 offen sc1
    s_waitcnt lgkmcnt(4)
    v_mfma_f32_16x16x32_bf16 v[76:79], a[60:63], v[108:111], v[76:79]
    ds_read_b64_tr_b16 v[104:105], v11 offset:24576
    ds_read_b64_tr_b16 v[106:107], v11 offset:25088
    v_permlane32_swap_b32 v60, v72
    v_mfma_f32_16x16x32_bf16 v[80:83], a[64:67], v[108:111], v[80:83]
    v_permlane32_swap_b32 v61, v73
    v_mfma_f32_16x16x32_bf16 v[84:87], a[68:71], v[108:111], v[84:87]
    v_permlane32_swap_b32 v62, v74
    s_waitcnt lgkmcnt(4)
    v_mfma_f32_16x16x32_bf16 v[88:91], a[60:63], v[112:115], v[88:91]
    ds_read_b64_tr_b16 v[108:109], v10 offset:25600
    ds_read_b64_tr_b16 v[110:111], v10 offset:26112
    v_permlane32_swap_b32 v63, v75
    v_mul_f32 v128, v52, v26
    v_mfma_f32_16x16x32_bf16 v[92:95], a[64:67], v[112:115], v[92:95]
    v_mul_f32 v129, v53, v26
    v_mul_f32 v130, v54, v26
    v_mfma_f32_16x16x32_bf16 v[96:99], a[68:71], v[112:115], v[96:99]
    v_mul_f32 v131, v55, v26
    s_add_u32 s36, s3, 4
    v_mov_b32 v30, s36
    v_mov_b32 v29, s64
    s_waitcnt vmcnt(6)
    s_barrier
    s_cmp_lg_u32 s18, 0
    s_cbranch_scc1 sg_8
    s_mov_b64 exec, 1
    s_cmp_eq_u32 s17, 1
    s_cbranch_scc1 ds_9_l
    buffer_store_dword v30, v29, s[28:31], 0 offen sc1
    s_branch ds_9_e
ds_9_l:
    buffer_store_dword v30, v29, s[28:31], 0 offen
ds_9_e:
    s_mov_b64 exec, -1
sg_8:
    s_add_u32 s36, s48, 36864
    buffer_load_dwordx4 v[224:227], v31, s[28:31], s36 offen sc1
    s_waitcnt lgkmcnt(4)
    v_mfma_f32_16x16x32_bf16 v[76:79], a[72:75], v[100:103], v[76:79]
    ds_read_b64_tr_b16 v[112:113], v11 offset:25600
    ds_read_b64_tr_b16 v[114:115], v11 offset:26112
    v_mul_f32 v132, v56, v26
    v_mul_f32 v133, v57, v26
    v_mfma_f32_16x16x32_bf16 v[80:83], a[76:79], v[100:103], v[80:83]
    v_mul_f32 v134, v58, v26
    v_mul_f32 v135, v59, v26
    v_mfma_f32_16x16x32_bf16 v[84:87], a[80:83], v[100:103], v[84:87]
    v_mul_f32 v136, v60, v26
    v_mul_f32 v137, v61, v26
    s_waitcnt lgkmcnt(4)
    v_mfma_f32_16x16x32_bf16 v[88:91], a[72:75], v[104:107], v[88:91]
    ds_read_b64_tr_b16 v[100:101], v10 offset:32768
    ds_read_b64_tr_b16 v[102:103], v10 offset:33280
    v_mul_f32 v138, v62, v26
    v_mul_f32 v139, v63, v26
    v_mfma_f32_16x16x32_bf16 v[92:95], a[76:79], v[104:107], v[92:95]
    v_mfma_f32_16x16x32_bf16 v[96:99], a[80:83], v[104:107], v[96:99]
    v_exp_f32 v128, v128
    s_add_u32 s36, s48, 37888
    buffer_load_dwordx4 v[228:231], v31, s[28:31], s36 offen sc1
    s_waitcnt lgkmcnt(4)
    v_mfma_f32_16x16x32_bf16 v[76:79], a[84:87], v[108:111], v[76:79]
    ds_read_b64_tr_b16 v[104:105], v11 offset:32768
    ds_read_b64_tr_b16 v[106:107], v11 offset:33280
    v_exp_f32 v129, v129
    v_mfma_f32_16x16x32_bf16 v[80:83], a[88:91], v[108:111], v[80:83]
    v_exp_f32 v130, v130
    v_mfma_f32_16x16x32_bf16 v[84:87], a[92:95], v[108:111], v[84:87]
    v_exp_f32 v131, v131
    v_mul_f32 v52, v52, v64
    s_waitcnt lgkmcnt(4)
    v_mfma_f32_16x16x32_bf16 v[88:91], a[84:87], v[112:115], v[88:91]
    ds_read_b64_tr_b16 v[108:109], v10 offset:33792
    ds_read_b64_tr_b16 v[110:111], v10 offset:34304
    v_mul_f32 v53, v53, v65
    v_mfma_f32_16x16x32_bf16 v[92:95], a[88:91], v[112:115], v[92:95]
    v_mul_f32 v54, v54, v66
    v_mul_f32 v55, v55, v67
    v_mfma_f32_16x16x32_bf16 v[96:99], a[92:95], v[112:115], v[96:99]
    v_exp_f32 v132, v132
    s_add_u32 s36, s48, 38912
    buffer_load_dwordx4 v[232:235], v31, s[28:31], s36 offen sc1
    s_waitcnt lgkmcnt(4)
    v_mfma_f32_16x16x32_bf16 v[76:79], a[96:99], v[100:103], v[76:79]
    ds_read_b64_tr_b16 v[112:113], v11 offset:33792
    ds_read_b64_tr_b16 v[114:115], v11 offset:34304
    v_exp_f32 v133, v133
    v_mfma_f32_16x16x32_bf16 v[80:83], a[100:103], v[100:103], v[80:83]
    v_exp_f32 v134, v134
    v_mfma_f32_16x16x32_bf16 v[84:87], a[104:107], v[100:103], v[84:87]
    v_exp_f32 v135, v135
    s_waitcnt lgkmcnt(4)
    v_mfma_f32_16x16x32_bf16 v[88:91], a[96:99], v[104:107], v[88:91]
    ds_read_b64_tr_b16 v[100:101], v10 offset:40960
    ds_read_b64_tr_b16 v[102:103], v10 offset:41472
    v_mul_f32 v56, v56, v68
    v_mfma_f32_16x16x32_bf16 v[92:95], a[100:103], v[104:107], v[92:95]
    v_mul_f32 v57, v57, v69
    v_mul_f32 v58, v58, v70
    v_mfma_f32_16x16x32_bf16 v[96:99], a[104:107], v[104:107], v[96:99]
    v_mul_f32 v59, v59, v71
    s_add_u32 s36, s48, 39936
    buffer_load_dwordx4 v[236:239], v31, s[28:31], s36 offen sc1
    s_waitcnt lgkmcnt(4)
    v_mfma_f32_16x16x32_bf16 v[76:79], a[108:111], v[108:111], v[76:79]
    ds_read_b64_tr_b16 v[104:105], v11 offset:40960
    ds_read_b64_tr_b16 v[106:107], v11 offset:41472
    v_exp_f32 v136, v136
    v_mfma_f32_16x16x32_bf16 v[80:83], a[112:115], v[108:111], v[80:83]
    v_exp_f32 v137, v137
    v_mfma_f32_16x16x32_bf16 v[84:87], a[116:119], v[108:111], v[84:87]
    v_exp_f32 v138, v138
    s_waitcnt lgkmcnt(4)
    v_mfma_f32_16x16x32_bf16 v[88:91], a[108:111], v[112:115], v[88:91]
    ds_read_b64_tr_b16 v[108:109], v10 offset:41984
    ds_read_b64_tr_b16 v[110:111], v10 offset:42496
    v_exp_f32 v139, v139
    v_mfma_f32_16x16x32_bf16 v[92:95], a[112:115], v[112:115], v[92:95]
    v_mul_f32 v60, v60, v72
    v_mul_f32 v61, v61, v73
    v_mfma_f32_16x16x32_bf16 v[96:99], a[116:119], v[112:115], v[96:99]
    v_mul_f32 v62, v62, v74
    v_mul_f32 v63, v63, v75
    s_add_u32 s36, s49, 40960
    buffer_load_dwordx4 v[240:243], v31, s[28:31], s36 offen sc1
    s_waitcnt lgkmcnt(4)
    v_mfma_f32_16x16x32_bf16 v[76:79], a[120:123], v[100:103], v[76:79]
    ds_read_b64_tr_b16 v[112:113], v11 offset:41984
    ds_read_b64_tr_b16 v[114:115], v11 offset:42496
    v_fma_f32 v128, v128, v27, v27
    v_fma_f32 v129, v129, v27, v27
    v_mfma_f32_16x16x32_bf16 v[80:83], a[124:127], v[100:103], v[80:83]
    v_fma_f32 v130, v130, v27, v27
    v_fma_f32 v131, v131, v27, v27
    v_mfma_f32_16x16x32_bf16 v[84:87], a[128:131], v[100:103], v[84:87]
    v_fma_f32 v132, v132, v27, v27
    s_waitcnt lgkmcnt(4)
    v_mfma_f32_16x16x32_bf16 v[88:91], a[120:123], v[104:107], v[88:91]
    ds_read_b64_tr_b16 v[100:101], v10 offset:49152
    ds_read_b64_tr_b16 v[102:103], v10 offset:49664
    v_fma_f32 v133, v133, v27, v27
    v_fma_f32 v134, v134, v27, v27
    v_mfma_f32_16x16x32_bf16 v[92:95], a[124:127], v[104:107], v[92:95]
    v_fma_f32 v135, v135, v27, v27
    v_fma_f32 v136, v136, v27, v27
    v_mfma_f32_16x16x32_bf16 v[96:99], a[128:131], v[104:107], v[96:99]
    v_fma_f32 v137, v137, v27, v27
    v_fma_f32 v138, v138, v27, v27
    s_add_u32 s36, s49, 41984
    buffer_load_dwordx4 v[244:247], v31, s[28:31], s36 offen sc1
    s_waitcnt lgkmcnt(4)
    v_mfma_f32_16x16x32_bf16 v[76:79], a[132:135], v[108:111], v[76:79]
    ds_read_b64_tr_b16 v[104:105], v11 offset:49152
    ds_read_b64_tr_b16 v[106:107], v11 offset:49664
    v_fma_f32 v139, v139, v27, v27
    v_mfma_f32_16x16x32_bf16 v[80:83], a[136:139], v[108:111], v[80:83]
    v_rcp_f32 v128, v128
    v_mfma_f32_16x16x32_bf16 v[84:87], a[140:143], v[108:111], v[84:87]
    v_rcp_f32 v129, v129
    s_waitcnt lgkmcnt(4)
    v_mfma_f32_16x16x32_bf16 v[88:91], a[132:135], v[112:115], v[88:91]
    ds_read_b64_tr_b16 v[108:109], v10 offset:50176
    ds_read_b64_tr_b16 v[110:111], v10 offset:50688
    v_rcp_f32 v130, v130
    v_mfma_f32_16x16x32_bf16 v[92:95], a[136:139], v[112:115], v[92:95]
    v_rcp_f32 v131, v131
    v_mfma_f32_16x16x32_bf16 v[96:99], a[140:143], v[112:115], v[96:99]
    v_rcp_f32 v132, v132
    s_add_u32 s36, s49, 43008
    buffer_load_dwordx4 v[248:251], v31, s[28:31], s36 offen sc1
    s_waitcnt lgkmcnt(4)
    v_mfma_f32_16x16x32_bf16 v[76:79], a[144:147], v[100:103], v[76:79]
    ds_read_b64_tr_b16 v[112:113], v11 offset:50176
    ds_read_b64_tr_b16 v[114:115], v11 offset:50688
    v_rcp_f32 v133, v133
    v_mfma_f32_16x16x32_bf16 v[80:83], a[148:151], v[100:103], v[80:83]
    v_mfma_f32_16x16x32_bf16 v[84:87], a[152:155], v[100:103], v[84:87]
    v_rcp_f32 v134, v134
    s_waitcnt lgkmcnt(4)
    v_mfma_f32_16x16x32_bf16 v[88:91], a[144:147], v[104:107], v[88:91]
    ds_read_b64_tr_b16 v[100:101], v10 offset:57344
    ds_read_b64_tr_b16 v[102:103], v10 offset:57856
    v_rcp_f32 v135, v135
    v_mfma_f32_16x16x32_bf16 v[92:95], a[148:151], v[104:107], v[92:95]
    v_rcp_f32 v136, v136
    v_mfma_f32_16x16x32_bf16 v[96:99], a[152:155], v[104:107], v[96:99]
    v_rcp_f32 v137, v137
    s_add_u32 s36, s49, 44032
    buffer_load_dwordx4 v[252:255], v31, s[28:31], s36 offen sc1
    s_waitcnt lgkmcnt(4)
    v_mfma_f32_16x16x32_bf16 v[76:79], a[156:159], v[108:111], v[76:79]
    ds_read_b64_tr_b16 v[104:105], v11 offset:57344
    ds_read_b64_tr_b16 v[106:107], v11 offset:57856
    v_rcp_f32 v138, v138
    v_mfma_f32_16x16x32_bf16 v[80:83], a[160:163], v[108:111], v[80:83]
    v_rcp_f32 v139, v139
    v_mfma_f32_16x16x32_bf16 v[84:87], a[164:167], v[108:111], v[84:87]
    v_mul_f32 v52, v52, v128
    v_mul_f32 v53, v53, v129
    s_waitcnt lgkmcnt(4)
    v_mfma_f32_16x16x32_bf16 v[88:91], a[156:159], v[112:115], v[88:91]
    ds_read_b64_tr_b16 v[108:109], v10 offset:58368
    ds_read_b64_tr_b16 v[110:111], v10 offset:58880
    v_mul_f32 v54, v54, v130
    v_mul_f32 v55, v55, v131
    v_mfma_f32_16x16x32_bf16 v[92:95], a[160:163], v[112:115], v[92:95]
    v_mul_f32 v56, v56, v132
    v_mul_f32 v57, v57, v133
    v_mfma_f32_16x16x32_bf16 v[96:99], a[164:167], v[112:115], v[96:99]
    v_mul_f32 v58, v58, v134
    s_waitcnt lgkmcnt(4)
    v_mfma_f32_16x16x32_bf16 v[76:79], a[168:171], v[100:103], v[76:79]
    ds_read_b64_tr_b16 v[112:113], v11 offset:58368
    ds_read_b64_tr_b16 v[114:115], v11 offset:58880
    v_mul_f32 v59, v59, v135
    v_mul_f32 v60, v60, v136
    v_mfma_f32_16x16x32_bf16 v[80:83], a[172:175], v[100:103], v[80:83]
    v_mul_f32 v61, v61, v137
    v_mul_f32 v62, v62, v138
    v_mfma_f32_16x16x32_bf16 v[84:87], a[176:179], v[100:103], v[84:87]
    v_mul_f32 v63, v63, v139
    v_cvt_pk_bf16_f32 v64, v52, v53
    s_waitcnt lgkmcnt(4)
    v_mfma_f32_16x16x32_bf16 v[88:91], a[168:171], v[104:107], v[88:91]
    v_cvt_pk_bf16_f32 v65, v54, v55
    v_cvt_pk_bf16_f32 v68, v56, v57
    v_mfma_f32_16x16x32_bf16 v[92:95], a[172:175], v[104:107], v[92:95]
    v_cvt_pk_bf16_f32 v69, v58, v59
    v_cvt_pk_bf16_f32 v72, v60, v61
    v_mfma_f32_16x16x32_bf16 v[96:99], a[176:179], v[104:107], v[96:99]
    v_cvt_pk_bf16_f32 v73, v62, v63
    s_waitcnt lgkmcnt(2)
    v_mfma_f32_16x16x32_bf16 v[76:79], a[180:183], v[108:111], v[76:79]
    buffer_store_dwordx2 v[64:65], v12, s[28:31], s52 offen sc1
    buffer_store_dwordx2 v[68:69], v12, s[28:31], s53 offen sc1
    v_mfma_f32_16x16x32_bf16 v[80:83], a[184:187], v[108:111], v[80:83]
    buffer_store_dwordx2 v[72:73], v12, s[28:31], s54 offen sc1
    v_add_u32 v12, 176128, v12
    v_mfma_f32_16x16x32_bf16 v[84:87], a[188:191], v[108:111], v[84:87]
    s_waitcnt lgkmcnt(0)
    v_mfma_f32_16x16x32_bf16 v[88:91], a[180:183], v[112:115], v[88:91]
    v_mfma_f32_16x16x32_bf16 v[92:95], a[184:187], v[112:115], v[92:95]
    v_mfma_f32_16x16x32_bf16 v[96:99], a[188:191], v[112:115], v[96:99]
    ds_read_b32 v22, v17 offset:1032
    ds_read_b32 v24, v18 offset:1032
    ds_read_b64 v[26:27], v20 offset:1024
    s_waitcnt lgkmcnt(0)
    v_pk_fma_f32 v[76:77], v[32:33], v[22:23], v[76:77] op_sel_hi:[1,0,1]
    v_pk_fma_f32 v[78:79], v[34:35], v[22:23], v[78:79] op_sel_hi:[1,0,1]
    v_pk_fma_f32 v[88:89], v[32:33], v[24:25], v[88:89] op_sel_hi:[1,0,1]
    v_pk_fma_f32 v[90:91], v[34:35], v[24:25], v[90:91] op_sel_hi:[1,0,1]
    v_pk_fma_f32 v[80:81], v[36:37], v[22:23], v[80:81] op_sel_hi:[1,0,1]
    v_pk_fma_f32 v[82:83], v[38:39], v[22:23], v[82:83] op_sel_hi:[1,0,1]
    v_pk_fma_f32 v[92:93], v[36:37], v[24:25], v[92:93] op_sel_hi:[1,0,1]
    v_pk_fma_f32 v[94:95], v[38:39], v[24:25], v[94:95] op_sel_hi:[1,0,1]
    v_pk_fma_f32 v[84:85], v[40:41], v[22:23], v[84:85] op_sel_hi:[1,0,1]
    v_pk_fma_f32 v[86:87], v[42:43], v[22:23], v[86:87] op_sel_hi:[1,0,1]
    v_pk_fma_f32 v[96:97], v[40:41], v[24:25], v[96:97] op_sel_hi:[1,0,1]
    v_pk_fma_f32 v[98:99], v[42:43], v[24:25], v[98:99] op_sel_hi:[1,0,1]
    v_permlane32_swap_b32 v76, v88
    v_permlane32_swap_b32 v77, v89
    v_permlane32_swap_b32 v78, v90
    v_permlane32_swap_b32 v79, v91
    v_permlane32_swap_b32 v80, v92
    v_permlane32_swap_b32 v81, v93
    v_permlane32_swap_b32 v82, v94
    v_permlane32_swap_b32 v83, v95
    v_permlane32_swap_b32 v84, v96
    v_permlane32_swap_b32 v85, v97
    v_permlane32_swap_b32 v86, v98
    v_permlane32_swap_b32 v87, v99
    v_pk_mul_f32 v[100:101], v[76:77], v[26:27] op_sel_hi:[1,0]
    v_pk_mul_f32 v[102:103], v[78:79], v[26:27] op_sel_hi:[1,0]
    v_pk_mul_f32 v[104:105], v[80:81], v[26:27] op_sel_hi:[1,0]
    v_pk_mul_f32 v[106:107], v[82:83], v[26:27] op_sel_hi:[1,0]
    v_pk_mul_f32 v[108:109], v[84:85], v[26:27] op_sel_hi:[1,0]
    v_pk_mul_f32 v[110:111], v[86:87], v[26:27] op_sel_hi:[1,0]
    v_exp_f32 v100, v100
    v_exp_f32 v101, v101
    v_exp_f32 v102, v102
    v_exp_f32 v103, v103
    v_exp_f32 v104, v104
    v_exp_f32 v105, v105
    v_exp_f32 v106, v106
    v_exp_f32 v107, v107
    v_exp_f32 v108, v108
    v_exp_f32 v109, v109
    v_exp_f32 v110, v110
    v_exp_f32 v111, v111
    v_pk_mul_f32 v[76:77], v[76:77], v[88:89]
    v_pk_mul_f32 v[78:79], v[78:79], v[90:91]
    v_pk_mul_f32 v[80:81], v[80:81], v[92:93]
    v_pk_mul_f32 v[82:83], v[82:83], v[94:95]
    v_pk_mul_f32 v[84:85], v[84:85], v[96:97]
    v_pk_mul_f32 v[86:87], v[86:87], v[98:99]
    v_pk_fma_f32 v[100:101], v[100:101], v[26:27], v[26:27] op_sel:[0,1,1] op_sel_hi:[1,1,1]
    v_pk_fma_f32 v[102:103], v[102:103], v[26:27], v[26:27] op_sel:[0,1,1] op_sel_hi:[1,1,1]
    v_pk_fma_f32 v[104:105], v[104:105], v[26:27], v[26:27] op_sel:[0,1,1] op_sel_hi:[1,1,1]
    v_pk_fma_f32 v[106:107], v[106:107], v[26:27], v[26:27] op_sel:[0,1,1] op_sel_hi:[1,1,1]
    v_pk_fma_f32 v[108:109], v[108:109], v[26:27], v[26:27] op_sel:[0,1,1] op_sel_hi:[1,1,1]
    v_pk_fma_f32 v[110:111], v[110:111], v[26:27], v[26:27] op_sel:[0,1,1] op_sel_hi:[1,1,1]
    v_rcp_f32 v100, v100
    v_rcp_f32 v101, v101
    v_rcp_f32 v102, v102
    v_rcp_f32 v103, v103
    v_rcp_f32 v104, v104
    v_rcp_f32 v105, v105
    v_rcp_f32 v106, v106
    v_rcp_f32 v107, v107
    v_rcp_f32 v108, v108
    v_rcp_f32 v109, v109
    v_rcp_f32 v110, v110
    v_rcp_f32 v111, v111
    v_pk_mul_f32 v[76:77], v[76:77], v[100:101]
    v_pk_mul_f32 v[78:79], v[78:79], v[102:103]
    v_pk_mul_f32 v[80:81], v[80:81], v[104:105]
    v_pk_mul_f32 v[82:83], v[82:83], v[106:107]
    v_pk_mul_f32 v[84:85], v[84:85], v[108:109]
    v_pk_mul_f32 v[86:87], v[86:87], v[110:111]
    v_cvt_pk_bf16_f32 v88, v76, v77
    v_cvt_pk_bf16_f32 v89, v78, v79
    v_cvt_pk_bf16_f32 v92, v80, v81
    v_cvt_pk_bf16_f32 v93, v82, v83
    v_cvt_pk_bf16_f32 v96, v84, v85
    v_cvt_pk_bf16_f32 v97, v86, v87
    buffer_store_dwordx2 v[88:89], v13, s[28:31], s52 offen sc1
    buffer_store_dwordx2 v[92:93], v13, s[28:31], s53 offen sc1
    buffer_store_dwordx2 v[96:97], v13, s[28:31], s54 offen sc1
    s_add_u32 s36, s3, 5
    v_mov_b32 v2, s36
    v_mov_b32 v3, s64
    s_waitcnt vmcnt(0)
    s_barrier
    s_cmp_lg_u32 s18, 0
    s_cbranch_scc1 sg_10
    s_mov_b64 exec, 1
    s_cmp_eq_u32 s17, 1
    s_cbranch_scc1 ds_11_l
    buffer_store_dword v2, v3, s[28:31], 0 offen sc1
    s_branch ds_11_e
ds_11_l:
    buffer_store_dword v2, v3, s[28:31], 0 offen
ds_11_e:
    s_mov_b64 exec, -1
sg_10:
    s_add_u32 s36, s18, 0
    s_and_b32 s36, s36, 3
    s_lshl_b32 s37, s20, 3
    s_add_u32 s36, s36, s37
    s_lshl_b32 s37, s22, 2
    s_add_u32 s36, s36, s37
    s_mul_i32 s36, s36, 44032
    s_mul_i32 s37, s18, 11264
    s_add_u32 s36, s36, s37
    s_add_u32 s56, s36, 10485760
    s_cmp_eq_u32 s18, 3
    s_cselect_b32 s60, 0x80000000, s56
    s_add_u32 s36, s18, 1
    s_and_b32 s36, s36, 3
    s_lshl_b32 s37, s20, 3
    s_add_u32 s36, s36, s37
    s_lshl_b32 s37, s22, 2
    s_add_u32 s36, s36, s37
    s_mul_i32 s36, s36, 44032
    s_mul_i32 s37, s18, 11264
    s_add_u32 s36, s36, s37
    s_add_u32 s57, s36, 10485760
    s_cmp_eq_u32 s18, 3
    s_cselect_b32 s61, 0x80000000, s57
    s_add_u32 s36, s18, 2
    s_and_b32 s36, s36, 3
    s_lshl_b32 s37, s20, 3
    s_add_u32 s36, s36, s37
    s_lshl_b32 s37, s22, 2
    s_add_u32 s36, s36, s37
    s_mul_i32 s36, s36, 44032
    s_mul_i32 s37, s18, 11264
    s_add_u32 s36, s36, s37
    s_add_u32 s58, s36, 10485760
    s_cmp_eq_u32 s18, 3
    s_cselect_b32 s62, 0x80000000, s58
    s_add_u32 s36, s18, 3
    s_and_b32 s36, s36, 3
    s_lshl_b32 s37, s20, 3
    s_add_u32 s36, s36, s37
    s_lshl_b32 s37, s22, 2
    s_add_u32 s36, s36, s37
    s_mul_i32 s36, s36, 44032
    s_mul_i32 s37, s18, 11264
    s_add_u32 s36, s36, s37
    s_add_u32 s59, s36, 10485760
    s_cmp_eq_u32 s18, 3
    s_cselect_b32 s63, 0x80000000, s59
    s_lshl_b32 s51, s18, 15
    v_lshrrev_b32 v2, 4, v1
    v_and_b32 v3, 15, v1
    v_lshlrev_b32 v8, 7, v2
    v_lshl_add_u32 v8, v3, 3, v8
    v_add_u32 v8, s51, v8
    s_add_u32 s50, s3, s22
    s_add_u32 s50, s50, 4
    s_cmp_lg_u32 s18, 0
    s_cbranch_scc1 ww_12
    v_and_b32 v9, 15, v1
    v_add_u32 v9, 0, v9
    v_lshlrev_b32 v9, 1, v9
    s_lshr_b32 s36, s20, 1
    s_lshl_b32 s36, s36, 5
    s_and_b32 s37, s20, 1
    s_add_u32 s36, s36, s37
    v_add_u32 v9, s36, v9
    v_lshlrev_b32 v9, 6, v9
    v_add_u32 v9, 9961472, v9
    s_mov_b32 s38, 0
    s_nop 0
wf_13:
    buffer_load_dword v116, v9, s[28:31], 0 offen sc1
    s_add_u32 s38, s38, 1
    s_waitcnt vmcnt(0)
    v_subrev_u32 v116, s50, v116
    v_cmp_gt_u32 vcc, 16, v116
    s_cmp_gt_u32 s38, 200000
    s_nop 2
    s_cbranch_scc1 wf_13_x
    s_cmp_eq_u64 vcc, -1
    s_cbranch_scc1 wf_13_x
    s_branch wf_13
wf_13_x:
ww_12:
    s_barrier
    v_add_u32 v10, s56, v31
    v_add_u32 v11, s57, v31
    v_add_u32 v12, s58, v31
    v_add_u32 v13, s59, v31
    s_mov_b32 s56, 0
    s_movk_i32 s57, 4096
    s_movk_i32 s58, 8192
    s_cmp_eq_u32 s18, 3
    s_cselect_b32 s59, 0x80000000, s58
    s_add_u32 m0, s51, 0
    s_nop 0
    buffer_load_dwordx4 v10, s[28:31], s56 offen offset:0 sc1 lds
    s_add_u32 m0, s51, 8192
    s_nop 0
    buffer_load_dwordx4 v11, s[28:31], s56 offen offset:0 sc1 lds
    s_add_u32 m0, s51, 16384
    s_nop 0
    buffer_load_dwordx4 v12, s[28:31], s56 offen offset:0 sc1 lds
    s_add_u32 m0, s51, 24576
    s_nop 0
    buffer_load_dwordx4 v13, s[28:31], s56 offen offset:0 sc1 lds
    s_add_u32 m0, s51, 0
    s_nop 0
    buffer_load_dwordx4 v10, s[28:31], s56 offen offset:1024 sc1 lds
    s_add_u32 m0, s51, 8192
    s_nop 0
    buffer_load_dwordx4 v11, s[28:31], s56 offen offset:1024 sc1 lds
    s_add_u32 m0, s51, 16384
    s_nop 0
    buffer_load_dwordx4 v12, s[28:31], s56 offen offset:1024 sc1 lds
    s_add_u32 m0, s51, 24576
    s_nop 0
    buffer_load_dwordx4 v13, s[28:31], s56 offen offset:1024 sc1 lds
    s_add_u32 m0, s51, 0
    s_nop 0
    buffer_load_dwordx4 v10, s[28:31], s56 offen offset:2048 sc1 lds
    s_add_u32 m0, s51, 8192
    s_nop 0
    buffer_load_dwordx4 v11, s[28:31], s56 offen offset:2048 sc1 lds
    s_add_u32 m0, s51, 16384
    s_nop 0
    buffer_load_dwordx4 v12, s[28:31], s56 offen offset:2048 sc1 lds
    s_add_u32 m0, s51, 24576
    s_nop 0
    buffer_load_dwordx4 v13, s[28:31], s56 offen offset:2048 sc1 lds
    s_add_u32 m0, s51, 0
    s_nop 0
    buffer_load_dwordx4 v10, s[28:31], s56 offen offset:3072 sc1 lds
    s_add_u32 m0, s51, 8192
    s_nop 0
    buffer_load_dwordx4 v11, s[28:31], s56 offen offset:3072 sc1 lds
    s_add_u32 m0, s51, 16384
    s_nop 0
    buffer_load_dwordx4 v12, s[28:31], s56 offen offset:3072 sc1 lds
    s_add_u32 m0, s51, 24576
    s_nop 0
    buffer_load_dwordx4 v13, s[28:31], s56 offen offset:3072 sc1 lds
    s_waitcnt vmcnt(13)
    ds_read_b64 v[116:117], v8 offset:0
    ds_read_b64 v[118:119], v8 offset:512
    ds_read_b64 v[120:121], v8 offset:8192
    ds_read_b64 v[122:123], v8 offset:8704
    ds_read_b64 v[124:125], v8 offset:16384
    ds_read_b64 v[126:127], v8 offset:16896
    v_add_u32 v9, s51, v31
    s_waitcnt lgkmcnt(4)
    v_mfma_f32_16x16x32_bf16 v[52:55], a[192:195], v[116:119], 0
    s_waitcnt vmcnt(12)
    ds_read_b64 v[128:129], v8 offset:24576
    ds_read_b64 v[130:131], v8 offset:25088
    v_mfma_f32_16x16x32_bf16 v[56:59], a[196:199], v[116:119], 0
    s_add_u32 m0, s51, 4096
    v_mfma_f32_16x16x32_bf16 v[60:63], a[200:203], v[116:119], 0
    buffer_load_dwordx4 v10, s[28:31], s57 offen offset:0 sc1 lds
    v_mfma_f32_16x16x32_bf16 v[64:67], a[204:207], v[116:119], 0
    s_waitcnt lgkmcnt(4)
    v_mfma_f32_16x16x32_bf16 v[68:71], a[192:195], v[120:123], 0
    s_waitcnt vmcnt(12)
    ds_read_b64 v[116:117], v8 offset:1024
    ds_read_b64 v[118:119], v8 offset:1536
    v_mfma_f32_16x16x32_bf16 v[72:75], a[196:199], v[120:123], 0
    s_add_u32 m0, s51, 12288
    v_mfma_f32_16x16x32_bf16 v[76:79], a[200:203], v[120:123], 0
    buffer_load_dwordx4 v11, s[28:31], s57 offen offset:0 sc1 lds
    v_mfma_f32_16x16x32_bf16 v[80:83], a[204:207], v[120:123], 0
    s_waitcnt lgkmcnt(4)
    v_mfma_f32_16x16x32_bf16 v[84:87], a[192:195], v[124:127], 0
    s_waitcnt vmcnt(12)
    ds_read_b64 v[120:121], v8 offset:9216
    ds_read_b64 v[122:123], v8 offset:9728
    v_mfma_f32_16x16x32_bf16 v[88:91], a[196:199], v[124:127], 0
    s_add_u32 m0, s51, 20480
    v_mfma_f32_16x16x32_bf16 v[92:95], a[200:203], v[124:127], 0
    buffer_load_dwordx4 v12, s[28:31], s57 offen offset:0 sc1 lds
    v_mfma_f32_16x16x32_bf16 v[96:99], a[204:207], v[124:127], 0
    s_waitcnt lgkmcnt(4)
    v_mfma_f32_16x16x32_bf16 v[100:103], a[192:195], v[128:131], 0
    s_waitcnt vmcnt(12)
    ds_read_b64 v[124:125], v8 offset:17408
    ds_read_b64 v[126:127], v8 offset:17920
    v_mfma_f32_16x16x32_bf16 v[104:107], a[196:199], v[128:131], 0
    s_add_u32 m0, s51, 28672
    v_mfma_f32_16x16x32_bf16 v[108:111], a[200:203], v[128:131], 0
    buffer_load_dwordx4 v13, s[28:31], s57 offen offset:0 sc1 lds
    v_mfma_f32_16x16x32_bf16 v[112:115], a[204:207], v[128:131], 0
    s_waitcnt lgkmcnt(4)
    v_mfma_f32_16x16x32_bf16 v[52:55], a[208:211], v[116:119], v[52:55]
    s_waitcnt vmcnt(12)
    ds_read_b64 v[128:129], v8 offset:25600
    ds_read_b64 v[130:131], v8 offset:26112
    v_mfma_f32_16x16x32_bf16 v[56:59], a[212:215], v[116:119], v[56:59]
    s_add_u32 m0, s51, 4096
    v_mfma_f32_16x16x32_bf16 v[60:63], a[216:219], v[116:119], v[60:63]
    buffer_load_dwordx4 v10, s[28:31], s57 offen offset:1024 sc1 lds
    v_mfma_f32_16x16x32_bf16 v[64:67], a[220:223], v[116:119], v[64:67]
    s_waitcnt lgkmcnt(4)
    v_mfma_f32_16x16x32_bf16 v[68:71], a[208:211], v[120:123], v[68:71]
    s_waitcnt vmcnt(12)
    ds_read_b64 v[116:117], v8 offset:2048
    ds_read_b64 v[118:119], v8 offset:2560
    v_mfma_f32_16x16x32_bf16 v[72:75], a[212:215], v[120:123], v[72:75]
    s_add_u32 m0, s51, 12288
    v_mfma_f32_16x16x32_bf16 v[76:79], a[216:219], v[120:123], v[76:79]
    buffer_load_dwordx4 v11, s[28:31], s57 offen offset:1024 sc1 lds
    v_mfma_f32_16x16x32_bf16 v[80:83], a[220:223], v[120:123], v[80:83]
    s_waitcnt lgkmcnt(4)
    v_mfma_f32_16x16x32_bf16 v[84:87], a[208:211], v[124:127], v[84:87]
    s_waitcnt vmcnt(12)
    ds_read_b64 v[120:121], v8 offset:10240
    ds_read_b64 v[122:123], v8 offset:10752
    v_mfma_f32_16x16x32_bf16 v[88:91], a[212:215], v[124:127], v[88:91]
    s_add_u32 m0, s51, 20480
    v_mfma_f32_16x16x32_bf16 v[92:95], a[216:219], v[124:127], v[92:95]
    buffer_load_dwordx4 v12, s[28:31], s57 offen offset:1024 sc1 lds
    v_mfma_f32_16x16x32_bf16 v[96:99], a[220:223], v[124:127], v[96:99]
    s_waitcnt lgkmcnt(4)
    v_mfma_f32_16x16x32_bf16 v[100:103], a[208:211], v[128:131], v[100:103]
    s_waitcnt vmcnt(12)
    ds_read_b64 v[124:125], v8 offset:18432
    ds_read_b64 v[126:127], v8 offset:18944
    v_mfma_f32_16x16x32_bf16 v[104:107], a[212:215], v[128:131], v[104:107]
    s_add_u32 m0, s51, 28672
    v_mfma_f32_16x16x32_bf16 v[108:111], a[216:219], v[128:131], v[108:111]
    buffer_load_dwordx4 v13, s[28:31], s57 offen offset:1024 sc1 lds
    v_mfma_f32_16x16x32_bf16 v[112:115], a[220:223], v[128:131], v[112:115]
    s_waitcnt lgkmcnt(4)
    v_mfma_f32_16x16x32_bf16 v[52:55], a[224:227], v[116:119], v[52:55]
    s_waitcnt vmcnt(12)
    ds_read_b64 v[128:129], v8 offset:26624
    ds_read_b64 v[130:131], v8 offset:27136
    v_mfma_f32_16x16x32_bf16 v[56:59], a[228:231], v[116:119], v[56:59]
    s_add_u32 m0, s51, 4096
    v_mfma_f32_16x16x32_bf16 v[60:63], a[232:235], v[116:119], v[60:63]
    buffer_load_dwordx4 v10, s[28:31], s57 offen offset:2048 sc1 lds
    v_mfma_f32_16x16x32_bf16 v[64:67], a[236:239], v[116:119], v[64:67]
    s_waitcnt lgkmcnt(4)
    v_mfma_f32_16x16x32_bf16 v[68:71], a[224:227], v[120:123], v[68:71]
    s_waitcnt vmcnt(12)
    ds_read_b64 v[116:117], v8 offset:3072
    ds_read_b64 v[118:119], v8 offset:3584
    v_mfma_f32_16x16x32_bf16 v[72:75], a[228:231], v[120:123], v[72:75]
    s_add_u32 m0, s51, 12288
    v_mfma_f32_16x16x32_bf16 v[76:79], a[232:235], v[120:123], v[76:79]
    buffer_load_dwordx4 v11, s[28:31], s57 offen offset:2048 sc1 lds
    v_mfma_f32_16x16x32_bf16 v[80:83], a[236:239], v[120:123], v[80:83]
    s_waitcnt lgkmcnt(4)
    v_mfma_f32_16x16x32_bf16 v[84:87], a[224:227], v[124:127], v[84:87]
    s_waitcnt vmcnt(12)
    ds_read_b64 v[120:121], v8 offset:11264
    ds_read_b64 v[122:123], v8 offset:11776
    v_mfma_f32_16x16x32_bf16 v[88:91], a[228:231], v[124:127], v[88:91]
    s_add_u32 m0, s51, 20480
    v_mfma_f32_16x16x32_bf16 v[92:95], a[232:235], v[124:127], v[92:95]
    buffer_load_dwordx4 v12, s[28:31], s57 offen offset:2048 sc1 lds
    v_mfma_f32_16x16x32_bf16 v[96:99], a[236:239], v[124:127], v[96:99]
    s_waitcnt lgkmcnt(4)
    v_mfma_f32_16x16x32_bf16 v[100:103], a[224:227], v[128:131], v[100:103]
    s_waitcnt vmcnt(12)
    ds_read_b64 v[124:125], v8 offset:19456
    ds_read_b64 v[126:127], v8 offset:19968
    v_mfma_f32_16x16x32_bf16 v[104:107], a[228:231], v[128:131], v[104:107]
    s_add_u32 m0, s51, 28672
    v_mfma_f32_16x16x32_bf16 v[108:111], a[232:235], v[128:131], v[108:111]
    buffer_load_dwordx4 v13, s[28:31], s57 offen offset:2048 sc1 lds
    v_mfma_f32_16x16x32_bf16 v[112:115], a[236:239], v[128:131], v[112:115]
    s_waitcnt lgkmcnt(4)
    v_mfma_f32_16x16x32_bf16 v[52:55], a[240:243], v[116:119], v[52:55]
    s_waitcnt vmcnt(12)
    ds_read_b64 v[128:129], v8 offset:27648
    ds_read_b64 v[130:131], v8 offset:28160
    v_mfma_f32_16x16x32_bf16 v[56:59], a[244:247], v[116:119], v[56:59]
    s_add_u32 m0, s51, 4096
    v_mfma_f32_16x16x32_bf16 v[60:63], a[248:251], v[116:119], v[60:63]
    buffer_load_dwordx4 v10, s[28:31], s57 offen offset:3072 sc1 lds
    v_mfma_f32_16x16x32_bf16 v[64:67], a[252:255], v[116:119], v[64:67]
    s_waitcnt lgkmcnt(4)
    v_mfma_f32_16x16x32_bf16 v[68:71], a[240:243], v[120:123], v[68:71]
    s_waitcnt vmcnt(12)
    ds_read_b64 v[116:117], v8 offset:4096
    ds_read_b64 v[118:119], v8 offset:4608
    v_mfma_f32_16x16x32_bf16 v[72:75], a[244:247], v[120:123], v[72:75]
    s_add_u32 m0, s51, 12288
    v_mfma_f32_16x16x32_bf16 v[76:79], a[248:251], v[120:123], v[76:79]
    buffer_load_dwordx4 v11, s[28:31], s57 offen offset:3072 sc1 lds
    v_mfma_f32_16x16x32_bf16 v[80:83], a[252:255], v[120:123], v[80:83]
    s_waitcnt lgkmcnt(4)
    v_mfma_f32_16x16x32_bf16 v[84:87], a[240:243], v[124:127], v[84:87]
    s_waitcnt vmcnt(12)
    ds_read_b64 v[120:121], v8 offset:12288
    ds_read_b64 v[122:123], v8 offset:12800
    v_mfma_f32_16x16x32_bf16 v[88:91], a[244:247], v[124:127], v[88:91]
    s_add_u32 m0, s51, 20480
    v_mfma_f32_16x16x32_bf16 v[92:95], a[248:251], v[124:127], v[92:95]
    buffer_load_dwordx4 v12, s[28:31], s57 offen offset:3072 sc1 lds
    v_mfma_f32_16x16x32_bf16 v[96:99], a[252:255], v[124:127], v[96:99]
    s_waitcnt lgkmcnt(4)
    v_mfma_f32_16x16x32_bf16 v[100:103], a[240:243], v[128:131], v[100:103]
    s_waitcnt vmcnt(12)
    ds_read_b64 v[124:125], v8 offset:20480
    ds_read_b64 v[126:127], v8 offset:20992
    v_mfma_f32_16x16x32_bf16 v[104:107], a[244:247], v[128:131], v[104:107]
    s_add_u32 m0, s51, 28672
    v_mfma_f32_16x16x32_bf16 v[108:111], a[248:251], v[128:131], v[108:111]
    buffer_load_dwordx4 v13, s[28:31], s57 offen offset:3072 sc1 lds
    v_mfma_f32_16x16x32_bf16 v[112:115], a[252:255], v[128:131], v[112:115]
    s_waitcnt lgkmcnt(4)
    v_mfma_f32_16x16x32_bf16 v[52:55], v[144:147], v[116:119], v[52:55]
    s_waitcnt vmcnt(12)
    ds_read_b64 v[128:129], v8 offset:28672
    ds_read_b64 v[130:131], v8 offset:29184
    v_mfma_f32_16x16x32_bf16 v[56:59], v[148:151], v[116:119], v[56:59]
    s_add_u32 m0, s51, 0
    v_mfma_f32_16x16x32_bf16 v[60:63], v[152:155], v[116:119], v[60:63]
    buffer_load_dwordx4 v10, s[28:31], s58 offen offset:0 sc1 lds
    v_mfma_f32_16x16x32_bf16 v[64:67], v[156:159], v[116:119], v[64:67]
    s_waitcnt lgkmcnt(4)
    v_mfma_f32_16x16x32_bf16 v[68:71], v[144:147], v[120:123], v[68:71]
    s_waitcnt vmcnt(12)
    ds_read_b64 v[116:117], v8 offset:5120
    ds_read_b64 v[118:119], v8 offset:5632
    v_mfma_f32_16x16x32_bf16 v[72:75], v[148:151], v[120:123], v[72:75]
    s_add_u32 m0, s51, 8192
    v_mfma_f32_16x16x32_bf16 v[76:79], v[152:155], v[120:123], v[76:79]
    buffer_load_dwordx4 v11, s[28:31], s58 offen offset:0 sc1 lds
    v_mfma_f32_16x16x32_bf16 v[80:83], v[156:159], v[120:123], v[80:83]
    s_waitcnt lgkmcnt(4)
    v_mfma_f32_16x16x32_bf16 v[84:87], v[144:147], v[124:127], v[84:87]
    s_waitcnt vmcnt(12)
    ds_read_b64 v[120:121], v8 offset:13312
    ds_read_b64 v[122:123], v8 offset:13824
    v_mfma_f32_16x16x32_bf16 v[88:91], v[148:151], v[124:127], v[88:91]
    s_add_u32 m0, s51, 16384
    v_mfma_f32_16x16x32_bf16 v[92:95], v[152:155], v[124:127], v[92:95]
    buffer_load_dwordx4 v12, s[28:31], s58 offen offset:0 sc1 lds
    v_mfma_f32_16x16x32_bf16 v[96:99], v[156:159], v[124:127], v[96:99]
    s_waitcnt lgkmcnt(4)
    v_mfma_f32_16x16x32_bf16 v[100:103], v[144:147], v[128:131], v[100:103]
    s_waitcnt vmcnt(12)
    ds_read_b64 v[124:125], v8 offset:21504
    ds_read_b64 v[126:127], v8 offset:22016
    v_mfma_f32_16x16x32_bf16 v[104:107], v[148:151], v[128:131], v[104:107]
    s_add_u32 m0, s51, 24576
    v_mfma_f32_16x16x32_bf16 v[108:111], v[152:155], v[128:131], v[108:111]
    buffer_load_dwordx4 v13, s[28:31], s58 offen offset:0 sc1 lds
    v_mfma_f32_16x16x32_bf16 v[112:115], v[156:159], v[128:131], v[112:115]
    s_waitcnt lgkmcnt(4)
    v_mfma_f32_16x16x32_bf16 v[52:55], v[160:163], v[116:119], v[52:55]
    s_waitcnt vmcnt(12)
    ds_read_b64 v[128:129], v8 offset:29696
    ds_read_b64 v[130:131], v8 offset:30208
    v_mfma_f32_16x16x32_bf16 v[56:59], v[164:167], v[116:119], v[56:59]
    s_add_u32 m0, s51, 0
    v_mfma_f32_16x16x32_bf16 v[60:63], v[168:171], v[116:119], v[60:63]
    buffer_load_dwordx4 v10, s[28:31], s58 offen offset:1024 sc1 lds
    v_mfma_f32_16x16x32_bf16 v[64:67], v[172:175], v[116:119], v[64:67]
    s_waitcnt lgkmcnt(4)
    v_mfma_f32_16x16x32_bf16 v[68:71], v[160:163], v[120:123], v[68:71]
    s_waitcnt vmcnt(12)
    ds_read_b64 v[116:117], v8 offset:6144
    ds_read_b64 v[118:119], v8 offset:6656
    v_mfma_f32_16x16x32_bf16 v[72:75], v[164:167], v[120:123], v[72:75]
    s_add_u32 m0, s51, 8192
    v_mfma_f32_16x16x32_bf16 v[76:79], v[168:171], v[120:123], v[76:79]
    buffer_load_dwordx4 v11, s[28:31], s58 offen offset:1024 sc1 lds
    v_mfma_f32_16x16x32_bf16 v[80:83], v[172:175], v[120:123], v[80:83]
    s_waitcnt lgkmcnt(4)
    v_mfma_f32_16x16x32_bf16 v[84:87], v[160:163], v[124:127], v[84:87]
    s_waitcnt vmcnt(12)
    ds_read_b64 v[120:121], v8 offset:14336
    ds_read_b64 v[122:123], v8 offset:14848
    v_mfma_f32_16x16x32_bf16 v[88:91], v[164:167], v[124:127], v[88:91]
    s_add_u32 m0, s51, 16384
    v_mfma_f32_16x16x32_bf16 v[92:95], v[168:171], v[124:127], v[92:95]
    buffer_load_dwordx4 v12, s[28:31], s58 offen offset:1024 sc1 lds
    v_mfma_f32_16x16x32_bf16 v[96:99], v[172:175], v[124:127], v[96:99]
    s_waitcnt lgkmcnt(4)
    v_mfma_f32_16x16x32_bf16 v[100:103], v[160:163], v[128:131], v[100:103]
    s_waitcnt vmcnt(12)
    ds_read_b64 v[124:125], v8 offset:22528
    ds_read_b64 v[126:127], v8 offset:23040
    v_mfma_f32_16x16x32_bf16 v[104:107], v[164:167], v[128:131], v[104:107]
    s_add_u32 m0, s51, 24576
    v_mfma_f32_16x16x32_bf16 v[108:111], v[168:171], v[128:131], v[108:111]
    buffer_load_dwordx4 v13, s[28:31], s58 offen offset:1024 sc1 lds
    v_mfma_f32_16x16x32_bf16 v[112:115], v[172:175], v[128:131], v[112:115]
    s_waitcnt lgkmcnt(4)
    v_mfma_f32_16x16x32_bf16 v[52:55], v[176:179], v[116:119], v[52:55]
    s_waitcnt vmcnt(12)
    ds_read_b64 v[128:129], v8 offset:30720
    ds_read_b64 v[130:131], v8 offset:31232
    v_mfma_f32_16x16x32_bf16 v[56:59], v[180:183], v[116:119], v[56:59]
    s_add_u32 m0, s51, 0
    v_mfma_f32_16x16x32_bf16 v[60:63], v[184:187], v[116:119], v[60:63]
    buffer_load_dwordx4 v10, s[28:31], s59 offen offset:2048 sc1 lds
    v_mfma_f32_16x16x32_bf16 v[64:67], v[188:191], v[116:119], v[64:67]
    s_waitcnt lgkmcnt(4)
    v_mfma_f32_16x16x32_bf16 v[68:71], v[176:179], v[120:123], v[68:71]
    s_waitcnt vmcnt(12)
    ds_read_b64 v[116:117], v8 offset:7168
    ds_read_b64 v[118:119], v8 offset:7680
    v_mfma_f32_16x16x32_bf16 v[72:75], v[180:183], v[120:123], v[72:75]
    s_add_u32 m0, s51, 8192
    v_mfma_f32_16x16x32_bf16 v[76:79], v[184:187], v[120:123], v[76:79]
    buffer_load_dwordx4 v11, s[28:31], s59 offen offset:2048 sc1 lds
    v_mfma_f32_16x16x32_bf16 v[80:83], v[188:191], v[120:123], v[80:83]
    s_waitcnt lgkmcnt(4)
    v_mfma_f32_16x16x32_bf16 v[84:87], v[176:179], v[124:127], v[84:87]
    s_waitcnt vmcnt(12)
    ds_read_b64 v[120:121], v8 offset:15360
    ds_read_b64 v[122:123], v8 offset:15872
    v_mfma_f32_16x16x32_bf16 v[88:91], v[180:183], v[124:127], v[88:91]
    s_add_u32 m0, s51, 16384
    v_mfma_f32_16x16x32_bf16 v[92:95], v[184:187], v[124:127], v[92:95]
    buffer_load_dwordx4 v12, s[28:31], s59 offen offset:2048 sc1 lds
    v_mfma_f32_16x16x32_bf16 v[96:99], v[188:191], v[124:127], v[96:99]
    s_waitcnt lgkmcnt(4)
    v_mfma_f32_16x16x32_bf16 v[100:103], v[176:179], v[128:131], v[100:103]
    s_waitcnt vmcnt(12)
    ds_read_b64 v[124:125], v8 offset:23552
    ds_read_b64 v[126:127], v8 offset:24064
    v_mfma_f32_16x16x32_bf16 v[104:107], v[180:183], v[128:131], v[104:107]
    s_add_u32 m0, s51, 24576
    v_mfma_f32_16x16x32_bf16 v[108:111], v[184:187], v[128:131], v[108:111]
    buffer_load_dwordx4 v13, s[28:31], s59 offen offset:2048 sc1 lds
    v_mfma_f32_16x16x32_bf16 v[112:115], v[188:191], v[128:131], v[112:115]
    s_waitcnt lgkmcnt(4)
    v_mfma_f32_16x16x32_bf16 v[52:55], v[192:195], v[116:119], v[52:55]
    s_waitcnt vmcnt(12)
    ds_read_b64 v[128:129], v8 offset:31744
    ds_read_b64 v[130:131], v8 offset:32256
    v_mfma_f32_16x16x32_bf16 v[56:59], v[196:199], v[116:119], v[56:59]
    v_mfma_f32_16x16x32_bf16 v[60:63], v[200:203], v[116:119], v[60:63]
    v_mfma_f32_16x16x32_bf16 v[64:67], v[204:207], v[116:119], v[64:67]
    s_waitcnt lgkmcnt(4)
    v_mfma_f32_16x16x32_bf16 v[68:71], v[192:195], v[120:123], v[68:71]
    s_waitcnt vmcnt(11)
    ds_read_b64 v[116:117], v8 offset:0
    ds_read_b64 v[118:119], v8 offset:512
    v_mfma_f32_16x16x32_bf16 v[72:75], v[196:199], v[120:123], v[72:75]
    v_mfma_f32_16x16x32_bf16 v[76:79], v[200:203], v[120:123], v[76:79]
    v_mfma_f32_16x16x32_bf16 v[80:83], v[204:207], v[120:123], v[80:83]
    s_waitcnt lgkmcnt(4)
    v_mfma_f32_16x16x32_bf16 v[84:87], v[192:195], v[124:127], v[84:87]
    s_waitcnt vmcnt(10)
    ds_read_b64 v[120:121], v8 offset:8192
    ds_read_b64 v[122:123], v8 offset:8704
    v_mfma_f32_16x16x32_bf16 v[88:91], v[196:199], v[124:127], v[88:91]
    v_mfma_f32_16x16x32_bf16 v[92:95], v[200:203], v[124:127], v[92:95]
    v_mfma_f32_16x16x32_bf16 v[96:99], v[204:207], v[124:127], v[96:99]
    s_waitcnt lgkmcnt(4)
    v_mfma_f32_16x16x32_bf16 v[100:103], v[192:195], v[128:131], v[100:103]
    s_waitcnt vmcnt(9)
    ds_read_b64 v[124:125], v8 offset:16384
    ds_read_b64 v[126:127], v8 offset:16896
    v_mfma_f32_16x16x32_bf16 v[104:107], v[196:199], v[128:131], v[104:107]
    v_mfma_f32_16x16x32_bf16 v[108:111], v[200:203], v[128:131], v[108:111]
    v_mfma_f32_16x16x32_bf16 v[112:115], v[204:207], v[128:131], v[112:115]
    s_waitcnt lgkmcnt(4)
    v_mfma_f32_16x16x32_bf16 v[52:55], v[208:211], v[116:119], v[52:55]
    s_waitcnt vmcnt(8)
    ds_read_b64 v[128:129], v8 offset:24576
    ds_read_b64 v[130:131], v8 offset:25088
    v_mfma_f32_16x16x32_bf16 v[56:59], v[212:215], v[116:119], v[56:59]
    v_mfma_f32_16x16x32_bf16 v[60:63], v[216:219], v[116:119], v[60:63]
    v_mfma_f32_16x16x32_bf16 v[64:67], v[220:223], v[116:119], v[64:67]
    s_waitcnt lgkmcnt(4)
    v_mfma_f32_16x16x32_bf16 v[68:71], v[208:211], v[120:123], v[68:71]
    s_waitcnt vmcnt(7)
    ds_read_b64 v[116:117], v8 offset:1024
    ds_read_b64 v[118:119], v8 offset:1536
    v_mfma_f32_16x16x32_bf16 v[72:75], v[212:215], v[120:123], v[72:75]
    v_mfma_f32_16x16x32_bf16 v[76:79], v[216:219], v[120:123], v[76:79]
    v_mfma_f32_16x16x32_bf16 v[80:83], v[220:223], v[120:123], v[80:83]
    s_waitcnt lgkmcnt(4)
    v_mfma_f32_16x16x32_bf16 v[84:87], v[208:211], v[124:127], v[84:87]
    s_waitcnt vmcnt(6)
    ds_read_b64 v[120:121], v8 offset:9216
    ds_read_b64 v[122:123], v8 offset:9728
    v_mfma_f32_16x16x32_bf16 v[88:91], v[212:215], v[124:127], v[88:91]
    v_mfma_f32_16x16x32_bf16 v[92:95], v[216:219], v[124:127], v[92:95]
    v_mfma_f32_16x16x32_bf16 v[96:99], v[220:223], v[124:127], v[96:99]
    s_waitcnt lgkmcnt(4)
    v_mfma_f32_16x16x32_bf16 v[100:103], v[208:211], v[128:131], v[100:103]
    s_waitcnt vmcnt(5)
    ds_read_b64 v[124:125], v8 offset:17408
    ds_read_b64 v[126:127], v8 offset:17920
    v_mfma_f32_16x16x32_bf16 v[104:107], v[212:215], v[128:131], v[104:107]
    v_mfma_f32_16x16x32_bf16 v[108:111], v[216:219], v[128:131], v[108:111]
    v_mfma_f32_16x16x32_bf16 v[112:115], v[220:223], v[128:131], v[112:115]
    s_waitcnt lgkmcnt(4)
    v_mfma_f32_16x16x32_bf16 v[52:55], v[224:227], v[116:119], v[52:55]
    s_waitcnt vmcnt(4)
    ds_read_b64 v[128:129], v8 offset:25600
    ds_read_b64 v[130:131], v8 offset:26112
    v_mfma_f32_16x16x32_bf16 v[56:59], v[228:231], v[116:119], v[56:59]
    v_mfma_f32_16x16x32_bf16 v[60:63], v[232:235], v[116:119], v[60:63]
    v_mfma_f32_16x16x32_bf16 v[64:67], v[236:239], v[116:119], v[64:67]
    s_waitcnt lgkmcnt(4)
    v_mfma_f32_16x16x32_bf16 v[68:71], v[224:227], v[120:123], v[68:71]
    s_waitcnt vmcnt(2)
    ds_read_b64 v[116:117], v8 offset:10240
    ds_read_b64 v[118:119], v8 offset:10752
    v_mfma_f32_16x16x32_bf16 v[72:75], v[228:231], v[120:123], v[72:75]
    v_mfma_f32_16x16x32_bf16 v[76:79], v[232:235], v[120:123], v[76:79]
    v_mfma_f32_16x16x32_bf16 v[80:83], v[236:239], v[120:123], v[80:83]
    s_waitcnt lgkmcnt(4)
    v_mfma_f32_16x16x32_bf16 v[84:87], v[224:227], v[124:127], v[84:87]
    s_waitcnt vmcnt(1)
    ds_read_b64 v[120:121], v8 offset:18432
    ds_read_b64 v[122:123], v8 offset:18944
    v_mfma_f32_16x16x32_bf16 v[88:91], v[228:231], v[124:127], v[88:91]
    v_mfma_f32_16x16x32_bf16 v[92:95], v[232:235], v[124:127], v[92:95]
    v_mfma_f32_16x16x32_bf16 v[96:99], v[236:239], v[124:127], v[96:99]
    s_waitcnt lgkmcnt(4)
    v_mfma_f32_16x16x32_bf16 v[100:103], v[224:227], v[128:131], v[100:103]
    s_waitcnt vmcnt(0)
    ds_read_b64 v[124:125], v8 offset:26624
    ds_read_b64 v[126:127], v8 offset:27136
    v_mfma_f32_16x16x32_bf16 v[104:107], v[228:231], v[128:131], v[104:107]
    v_mfma_f32_16x16x32_bf16 v[108:111], v[232:235], v[128:131], v[108:111]
    v_mfma_f32_16x16x32_bf16 v[112:115], v[236:239], v[128:131], v[112:115]
    s_waitcnt lgkmcnt(4)
    v_mfma_f32_16x16x32_bf16 v[68:71], v[240:243], v[116:119], v[68:71]
    ds_read_b64 v[128:129], v8 offset:2048
    ds_read_b64 v[130:131], v8 offset:2560
    v_mfma_f32_16x16x32_bf16 v[72:75], v[244:247], v[116:119], v[72:75]
    v_mfma_f32_16x16x32_bf16 v[76:79], v[248:251], v[116:119], v[76:79]
    v_mfma_f32_16x16x32_bf16 v[80:83], v[252:255], v[116:119], v[80:83]
    s_waitcnt lgkmcnt(4)
    v_mfma_f32_16x16x32_bf16 v[84:87], v[240:243], v[120:123], v[84:87]
    v_mfma_f32_16x16x32_bf16 v[88:91], v[244:247], v[120:123], v[88:91]
    v_mfma_f32_16x16x32_bf16 v[92:95], v[248:251], v[120:123], v[92:95]
    v_mfma_f32_16x16x32_bf16 v[96:99], v[252:255], v[120:123], v[96:99]
    s_waitcnt lgkmcnt(2)
    v_mfma_f32_16x16x32_bf16 v[100:103], v[240:243], v[124:127], v[100:103]
    v_mfma_f32_16x16x32_bf16 v[104:107], v[244:247], v[124:127], v[104:107]
    v_mfma_f32_16x16x32_bf16 v[108:111], v[248:251], v[124:127], v[108:111]
    v_mfma_f32_16x16x32_bf16 v[112:115], v[252:255], v[124:127], v[112:115]
    ds_write_b128 v9, v[68:71] offset:0
    ds_write_b128 v9, v[72:75] offset:1024
    ds_write_b128 v9, v[76:79] offset:2048
    ds_write_b128 v9, v[80:83] offset:3072
    s_waitcnt lgkmcnt(4)
    v_mfma_f32_16x16x32_bf16 v[52:55], v[240:243], v[128:131], v[52:55]
    v_mfma_f32_16x16x32_bf16 v[56:59], v[244:247], v[128:131], v[56:59]
    v_mfma_f32_16x16x32_bf16 v[60:63], v[248:251], v[128:131], v[60:63]
    v_mfma_f32_16x16x32_bf16 v[64:67], v[252:255], v[128:131], v[64:67]
    ds_write_b128 v9, v[84:87] offset:4096
    ds_write_b128 v9, v[88:91] offset:5120
    ds_write_b128 v9, v[92:95] offset:6144
    ds_write_b128 v9, v[96:99] offset:7168
    ds_write_b128 v9, v[100:103] offset:8192
    ds_write_b128 v9, v[104:107] offset:9216
    ds_write_b128 v9, v[108:111] offset:10240
    ds_write_b128 v9, v[112:115] offset:11264
    s_sub_u32 s36, s18, 1
    s_and_b32 s36, s36, 3
    s_lshl_b32 s36, s36, 15
    v_add_u32 v10, s36, v31
    s_sub_u32 s36, s18, 2
    s_and_b32 s36, s36, 3
    s_lshl_b32 s36, s36, 15
    v_add_u32 v11, s36, v31
    s_sub_u32 s36, s18, 3
    s_and_b32 s36, s36, 3
    s_lshl_b32 s36, s36, 15
    v_add_u32 v12, s36, v31
    s_waitcnt lgkmcnt(0)
    s_barrier
    ds_read_b128 v[68:71], v10 offset:0
    ds_read_b128 v[72:75], v10 offset:1024
    ds_read_b128 v[76:79], v10 offset:2048
    ds_read_b128 v[80:83], v10 offset:3072
    ds_read_b128 v[84:87], v11 offset:4096
    ds_read_b128 v[88:91], v11 offset:5120
    ds_read_b128 v[92:95], v11 offset:6144
    ds_read_b128 v[96:99], v11 offset:7168
    ds_read_b128 v[100:103], v12 offset:8192
    ds_read_b128 v[104:107], v12 offset:9216
    ds_read_b128 v[108:111], v12 offset:10240
    ds_read_b128 v[112:115], v12 offset:11264
    v_bfe_u32 v4, v1, 2, 2
    v_lshl_add_u32 v4, v2, 4, v4
    v_lshlrev_b32 v4, 7, v4
    v_and_b32 v5, 3, v1
    v_lshl_add_u32 v4, v5, 3, v4
    s_lshl_b32 s36, s18, 5
    s_add_u32 s36, s36, 131072
    v_add_u32 v4, s36, v4
    ds_read_b64_tr_b16 v[116:117], v4 offset:0
    ds_read_b64_tr_b16 v[118:119], v4 offset:512
    ds_read_b64_tr_b16 v[120:121], v4 offset:1024
    ds_read_b64_tr_b16 v[122:123], v4 offset:1536
    ds_read_b64_tr_b16 v[124:125], v4 offset:8192
    ds_read_b64_tr_b16 v[126:127], v4 offset:8704
    ds_read_b64_tr_b16 v[128:129], v4 offset:9216
    ds_read_b64_tr_b16 v[130:131], v4 offset:9728
    s_waitcnt lgkmcnt(15)
    v_pk_add_f32 v[52:53], v[52:53], v[68:69]
    v_pk_add_f32 v[54:55], v[54:55], v[70:71]
    v_pk_add_f32 v[56:57], v[56:57], v[72:73]
    v_pk_add_f32 v[58:59], v[58:59], v[74:75]
    v_pk_add_f32 v[60:61], v[60:61], v[76:77]
    v_pk_add_f32 v[62:63], v[62:63], v[78:79]
    v_pk_add_f32 v[64:65], v[64:65], v[80:81]
    v_pk_add_f32 v[66:67], v[66:67], v[82:83]
    s_waitcnt lgkmcnt(12)
    v_pk_add_f32 v[52:53], v[52:53], v[84:85]
    v_pk_add_f32 v[54:55], v[54:55], v[86:87]
    v_pk_add_f32 v[56:57], v[56:57], v[88:89]
    v_pk_add_f32 v[58:59], v[58:59], v[90:91]
    v_pk_add_f32 v[60:61], v[60:61], v[92:93]
    v_pk_add_f32 v[62:63], v[62:63], v[94:95]
    v_pk_add_f32 v[64:65], v[64:65], v[96:97]
    v_pk_add_f32 v[66:67], v[66:67], v[98:99]
    s_waitcnt lgkmcnt(8)
    v_pk_add_f32 v[52:53], v[52:53], v[100:101]
    v_pk_add_f32 v[54:55], v[54:55], v[102:103]
    v_pk_add_f32 v[56:57], v[56:57], v[104:105]
    v_pk_add_f32 v[58:59], v[58:59], v[106:107]
    v_pk_add_f32 v[60:61], v[60:61], v[108:109]
    v_pk_add_f32 v[62:63], v[62:63], v[110:111]
    v_pk_add_f32 v[64:65], v[64:65], v[112:113]
    v_pk_add_f32 v[66:67], v[66:67], v[114:115]
    s_waitcnt lgkmcnt(0)
    v_lshlrev_b32 v68, 16, v116
    v_and_b32 v69, 0xffff0000, v116
    v_lshlrev_b32 v70, 16, v117
    v_and_b32 v71, 0xffff0000, v117
    v_lshlrev_b32 v72, 16, v118
    v_and_b32 v73, 0xffff0000, v118
    v_lshlrev_b32 v74, 16, v119
    v_and_b32 v75, 0xffff0000, v119
    v_lshlrev_b32 v76, 16, v120
    v_and_b32 v77, 0xffff0000, v120
    v_lshlrev_b32 v78, 16, v121
    v_and_b32 v79, 0xffff0000, v121
    v_lshlrev_b32 v80, 16, v122
    v_and_b32 v81, 0xffff0000, v122
    v_lshlrev_b32 v82, 16, v123
    v_and_b32 v83, 0xffff0000, v123
    v_cvt_pk_bf16_f32 v100, v52, v53
    v_cvt_pk_bf16_f32 v101, v54, v55
    v_cvt_pk_bf16_f32 v102, v56, v57
    v_cvt_pk_bf16_f32 v103, v58, v59
    v_cvt_pk_bf16_f32 v104, v60, v61
    v_cvt_pk_bf16_f32 v105, v62, v63
    v_cvt_pk_bf16_f32 v106, v64, v65
    v_cvt_pk_bf16_f32 v107, v66, v67
    v_lshlrev_b32 v52, 16, v100
    v_and_b32 v53, 0xffff0000, v100
    v_lshlrev_b32 v54, 16, v101
    v_and_b32 v55, 0xffff0000, v101
    v_lshlrev_b32 v56, 16, v102
    v_and_b32 v57, 0xffff0000, v102
    v_lshlrev_b32 v58, 16, v103
    v_and_b32 v59, 0xffff0000, v103
    v_lshlrev_b32 v60, 16, v104
    v_and_b32 v61, 0xffff0000, v104
    v_lshlrev_b32 v62, 16, v105
    v_and_b32 v63, 0xffff0000, v105
    v_lshlrev_b32 v64, 16, v106
    v_and_b32 v65, 0xffff0000, v106
    v_lshlrev_b32 v66, 16, v107
    v_and_b32 v67, 0xffff0000, v107
    v_pk_add_f32 v[52:53], v[52:53], v[68:69]
    v_pk_add_f32 v[54:55], v[54:55], v[70:71]
    v_pk_add_f32 v[56:57], v[56:57], v[72:73]
    v_pk_add_f32 v[58:59], v[58:59], v[74:75]
    v_pk_add_f32 v[60:61], v[60:61], v[76:77]
    v_pk_add_f32 v[62:63], v[62:63], v[78:79]
    v_pk_add_f32 v[64:65], v[64:65], v[80:81]
    v_pk_add_f32 v[66:67], v[66:67], v[82:83]
    v_cvt_pk_bf16_f32 v100, v52, v53
    v_cvt_pk_bf16_f32 v101, v54, v55
    v_cvt_pk_bf16_f32 v102, v56, v57
    v_cvt_pk_bf16_f32 v103, v58, v59
    v_cvt_pk_bf16_f32 v104, v60, v61
    v_cvt_pk_bf16_f32 v105, v62, v63
    v_cvt_pk_bf16_f32 v106, v64, v65
    v_cvt_pk_bf16_f32 v107, v66, v67
    v_mov_b32 v22, 0
    v_mov_b32 v23, 0
    v_mov_b32 v21, 0x3f803f80
    v_mov_b32 v26, 0
    v_mov_b32 v27, 0
    v_dot2_f32_bf16 v22, v100, v21, v22
    v_dot2_f32_bf16 v23, v100, v100, v23
    v_dot2_f32_bf16 v26, v101, v21, v26
    v_dot2_f32_bf16 v27, v101, v101, v27
    v_dot2_f32_bf16 v22, v102, v21, v22
    v_dot2_f32_bf16 v23, v102, v102, v23
    v_dot2_f32_bf16 v26, v103, v21, v26
    v_dot2_f32_bf16 v27, v103, v103, v27
    v_dot2_f32_bf16 v22, v104, v21, v22
    v_dot2_f32_bf16 v23, v104, v104, v23
    v_dot2_f32_bf16 v26, v105, v21, v26
    v_dot2_f32_bf16 v27, v105, v105, v27
    v_dot2_f32_bf16 v22, v106, v21, v22
    v_dot2_f32_bf16 v23, v106, v106, v23
    v_dot2_f32_bf16 v26, v107, v21, v26
    v_dot2_f32_bf16 v27, v107, v107, v27
    s_nop 1
    v_add_f32 v22, v22, v26
    v_add_f32 v23, v23, v27
    v_mov_b32 v24, v22
    v_mov_b32 v25, v23
    s_nop 0
    v_permlane16_swap_b32 v22, v24
    v_permlane16_swap_b32 v23, v25
    v_add_f32 v22, v22, v24
    v_add_f32 v23, v23, v25
    v_mov_b32 v24, v22
    v_mov_b32 v25, v23
    s_nop 0
    v_permlane32_swap_b32 v22, v24
    v_permlane32_swap_b32 v23, v25
    v_add_f32 v22, v22, v24
    v_add_f32 v23, v23, v25
    s_add_u32 s50, s3, 12
    v_mov_b32 v24, s50
    v_mov_b32 v25, 0
    s_lshl_b32 s36, s20, 1
    s_add_u32 s36, s36, s22
    s_lshl_b32 s36, s36, 13
    s_lshl_b32 s37, s18, 8
    s_add_u32 s36, s36, s37
    s_add_u32 s36, s36, 9994240
    s_lshl_b32 s37, s23, 10
    s_add_u32 s37, s37, s36
    v_lshlrev_b32 v4, 4, v3
    s_mov_b64 exec, 0xffff
    s_cmp_eq_u32 s17, 1
    s_cbranch_scc1 ds_15_l
    buffer_store_dwordx4 v[22:25], v4, s[28:31], s37 offen sc1
    s_nop 0
    s_branch ds_15_e
ds_15_l:
    buffer_store_dwordx4 v[22:25], v4, s[28:31], s37 offen
    s_nop 1
ds_15_e:
    s_mov_b64 exec, -1
    v_lshl_add_u32 v5, v2, 11, v4
    v_lshlrev_b32 v68, 16, v100
    v_and_b32 v69, 0xffff0000, v100
    v_lshlrev_b32 v70, 16, v101
    v_and_b32 v71, 0xffff0000, v101
    v_lshlrev_b32 v72, 16, v102
    v_and_b32 v73, 0xffff0000, v102
    v_lshlrev_b32 v74, 16, v103
    v_and_b32 v75, 0xffff0000, v103
    v_lshlrev_b32 v76, 16, v104
    v_and_b32 v77, 0xffff0000, v104
    v_lshlrev_b32 v78, 16, v105
    v_and_b32 v79, 0xffff0000, v105
    v_lshlrev_b32 v80, 16, v106
    v_and_b32 v81, 0xffff0000, v106
    v_lshlrev_b32 v82, 16, v107
    v_and_b32 v83, 0xffff0000, v107
    s_mov_b32 s38, 0
    s_nop 0
hop_14_p:
    buffer_load_dwordx4 v[52:55], v5, s[28:31], s36 offen sc1
    buffer_load_dwordx4 v[56:59], v5, s[28:31], s36 offen offset:1024 sc1
    s_add_u32 s38, s38, 1
    s_waitcnt vmcnt(0)
    v_cmp_eq_u32 vcc, s50, v54
    v_cmp_eq_u32 s[40:41], s50, v58
    s_nop 1
    s_and_b64 vcc, vcc, s[40:41]
    s_cmp_gt_u32 s38, 200000
    s_cbranch_scc1 hop_14_d
    s_cmp_eq_u64 vcc, -1
    s_cbranch_scc0 hop_14_p
hop_14_d:
    v_add_f32 v22, v52, v56
    v_add_f32 v23, v53, v57
    v_mov_b32 v24, v22
    v_mov_b32 v25, v23
    s_nop 0
    v_permlane16_swap_b32 v22, v24
    v_permlane16_swap_b32 v23, v25
    v_add_f32 v22, v22, v24
    v_add_f32 v23, v23, v25
    v_mov_b32 v24, v22
    v_mov_b32 v25, v23
    s_nop 0
    v_permlane32_swap_b32 v22, v24
    v_permlane32_swap_b32 v23, v25
    v_add_f32 v22, v22, v24
    v_add_f32 v23, v23, v25
    v_mul_f32 v22, 0x3b000000, v22
    v_mul_f32 v23, 0x3b000000, v23
    v_fma_f32 v23, -v22, v22, v23
    v_max_f32 v23, 0, v23
    v_cvt_pk_bf16_f32 v23, v23, v23
    v_and_b32 v23, 0xffff0000, v23
    v_add_f32 v23, 0x3727c5ac, v23
    v_cvt_pk_bf16_f32 v23, v23, v23
    v_and_b32 v23, 0xffff0000, v23
    v_sqrt_f32 v23, v23
    s_nop 0
    v_cvt_pk_bf16_f32 v23, v23, v23
    v_and_b32 v23, 0xffff0000, v23
    v_cvt_pk_bf16_f32 v22, v22, v22
    v_and_b32 v22, 0xffff0000, v22
    v_rcp_f32 v24, v23
    v_sub_f32 v22, 0, v22
    v_mul_f32 v26, v22, v24
    v_lshlrev_b32 v52, 16, v124
    v_and_b32 v53, 0xffff0000, v124
    v_lshlrev_b32 v54, 16, v125
    v_and_b32 v55, 0xffff0000, v125
    v_lshlrev_b32 v56, 16, v126
    v_and_b32 v57, 0xffff0000, v126
    v_lshlrev_b32 v58, 16, v127
    v_and_b32 v59, 0xffff0000, v127
    v_lshlrev_b32 v60, 16, v128
    v_and_b32 v61, 0xffff0000, v128
    v_lshlrev_b32 v62, 16, v129
    v_and_b32 v63, 0xffff0000, v129
    v_lshlrev_b32 v64, 16, v130
    v_and_b32 v65, 0xffff0000, v130
    v_lshlrev_b32 v66, 16, v131
    v_and_b32 v67, 0xffff0000, v131
    v_pk_fma_f32 v[84:85], v[68:69], v[24:25], v[26:27] op_sel_hi:[1,0,0]
    v_pk_fma_f32 v[86:87], v[70:71], v[24:25], v[26:27] op_sel_hi:[1,0,0]
    v_pk_fma_f32 v[88:89], v[72:73], v[24:25], v[26:27] op_sel_hi:[1,0,0]
    v_pk_fma_f32 v[90:91], v[74:75], v[24:25], v[26:27] op_sel_hi:[1,0,0]
    v_pk_fma_f32 v[92:93], v[76:77], v[24:25], v[26:27] op_sel_hi:[1,0,0]
    v_pk_fma_f32 v[94:95], v[78:79], v[24:25], v[26:27] op_sel_hi:[1,0,0]
    v_pk_fma_f32 v[96:97], v[80:81], v[24:25], v[26:27] op_sel_hi:[1,0,0]
    v_pk_fma_f32 v[98:99], v[82:83], v[24:25], v[26:27] op_sel_hi:[1,0,0]
    v_pk_fma_f32 v[84:85], v[84:85], v[52:53], v[68:69]
    v_pk_fma_f32 v[86:87], v[86:87], v[54:55], v[70:71]
    v_pk_fma_f32 v[88:89], v[88:89], v[56:57], v[72:73]
    v_pk_fma_f32 v[90:91], v[90:91], v[58:59], v[74:75]
    v_pk_fma_f32 v[92:93], v[92:93], v[60:61], v[76:77]
    v_pk_fma_f32 v[94:95], v[94:95], v[62:63], v[78:79]
    v_pk_fma_f32 v[96:97], v[96:97], v[64:65], v[80:81]
    v_pk_fma_f32 v[98:99], v[98:99], v[66:67], v[82:83]
    v_cvt_pk_bf16_f32 v44, v84, v85
    v_cvt_pk_bf16_f32 v45, v86, v87
    v_cvt_pk_bf16_f32 v46, v88, v89
    v_cvt_pk_bf16_f32 v47, v90, v91
    v_cvt_pk_bf16_f32 v48, v92, v93
    v_cvt_pk_bf16_f32 v49, v94, v95
    v_cvt_pk_bf16_f32 v50, v96, v97
    v_cvt_pk_bf16_f32 v51, v98, v99
    s_lshl_b32 s36, s20, 3
    s_lshl_b32 s37, s22, 2
    s_add_u32 s36, s36, s37
    s_add_u32 s36, s36, s18
    s_lshl_b32 s38, s36, 10
    s_lshl_b32 s36, s36, 14
    s_lshl_b32 s37, s23, 11
    s_add_u32 s36, s36, s37
    s_add_u32 s36, s36, 23068672
    s_cmp_eq_u32 s17, 1
    s_cbranch_scc1 ds_16_l
    buffer_store_dwordx4 v[44:47], v31, s[28:31], s36 offen sc1
    buffer_store_dwordx4 v[48:51], v31, s[28:31], s36 offen offset:1024 sc1
    s_nop 0
    s_branch ds_16_e
ds_16_l:
    buffer_store_dwordx4 v[44:47], v31, s[28:31], s36 offen
    buffer_store_dwordx4 v[48:51], v31, s[28:31], s36 offen offset:1024
    s_nop 1
ds_16_e:
    v_mov_b32 v22, 0
    v_mov_b32 v23, 0
    v_mov_b32 v26, 0
    v_mov_b32 v27, 0
    v_dot2_f32_bf16 v22, v44, v21, v22
    v_dot2_f32_bf16 v23, v44, v44, v23
    v_dot2_f32_bf16 v26, v45, v21, v26
    v_dot2_f32_bf16 v27, v45, v45, v27
    v_dot2_f32_bf16 v22, v46, v21, v22
    v_dot2_f32_bf16 v23, v46, v46, v23
    v_dot2_f32_bf16 v26, v47, v21, v26
    v_dot2_f32_bf16 v27, v47, v47, v27
    v_dot2_f32_bf16 v22, v48, v21, v22
    v_dot2_f32_bf16 v23, v48, v48, v23
    v_dot2_f32_bf16 v26, v49, v21, v26
    v_dot2_f32_bf16 v27, v49, v49, v27
    v_dot2_f32_bf16 v22, v50, v21, v22
    v_dot2_f32_bf16 v23, v50, v50, v23
    v_dot2_f32_bf16 v26, v51, v21, v26
    v_dot2_f32_bf16 v27, v51, v51, v27
    s_nop 1
    v_add_f32 v22, v22, v26
    v_add_f32 v23, v23, v27
    v_mov_b32 v24, v22
    v_mov_b32 v25, v23
    s_nop 0
    v_permlane16_swap_b32 v22, v24
    v_permlane16_swap_b32 v23, v25
    v_add_f32 v22, v22, v24
    v_add_f32 v23, v23, v25
    v_mov_b32 v24, v22
    v_mov_b32 v25, v23
    s_nop 0
    v_permlane32_swap_b32 v22, v24
    v_permlane32_swap_b32 v23, v25
    v_add_f32 v22, v22, v24
    v_add_f32 v23, v23, v25
    s_lshl_b32 s37, s23, 7
    s_add_u32 s38, s38, s37
    s_add_u32 s38, s38, 10256384
    v_lshlrev_b32 v4, 3, v3
    s_mov_b64 exec, 0xffff
    s_cmp_eq_u32 s17, 1
    s_cbranch_scc1 ds_17_l
    buffer_store_dwordx2 v[22:23], v4, s[28:31], s38 offen sc1
    s_branch ds_17_e
ds_17_l:
    buffer_store_dwordx2 v[22:23], v4, s[28:31], s38 offen
ds_17_e:
    s_mov_b64 exec, -1
    s_add_u32 s36, s3, 6
    v_mov_b32 v2, s36
    v_mov_b32 v3, s64
    s_waitcnt vmcnt(0)
    s_barrier
    s_cmp_lg_u32 s18, 0
    s_cbranch_scc1 sg_18
    s_mov_b64 exec, 1
    s_cmp_eq_u32 s17, 1
    s_cbranch_scc1 ds_19_l
    buffer_store_dword v2, v3, s[28:31], 0 offen sc1
    s_branch ds_19_e
ds_19_l:
    buffer_store_dword v2, v3, s[28:31], 0 offen
ds_19_e:
    s_mov_b64 exec, -1
sg_18:
    v_and_b32 v2, 15, v1
    v_lshrrev_b32 v3, 4, v1
    s_add_u32 s36, s18, 0
    s_and_b32 s36, s36, 3
    s_lshl_b32 s37, s36, 14
    v_add_u32 v8, s37, v31
    s_lshl_b32 s37, s36, 8
    s_add_u32 s37, s37, 147456
    v_lshl_add_u32 v15, v2, 4, s37
    s_add_u32 s36, s18, 1
    s_and_b32 s36, s36, 3
    s_lshl_b32 s37, s36, 14
    v_add_u32 v9, s37, v31
    s_lshl_b32 s37, s36, 8
    s_add_u32 s37, s37, 147456
    v_lshl_add_u32 v16, v2, 4, s37
    s_add_u32 s36, s18, 2
    s_and_b32 s36, s36, 3
    s_lshl_b32 s37, s36, 14
    v_add_u32 v10, s37, v31
    s_lshl_b32 s37, s36, 8
    s_add_u32 s37, s37, 147456
    v_lshl_add_u32 v17, v2, 4, s37
    s_add_u32 s36, s18, 3
    s_and_b32 s36, s36, 3
    s_lshl_b32 s37, s36, 14
    v_add_u32 v11, s37, v31
    s_lshl_b32 s37, s36, 8
    s_add_u32 s37, s37, 147456
    v_lshl_add_u32 v18, v2, 4, s37
    v_lshrrev_b32 v4, 5, v1
    v_add_u32 v4, s18, v4
    v_add_u32 v4, 0, v4
    v_and_b32 v4, 3, v4
    v_mul_u32_u24 v5, 44032, v4
    v_bfe_u32 v6, v1, 4, 1
    v_lshl_add_u32 v5, v6, 7, v5
    v_lshl_add_u32 v12, v2, 3, v5
    v_lshlrev_b32 v4, 8, v4
    v_lshl_add_u32 v4, v2, 4, v4
    v_add_u32 v19, 147456, v4
    v_lshrrev_b32 v4, 5, v1
    v_add_u32 v4, s18, v4
    v_add_u32 v4, 2, v4
    v_and_b32 v4, 3, v4
    v_mul_u32_u24 v5, 44032, v4
    v_bfe_u32 v6, v1, 4, 1
    v_lshl_add_u32 v5, v6, 7, v5
    v_lshl_add_u32 v13, v2, 3, v5
    v_lshlrev_b32 v4, 8, v4
    v_lshl_add_u32 v4, v2, 4, v4
    v_add_u32 v20, 147456, v4
    s_mul_i32 s36, s20, 352256
    s_add_u32 s36, s36, 16777216
    s_add_u32 s52, s44, s36
    s_add_u32 s53, s45, s36
    s_add_u32 s54, s46, s36
    s_cmp_lg_u32 s18, 0
    s_cbranch_scc1 ww_20
    v_and_b32 v14, 7, v1
    v_add_u32 v14, 0, v14
    v_lshlrev_b32 v14, 1, v14
    s_lshr_b32 s36, s20, 1
    s_lshl_b32 s36, s36, 5
    s_and_b32 s37, s20, 1
    s_add_u32 s36, s36, s37
    v_add_u32 v14, s36, v14
    v_lshlrev_b32 v14, 6, v14
    v_add_u32 v14, 9961472, v14
    s_add_u32 s37, s3, 6
    s_mov_b32 s38, 0
wf_21:
    buffer_load_dword v116, v14, s[28:31], 0 offen sc1
    s_add_u32 s38, s38, 1
    s_waitcnt vmcnt(0)
    v_subrev_u32 v116, s37, v116
    v_cmp_gt_u32 vcc, 16, v116
    s_cmp_gt_u32 s38, 200000
    s_nop 2
    s_cbranch_scc1 wf_21_x
    s_cmp_eq_u64 vcc, -1
    s_cbranch_scc1 wf_21_x
    s_branch wf_21
wf_21_x:
ww_20:
    s_barrier
    s_lshl_b32 s36, s20, 3
    s_add_u32 s36, s36, s18
    s_add_u32 s36, s36, 0
    s_lshl_b32 s36, s36, 10
    s_add_u32 s36, s36, 10256384
    v_lshrrev_b32 v124, 4, v1
    v_lshlrev_b32 v124, 8, v124
    v_and_b32 v125, 15, v1
    v_lshl_add_u32 v124, v125, 3, v124
    buffer_load_dwordx2 v[120:121], v124, s[28:31], s36 offen sc1
    buffer_load_dwordx2 v[122:123], v124, s[28:31], s36 offen offset:128 sc1
    s_lshl_b32 s56, s20, 3
    s_add_u32 s56, s56, s18
    s_add_u32 s56, s56, 0
    s_lshl_b32 s56, s56, 14
    s_add_u32 s56, s56, 23068672
    s_lshl_b32 s57, s18, 14
    s_add_u32 s57, s57, 0
    s_add_u32 m0, s57, 0
    s_nop 0
    buffer_load_dwordx4 v31, s[28:31], s56 offen sc1 lds
    s_add_u32 s56, s56, 1024
    s_add_u32 m0, s57, 1024
    s_nop 0
    buffer_load_dwordx4 v31, s[28:31], s56 offen sc1 lds
    s_add_u32 s56, s56, 1024
    s_add_u32 m0, s57, 2048
    s_nop 0
    buffer_load_dwordx4 v31, s[28:31], s56 offen sc1 lds
    s_add_u32 s56, s56, 1024
    s_add_u32 m0, s57, 3072
    s_nop 0
    buffer_load_dwordx4 v31, s[28:31], s56 offen sc1 lds
    s_add_u32 s56, s56, 1024
    s_add_u32 m0, s57, 4096
    s_nop 0
    buffer_load_dwordx4 v31, s[28:31], s56 offen sc1 lds
    s_add_u32 s56, s56, 1024
    s_add_u32 m0, s57, 5120
    s_nop 0
    buffer_load_dwordx4 v31, s[28:31], s56 offen sc1 lds
    s_add_u32 s56, s56, 1024
    s_add_u32 m0, s57, 6144
    s_nop 0
    buffer_load_dwordx4 v31, s[28:31], s56 offen sc1 lds
    s_add_u32 s56, s56, 1024
    s_add_u32 m0, s57, 7168
    s_nop 0
    buffer_load_dwordx4 v31, s[28:31], s56 offen sc1 lds
    s_add_u32 s56, s56, 1024
    s_add_u32 m0, s57, 8192
    s_nop 0
    buffer_load_dwordx4 v31, s[28:31], s56 offen sc1 lds
    s_add_u32 s56, s56, 1024
    s_add_u32 m0, s57, 9216
    s_nop 0
    buffer_load_dwordx4 v31, s[28:31], s56 offen sc1 lds
    s_add_u32 s56, s56, 1024
    s_add_u32 m0, s57, 10240
    s_nop 0
    buffer_load_dwordx4 v31, s[28:31], s56 offen sc1 lds
    s_add_u32 s56, s56, 1024
    s_add_u32 m0, s57, 11264
    s_nop 0
    buffer_load_dwordx4 v31, s[28:31], s56 offen sc1 lds
    s_add_u32 s56, s56, 1024
    s_add_u32 m0, s57, 12288
    s_nop 0
    buffer_load_dwordx4 v31, s[28:31], s56 offen sc1 lds
    s_add_u32 s56, s56, 1024
    s_add_u32 m0, s57, 13312
    s_nop 0
    buffer_load_dwordx4 v31, s[28:31], s56 offen sc1 lds
    s_add_u32 s56, s56, 1024
    s_add_u32 m0, s57, 14336
    s_nop 0
    buffer_load_dwordx4 v31, s[28:31], s56 offen sc1 lds
    s_add_u32 s56, s56, 1024
    s_add_u32 m0, s57, 15360
    s_nop 0
    buffer_load_dwordx4 v31, s[28:31], s56 offen sc1 lds
    s_add_u32 s56, s56, 1024
    s_waitcnt vmcnt(16)
    v_add_f32 v126, v120, v122
    v_add_f32 v127, v121, v123
    v_mov_b32 v120, v126
    s_nop 1
    v_permlane16_swap_b32 v126, v120
    v_add_f32 v126, v126, v120
    v_mov_b32 v120, v126
    s_nop 1
    v_permlane32_swap_b32 v126, v120
    v_add_f32 v126, v126, v120
    v_mov_b32 v121, v127
    s_nop 1
    v_permlane16_swap_b32 v127, v121
    v_add_f32 v127, v127, v121
    v_mov_b32 v121, v127
    s_nop 1
    v_permlane32_swap_b32 v127, v121
    v_add_f32 v127, v127, v121
    v_mul_f32 v126, 0x3b000000, v126
    v_mul_f32 v127, 0x3b000000, v127
    v_fma_f32 v127, -v126, v126, v127
    v_max_f32 v127, 0, v127
    v_cvt_pk_bf16_f32 v127, v127, v127
    v_and_b32 v127, 0xffff0000, v127
    v_add_f32 v127, 0x3727c5ac, v127
    v_cvt_pk_bf16_f32 v127, v127, v127
    v_and_b32 v127, 0xffff0000, v127
    v_sqrt_f32 v127, v127
    s_nop 0
    v_cvt_pk_bf16_f32 v127, v127, v127
    v_and_b32 v127, 0xffff0000, v127
    v_cvt_pk_bf16_f32 v126, v126, v126
    v_and_b32 v126, 0xffff0000, v126
    v_rcp_f32 v120, v127
    v_mul_f32 v117, v127, v127
    v_sub_f32 v118, 0, v126
    v_mul_f32 v116, 0xbfb8aa3b, v120
    v_mov_b32 v119, 0
    s_lshl_b32 s36, s18, 8
    s_add_u32 s36, s36, 147456
    v_lshl_add_u32 v124, v125, 4, s36
    ds_write_b128 v124, v[116:119]
    s_waitcnt vmcnt(8) lgkmcnt(0)
    s_barrier
    ds_read_b128 v[100:103], v8 offset:0
    ds_read_b128 v[104:107], v9 offset:0
    ds_read_b128 v[108:111], v8 offset:1024
    v_and_b32 v14, 7, v1
    v_add_u32 v14, 8, v14
    v_lshlrev_b32 v14, 1, v14
    s_lshr_b32 s36, s20, 1
    s_lshl_b32 s36, s36, 5
    s_and_b32 s37, s20, 1
    s_add_u32 s36, s36, s37
    v_add_u32 v14, s36, v14
    v_lshlrev_b32 v14, 6, v14
    v_add_u32 v14, 9961472, v14
    buffer_load_dword v30, v14, s[28:31], 0 offen sc1
    s_waitcnt lgkmcnt(2)
    v_mfma_f32_16x16x32_bf16 v[52:55], a[0:3], v[100:103], 0
    ds_read_b128 v[112:115], v9 offset:1024
    v_mfma_f32_16x16x32_bf16 v[56:59], a[4:7], v[100:103], 0
    v_mfma_f32_16x16x32_bf16 v[60:63], a[8:11], v[100:103], 0
    s_waitcnt lgkmcnt(2)
    v_mfma_f32_16x16x32_bf16 v[64:67], a[0:3], v[104:107], 0
    ds_read_b128 v[100:103], v8 offset:2048
    v_mfma_f32_16x16x32_bf16 v[68:71], a[4:7], v[104:107], 0
    v_mfma_f32_16x16x32_bf16 v[72:75], a[8:11], v[104:107], 0
    s_waitcnt lgkmcnt(2)
    v_mfma_f32_16x16x32_bf16 v[52:55], a[12:15], v[108:111], v[52:55]
    ds_read_b128 v[104:107], v9 offset:2048
    v_mfma_f32_16x16x32_bf16 v[56:59], a[16:19], v[108:111], v[56:59]
    v_mfma_f32_16x16x32_bf16 v[60:63], a[20:23], v[108:111], v[60:63]
    s_waitcnt lgkmcnt(2)
    v_mfma_f32_16x16x32_bf16 v[64:67], a[12:15], v[112:115], v[64:67]
    ds_read_b128 v[108:111], v8 offset:3072
    v_mfma_f32_16x16x32_bf16 v[68:71], a[16:19], v[112:115], v[68:71]
    v_mfma_f32_16x16x32_bf16 v[72:75], a[20:23], v[112:115], v[72:75]
    s_waitcnt lgkmcnt(2)
    v_mfma_f32_16x16x32_bf16 v[52:55], a[24:27], v[100:103], v[52:55]
    ds_read_b128 v[112:115], v9 offset:3072
    v_mfma_f32_16x16x32_bf16 v[56:59], a[28:31], v[100:103], v[56:59]
    v_mfma_f32_16x16x32_bf16 v[60:63], a[32:35], v[100:103], v[60:63]
    s_waitcnt lgkmcnt(2)
    v_mfma_f32_16x16x32_bf16 v[64:67], a[24:27], v[104:107], v[64:67]
    ds_read_b128 v[100:103], v8 offset:4096
    v_mfma_f32_16x16x32_bf16 v[68:71], a[28:31], v[104:107], v[68:71]
    v_mfma_f32_16x16x32_bf16 v[72:75], a[32:35], v[104:107], v[72:75]
    s_waitcnt lgkmcnt(2)
    v_mfma_f32_16x16x32_bf16 v[52:55], a[36:39], v[108:111], v[52:55]
    ds_read_b128 v[104:107], v9 offset:4096
    v_mfma_f32_16x16x32_bf16 v[56:59], a[40:43], v[108:111], v[56:59]
    v_mfma_f32_16x16x32_bf16 v[60:63], a[44:47], v[108:111], v[60:63]
    s_waitcnt lgkmcnt(2)
    v_mfma_f32_16x16x32_bf16 v[64:67], a[36:39], v[112:115], v[64:67]
    ds_read_b128 v[108:111], v8 offset:5120
    v_mfma_f32_16x16x32_bf16 v[68:71], a[40:43], v[112:115], v[68:71]
    v_mfma_f32_16x16x32_bf16 v[72:75], a[44:47], v[112:115], v[72:75]
    s_waitcnt lgkmcnt(2)
    v_mfma_f32_16x16x32_bf16 v[52:55], a[48:51], v[100:103], v[52:55]
    ds_read_b128 v[112:115], v9 offset:5120
    v_mfma_f32_16x16x32_bf16 v[56:59], a[52:55], v[100:103], v[56:59]
    v_mfma_f32_16x16x32_bf16 v[60:63], a[56:59], v[100:103], v[60:63]
    s_waitcnt lgkmcnt(2)
    v_mfma_f32_16x16x32_bf16 v[64:67], a[48:51], v[104:107], v[64:67]
    ds_read_b128 v[100:103], v8 offset:6144
    v_mfma_f32_16x16x32_bf16 v[68:71], a[52:55], v[104:107], v[68:71]
    v_mfma_f32_16x16x32_bf16 v[72:75], a[56:59], v[104:107], v[72:75]
    s_waitcnt lgkmcnt(2)
    v_mfma_f32_16x16x32_bf16 v[52:55], a[60:63], v[108:111], v[52:55]
    ds_read_b128 v[104:107], v9 offset:6144
    v_mfma_f32_16x16x32_bf16 v[56:59], a[64:67], v[108:111], v[56:59]
    v_mfma_f32_16x16x32_bf16 v[60:63], a[68:71], v[108:111], v[60:63]
    s_waitcnt lgkmcnt(2)
    v_mfma_f32_16x16x32_bf16 v[64:67], a[60:63], v[112:115], v[64:67]
    ds_read_b128 v[108:111], v8 offset:7168
    v_mfma_f32_16x16x32_bf16 v[68:71], a[64:67], v[112:115], v[68:71]
    v_mfma_f32_16x16x32_bf16 v[72:75], a[68:71], v[112:115], v[72:75]
    s_waitcnt vmcnt(1)
    s_barrier
    s_waitcnt lgkmcnt(2)
    v_mfma_f32_16x16x32_bf16 v[52:55], a[72:75], v[100:103], v[52:55]
    ds_read_b128 v[112:115], v9 offset:7168
    v_mfma_f32_16x16x32_bf16 v[56:59], a[76:79], v[100:103], v[56:59]
    v_mfma_f32_16x16x32_bf16 v[60:63], a[80:83], v[100:103], v[60:63]
    s_waitcnt lgkmcnt(2)
    v_mfma_f32_16x16x32_bf16 v[64:67], a[72:75], v[104:107], v[64:67]
    ds_read_b128 v[100:103], v8 offset:8192
    v_mfma_f32_16x16x32_bf16 v[68:71], a[76:79], v[104:107], v[68:71]
    v_mfma_f32_16x16x32_bf16 v[72:75], a[80:83], v[104:107], v[72:75]
    s_waitcnt lgkmcnt(2)
    v_mfma_f32_16x16x32_bf16 v[52:55], a[84:87], v[108:111], v[52:55]
    ds_read_b128 v[104:107], v9 offset:8192
    v_mfma_f32_16x16x32_bf16 v[56:59], a[88:91], v[108:111], v[56:59]
    v_mfma_f32_16x16x32_bf16 v[60:63], a[92:95], v[108:111], v[60:63]
    s_waitcnt lgkmcnt(2)
    v_mfma_f32_16x16x32_bf16 v[64:67], a[84:87], v[112:115], v[64:67]
    ds_read_b128 v[108:111], v8 offset:9216
    v_mfma_f32_16x16x32_bf16 v[68:71], a[88:91], v[112:115], v[68:71]
    v_mfma_f32_16x16x32_bf16 v[72:75], a[92:95], v[112:115], v[72:75]
    s_waitcnt lgkmcnt(2)
    v_mfma_f32_16x16x32_bf16 v[52:55], a[96:99], v[100:103], v[52:55]
    ds_read_b128 v[112:115], v9 offset:9216
    v_mfma_f32_16x16x32_bf16 v[56:59], a[100:103], v[100:103], v[56:59]
    v_mfma_f32_16x16x32_bf16 v[60:63], a[104:107], v[100:103], v[60:63]
    s_waitcnt lgkmcnt(2)
    v_mfma_f32_16x16x32_bf16 v[64:67], a[96:99], v[104:107], v[64:67]
    ds_read_b128 v[100:103], v8 offset:10240
    v_mfma_f32_16x16x32_bf16 v[68:71], a[100:103], v[104:107], v[68:71]
    v_mfma_f32_16x16x32_bf16 v[72:75], a[104:107], v[104:107], v[72:75]
    s_waitcnt lgkmcnt(2)
    v_mfma_f32_16x16x32_bf16 v[52:55], a[108:111], v[108:111], v[52:55]
    ds_read_b128 v[104:107], v9 offset:10240
    v_mfma_f32_16x16x32_bf16 v[56:59], a[112:115], v[108:111], v[56:59]
    v_mfma_f32_16x16x32_bf16 v[60:63], a[116:119], v[108:111], v[60:63]
    s_waitcnt lgkmcnt(2)
    v_mfma_f32_16x16x32_bf16 v[64:67], a[108:111], v[112:115], v[64:67]
    ds_read_b128 v[108:111], v8 offset:11264
    v_mfma_f32_16x16x32_bf16 v[68:71], a[112:115], v[112:115], v[68:71]
    v_mfma_f32_16x16x32_bf16 v[72:75], a[116:119], v[112:115], v[72:75]
    s_waitcnt vmcnt(0)
    s_add_u32 s37, s3, 6
    v_subrev_u32 v30, s37, v30
    v_cmp_gt_u32 vcc, 16, v30
    s_nop 1
    s_cmp_eq_u64 vcc, -1
    s_nop 0
    s_cbranch_scc1 x3b_22
    s_add_u32 s37, s3, 6
    s_mov_b32 s38, 0
wf_23:
    buffer_load_dword v30, v14, s[28:31], 0 offen sc1
    s_add_u32 s38, s38, 1
    s_waitcnt vmcnt(0)
    v_subrev_u32 v30, s37, v30
    v_cmp_gt_u32 vcc, 16, v30
    s_cmp_gt_u32 s38, 200000
    s_nop 2
    s_cbranch_scc1 wf_23_x
    s_cmp_eq_u64 vcc, -1
    s_cbranch_scc1 wf_23_x
    s_branch wf_23
wf_23_x:
x3b_22:
    s_lshl_b32 s36, s20, 3
    s_add_u32 s36, s36, s18
    s_add_u32 s36, s36, 4
    s_lshl_b32 s36, s36, 10
    s_add_u32 s36, s36, 10256384
    v_lshrrev_b32 v124, 4, v1
    v_lshlrev_b32 v124, 8, v124
    v_and_b32 v125, 15, v1
    v_lshl_add_u32 v124, v125, 3, v124
    buffer_load_dwordx2 v[120:121], v124, s[28:31], s36 offen sc1
    buffer_load_dwordx2 v[122:123], v124, s[28:31], s36 offen offset:128 sc1
    s_lshl_b32 s56, s20, 3
    s_add_u32 s56, s56, s18
    s_add_u32 s56, s56, 4
    s_lshl_b32 s56, s56, 14
    s_add_u32 s56, s56, 23068672
    s_lshl_b32 s57, s18, 14
    s_add_u32 s57, s57, 65536
    s_add_u32 m0, s57, 0
    s_nop 0
    buffer_load_dwordx4 v31, s[28:31], s56 offen sc1 lds
    s_add_u32 s56, s56, 1024
    s_add_u32 m0, s57, 1024
    s_nop 0
    buffer_load_dwordx4 v31, s[28:31], s56 offen sc1 lds
    s_add_u32 s56, s56, 1024
    s_waitcnt lgkmcnt(2)
    v_mfma_f32_16x16x32_bf16 v[52:55], a[120:123], v[100:103], v[52:55]
    ds_read_b128 v[112:115], v9 offset:11264
    v_mfma_f32_16x16x32_bf16 v[56:59], a[124:127], v[100:103], v[56:59]
    v_mfma_f32_16x16x32_bf16 v[60:63], a[128:131], v[100:103], v[60:63]
    s_waitcnt lgkmcnt(2)
    v_mfma_f32_16x16x32_bf16 v[64:67], a[120:123], v[104:107], v[64:67]
    ds_read_b128 v[100:103], v8 offset:12288
    v_mfma_f32_16x16x32_bf16 v[68:71], a[124:127], v[104:107], v[68:71]
    v_mfma_f32_16x16x32_bf16 v[72:75], a[128:131], v[104:107], v[72:75]
    s_add_u32 m0, s57, 2048
    s_nop 0
    buffer_load_dwordx4 v31, s[28:31], s56 offen sc1 lds
    s_add_u32 s56, s56, 1024
    s_add_u32 m0, s57, 3072
    s_nop 0
    buffer_load_dwordx4 v31, s[28:31], s56 offen sc1 lds
    s_add_u32 s56, s56, 1024
    s_waitcnt lgkmcnt(2)
    v_mfma_f32_16x16x32_bf16 v[52:55], a[132:135], v[108:111], v[52:55]
    ds_read_b128 v[104:107], v9 offset:12288
    v_mfma_f32_16x16x32_bf16 v[56:59], a[136:139], v[108:111], v[56:59]
    v_mfma_f32_16x16x32_bf16 v[60:63], a[140:143], v[108:111], v[60:63]
    s_waitcnt lgkmcnt(2)
    v_mfma_f32_16x16x32_bf16 v[64:67], a[132:135], v[112:115], v[64:67]
    ds_read_b128 v[108:111], v8 offset:13312
    v_mfma_f32_16x16x32_bf16 v[68:71], a[136:139], v[112:115], v[68:71]
    v_mfma_f32_16x16x32_bf16 v[72:75], a[140:143], v[112:115], v[72:75]
    s_add_u32 m0, s57, 4096
    s_nop 0
    buffer_load_dwordx4 v31, s[28:31], s56 offen sc1 lds
    s_add_u32 s56, s56, 1024
    s_add_u32 m0, s57, 5120
    s_nop 0
    buffer_load_dwordx4 v31, s[28:31], s56 offen sc1 lds
    s_add_u32 s56, s56, 1024
    s_waitcnt lgkmcnt(2)
    v_mfma_f32_16x16x32_bf16 v[52:55], a[144:147], v[100:103], v[52:55]
    ds_read_b128 v[112:115], v9 offset:13312
    v_mfma_f32_16x16x32_bf16 v[56:59], a[148:151], v[100:103], v[56:59]
    v_mfma_f32_16x16x32_bf16 v[60:63], a[152:155], v[100:103], v[60:63]
    s_waitcnt lgkmcnt(2)
    v_mfma_f32_16x16x32_bf16 v[64:67], a[144:147], v[104:107], v[64:67]
    ds_read_b128 v[100:103], v8 offset:14336
    v_mfma_f32_16x16x32_bf16 v[68:71], a[148:151], v[104:107], v[68:71]
    v_mfma_f32_16x16x32_bf16 v[72:75], a[152:155], v[104:107], v[72:75]
    s_add_u32 m0, s57, 6144
    s_nop 0
    buffer_load_dwordx4 v31, s[28:31], s56 offen sc1 lds
    s_add_u32 s56, s56, 1024
    s_add_u32 m0, s57, 7168
    s_nop 0
    buffer_load_dwordx4 v31, s[28:31], s56 offen sc1 lds
    s_add_u32 s56, s56, 1024
    s_waitcnt lgkmcnt(2)
    v_mfma_f32_16x16x32_bf16 v[52:55], a[156:159], v[108:111], v[52:55]
    ds_read_b128 v[104:107], v9 offset:14336
    v_mfma_f32_16x16x32_bf16 v[56:59], a[160:163], v[108:111], v[56:59]
    v_mfma_f32_16x16x32_bf16 v[60:63], a[164:167], v[108:111], v[60:63]
    s_waitcnt lgkmcnt(2)
    v_mfma_f32_16x16x32_bf16 v[64:67], a[156:159], v[112:115], v[64:67]
    ds_read_b128 v[108:111], v8 offset:15360
    v_mfma_f32_16x16x32_bf16 v[68:71], a[160:163], v[112:115], v[68:71]
    v_mfma_f32_16x16x32_bf16 v[72:75], a[164:167], v[112:115], v[72:75]
    s_add_u32 m0, s57, 8192
    s_nop 0
    buffer_load_dwordx4 v31, s[28:31], s56 offen sc1 lds
    s_add_u32 s56, s56, 1024
    s_add_u32 m0, s57, 9216
    s_nop 0
    buffer_load_dwordx4 v31, s[28:31], s56 offen sc1 lds
    s_add_u32 s56, s56, 1024
    s_waitcnt lgkmcnt(2)
    v_mfma_f32_16x16x32_bf16 v[52:55], a[168:171], v[100:103], v[52:55]
    ds_read_b128 v[112:115], v9 offset:15360
    v_mfma_f32_16x16x32_bf16 v[56:59], a[172:175], v[100:103], v[56:59]
    v_mfma_f32_16x16x32_bf16 v[60:63], a[176:179], v[100:103], v[60:63]
    s_waitcnt lgkmcnt(2)
    v_mfma_f32_16x16x32_bf16 v[64:67], a[168:171], v[104:107], v[64:67]
    ds_read_b128 v[100:103], v10 offset:0
    v_mfma_f32_16x16x32_bf16 v[68:71], a[172:175], v[104:107], v[68:71]
    v_mfma_f32_16x16x32_bf16 v[72:75], a[176:179], v[104:107], v[72:75]
    s_add_u32 m0, s57, 10240
    s_nop 0
    buffer_load_dwordx4 v31, s[28:31], s56 offen sc1 lds
    s_add_u32 s56, s56, 1024
    s_add_u32 m0, s57, 11264
    s_nop 0
    buffer_load_dwordx4 v31, s[28:31], s56 offen sc1 lds
    s_add_u32 s56, s56, 1024
    s_waitcnt lgkmcnt(2)
    v_mfma_f32_16x16x32_bf16 v[52:55], a[180:183], v[108:111], v[52:55]
    ds_read_b128 v[104:107], v11 offset:0
    v_mfma_f32_16x16x32_bf16 v[56:59], a[184:187], v[108:111], v[56:59]
    v_mfma_f32_16x16x32_bf16 v[60:63], a[188:191], v[108:111], v[60:63]
    s_waitcnt lgkmcnt(2)
    v_mfma_f32_16x16x32_bf16 v[64:67], a[180:183], v[112:115], v[64:67]
    ds_read_b128 v[108:111], v10 offset:1024
    v_mfma_f32_16x16x32_bf16 v[68:71], a[184:187], v[112:115], v[68:71]
    v_mfma_f32_16x16x32_bf16 v[72:75], a[188:191], v[112:115], v[72:75]
    s_add_u32 m0, s57, 12288
    s_nop 0
    buffer_load_dwordx4 v31, s[28:31], s56 offen sc1 lds
    s_add_u32 s56, s56, 1024
    s_add_u32 m0, s57, 13312
    s_nop 0
    buffer_load_dwordx4 v31, s[28:31], s56 offen sc1 lds
    s_add_u32 s56, s56, 1024
    s_waitcnt lgkmcnt(2)
    v_mfma_f32_16x16x32_bf16 v[76:79], a[0:3], v[100:103], 0
    ds_read_b128 v[112:115], v11 offset:1024
    v_add_u32 v8, 0x10000, v8
    v_add_u32 v9, 0x10000, v9
    v_mfma_f32_16x16x32_bf16 v[80:83], a[4:7], v[100:103], 0
    ds_read_b32 v22, v15 offset:8
    ds_read_b32 v24, v16 offset:8
    v_mfma_f32_16x16x32_bf16 v[84:87], a[8:11], v[100:103], 0
    ds_read_b64 v[26:27], v19 offset:0
    s_waitcnt lgkmcnt(2)
    v_mfma_f32_16x16x32_bf16 v[88:91], a[0:3], v[104:107], 0
    ds_read_b128 v[100:103], v10 offset:2048
    v_mfma_f32_16x16x32_bf16 v[92:95], a[4:7], v[104:107], 0
    v_mfma_f32_16x16x32_bf16 v[96:99], a[8:11], v[104:107], 0
    s_add_u32 m0, s57, 14336
    s_nop 0
    buffer_load_dwordx4 v31, s[28:31], s56 offen sc1 lds
    s_add_u32 s56, s56, 1024
    s_add_u32 m0, s57, 15360
    s_nop 0
    buffer_load_dwordx4 v31, s[28:31], s56 offen sc1 lds
    s_add_u32 s56, s56, 1024
    s_waitcnt lgkmcnt(2)
    v_mfma_f32_16x16x32_bf16 v[76:79], a[12:15], v[108:111], v[76:79]
    ds_read_b128 v[104:107], v11 offset:2048
    v_mfma_f32_16x16x32_bf16 v[80:83], a[16:19], v[108:111], v[80:83]
    v_mfma_f32_16x16x32_bf16 v[84:87], a[20:23], v[108:111], v[84:87]
    v_fma_f32 v52, v32, v22, v52
    v_fma_f32 v53, v33, v22, v53
    s_waitcnt lgkmcnt(2)
    v_mfma_f32_16x16x32_bf16 v[88:91], a[12:15], v[112:115], v[88:91]
    ds_read_b128 v[108:111], v10 offset:3072
    v_fma_f32 v54, v34, v22, v54
    v_mfma_f32_16x16x32_bf16 v[92:95], a[16:19], v[112:115], v[92:95]
    v_fma_f32 v55, v35, v22, v55
    v_fma_f32 v64, v32, v24, v64
    v_mfma_f32_16x16x32_bf16 v[96:99], a[20:23], v[112:115], v[96:99]
    v_fma_f32 v65, v33, v24, v65
    v_fma_f32 v66, v34, v24, v66
    s_waitcnt lgkmcnt(2)
    v_mfma_f32_16x16x32_bf16 v[76:79], a[24:27], v[100:103], v[76:79]
    ds_read_b128 v[112:115], v11 offset:3072
    v_fma_f32 v67, v35, v24, v67
    v_fma_f32 v56, v36, v22, v56
    v_mfma_f32_16x16x32_bf16 v[80:83], a[28:31], v[100:103], v[80:83]
    v_fma_f32 v57, v37, v22, v57
    v_fma_f32 v58, v38, v22, v58
    v_mfma_f32_16x16x32_bf16 v[84:87], a[32:35], v[100:103], v[84:87]
    v_fma_f32 v59, v39, v22, v59
    v_fma_f32 v68, v36, v24, v68
    s_waitcnt lgkmcnt(2)
    v_mfma_f32_16x16x32_bf16 v[88:91], a[24:27], v[104:107], v[88:91]
    ds_read_b128 v[100:103], v10 offset:4096
    v_fma_f32 v69, v37, v24, v69
    v_mfma_f32_16x16x32_bf16 v[92:95], a[28:31], v[104:107], v[92:95]
    v_fma_f32 v70, v38, v24, v70
    v_fma_f32 v71, v39, v24, v71
    v_mfma_f32_16x16x32_bf16 v[96:99], a[32:35], v[104:107], v[96:99]
    v_fma_f32 v60, v40, v22, v60
    v_fma_f32 v61, v41, v22, v61
    s_waitcnt lgkmcnt(2)
    v_mfma_f32_16x16x32_bf16 v[76:79], a[36:39], v[108:111], v[76:79]
    ds_read_b128 v[104:107], v11 offset:4096
    v_fma_f32 v62, v42, v22, v62
    v_fma_f32 v63, v43, v22, v63
    v_mfma_f32_16x16x32_bf16 v[80:83], a[40:43], v[108:111], v[80:83]
    v_fma_f32 v72, v40, v24, v72
    v_fma_f32 v73, v41, v24, v73
    v_mfma_f32_16x16x32_bf16 v[84:87], a[44:47], v[108:111], v[84:87]
    v_fma_f32 v74, v42, v24, v74
    v_fma_f32 v75, v43, v24, v75
    s_waitcnt lgkmcnt(2)
    v_mfma_f32_16x16x32_bf16 v[88:91], a[36:39], v[112:115], v[88:91]
    ds_read_b128 v[108:111], v10 offset:5120
    v_mfma_f32_16x16x32_bf16 v[92:95], a[40:43], v[112:115], v[92:95]
    v_permlane32_swap_b32 v52, v64
    v_mfma_f32_16x16x32_bf16 v[96:99], a[44:47], v[112:115], v[96:99]
    v_permlane32_swap_b32 v53, v65
    s_waitcnt lgkmcnt(2)
    v_mfma_f32_16x16x32_bf16 v[76:79], a[48:51], v[100:103], v[76:79]
    ds_read_b128 v[112:115], v11 offset:5120
    v_permlane32_swap_b32 v54, v66
    v_mfma_f32_16x16x32_bf16 v[80:83], a[52:55], v[100:103], v[80:83]
    v_permlane32_swap_b32 v55, v67
    v_mfma_f32_16x16x32_bf16 v[84:87], a[56:59], v[100:103], v[84:87]
    v_permlane32_swap_b32 v56, v68
    s_waitcnt lgkmcnt(2)
    v_mfma_f32_16x16x32_bf16 v[88:91], a[48:51], v[104:107], v[88:91]
    ds_read_b128 v[100:103], v10 offset:6144
    v_permlane32_swap_b32 v57, v69
    v_mfma_f32_16x16x32_bf16 v[92:95], a[52:55], v[104:107], v[92:95]
    v_permlane32_swap_b32 v58, v70
    v_mfma_f32_16x16x32_bf16 v[96:99], a[56:59], v[104:107], v[96:99]
    v_permlane32_swap_b32 v59, v71
    s_waitcnt lgkmcnt(2)
    v_mfma_f32_16x16x32_bf16 v[76:79], a[60:63], v[108:111], v[76:79]
    ds_read_b128 v[104:107], v11 offset:6144
    v_permlane32_swap_b32 v60, v72
    v_mfma_f32_16x16x32_bf16 v[80:83], a[64:67], v[108:111], v[80:83]
    v_permlane32_swap_b32 v61, v73
    v_mfma_f32_16x16x32_bf16 v[84:87], a[68:71], v[108:111], v[84:87]
    v_permlane32_swap_b32 v62, v74
    s_waitcnt lgkmcnt(2)
    v_mfma_f32_16x16x32_bf16 v[88:91], a[60:63], v[112:115], v[88:91]
    ds_read_b128 v[108:111], v10 offset:7168
    v_mfma_f32_16x16x32_bf16 v[92:95], a[64:67], v[112:115], v[92:95]
    v_permlane32_swap_b32 v63, v75
    v_mul_f32 v128, v52, v26
    v_mfma_f32_16x16x32_bf16 v[96:99], a[68:71], v[112:115], v[96:99]
    v_mul_f32 v129, v53, v26
    v_mul_f32 v130, v54, v26
    s_waitcnt vmcnt(16)
    v_add_f32 v126, v120, v122
    v_add_f32 v127, v121, v123
    v_mov_b32 v120, v126
    s_nop 1
    v_permlane16_swap_b32 v126, v120
    v_add_f32 v126, v126, v120
    v_mov_b32 v120, v126
    s_nop 1
    v_permlane32_swap_b32 v126, v120
    v_add_f32 v126, v126, v120
    v_mov_b32 v121, v127
    s_nop 1
    v_permlane16_swap_b32 v127, v121
    v_add_f32 v127, v127, v121
    v_mov_b32 v121, v127
    s_nop 1
    v_permlane32_swap_b32 v127, v121
    v_add_f32 v127, v127, v121
    v_mul_f32 v126, 0x3b000000, v126
    v_mul_f32 v127, 0x3b000000, v127
    v_fma_f32 v127, -v126, v126, v127
    v_max_f32 v127, 0, v127
    v_cvt_pk_bf16_f32 v127, v127, v127
    v_and_b32 v127, 0xffff0000, v127
    v_add_f32 v127, 0x3727c5ac, v127
    v_cvt_pk_bf16_f32 v127, v127, v127
    v_and_b32 v127, 0xffff0000, v127
    v_sqrt_f32 v127, v127
    s_nop 0
    v_cvt_pk_bf16_f32 v127, v127, v127
    v_and_b32 v127, 0xffff0000, v127
    v_cvt_pk_bf16_f32 v126, v126, v126
    v_and_b32 v126, 0xffff0000, v126
    v_rcp_f32 v120, v127
    v_mul_f32 v117, v127, v127
    v_sub_f32 v118, 0, v126
    v_mul_f32 v116, 0xbfb8aa3b, v120
    v_mov_b32 v119, 0
    s_lshl_b32 s36, s18, 8
    s_add_u32 s36, s36, 148480
    v_lshl_add_u32 v124, v125, 4, s36
    ds_write_b128 v124, v[116:119]
    s_waitcnt lgkmcnt(2)
    v_mfma_f32_16x16x32_bf16 v[76:79], a[72:75], v[100:103], v[76:79]
    ds_read_b128 v[112:115], v11 offset:7168
    v_mul_f32 v131, v55, v26
    v_mul_f32 v132, v56, v26
    v_mfma_f32_16x16x32_bf16 v[80:83], a[76:79], v[100:103], v[80:83]
    v_mul_f32 v133, v57, v26
    v_mul_f32 v134, v58, v26
    v_mfma_f32_16x16x32_bf16 v[84:87], a[80:83], v[100:103], v[84:87]
    v_mul_f32 v135, v59, v26
    v_mul_f32 v136, v60, v26
    s_waitcnt lgkmcnt(2)
    v_mfma_f32_16x16x32_bf16 v[88:91], a[72:75], v[104:107], v[88:91]
    ds_read_b128 v[100:103], v10 offset:8192
    v_mul_f32 v137, v61, v26
    v_mfma_f32_16x16x32_bf16 v[92:95], a[76:79], v[104:107], v[92:95]
    v_mul_f32 v138, v62, v26
    v_mul_f32 v139, v63, v26
    v_mfma_f32_16x16x32_bf16 v[96:99], a[80:83], v[104:107], v[96:99]
    v_exp_f32 v128, v128
    s_waitcnt lgkmcnt(2)
    v_mfma_f32_16x16x32_bf16 v[76:79], a[84:87], v[108:111], v[76:79]
    ds_read_b128 v[104:107], v11 offset:8192
    v_exp_f32 v129, v129
    v_mfma_f32_16x16x32_bf16 v[80:83], a[88:91], v[108:111], v[80:83]
    v_exp_f32 v130, v130
    v_mfma_f32_16x16x32_bf16 v[84:87], a[92:95], v[108:111], v[84:87]
    v_exp_f32 v131, v131
    s_waitcnt lgkmcnt(2)
    v_mfma_f32_16x16x32_bf16 v[88:91], a[84:87], v[112:115], v[88:91]
    ds_read_b128 v[108:111], v10 offset:9216
    v_mul_f32 v52, v52, v64
    v_mfma_f32_16x16x32_bf16 v[92:95], a[88:91], v[112:115], v[92:95]
    v_mul_f32 v53, v53, v65
    v_mul_f32 v54, v54, v66
    v_mfma_f32_16x16x32_bf16 v[96:99], a[92:95], v[112:115], v[96:99]
    v_mul_f32 v55, v55, v67
    s_waitcnt lgkmcnt(2)
    v_mfma_f32_16x16x32_bf16 v[76:79], a[96:99], v[100:103], v[76:79]
    ds_read_b128 v[112:115], v11 offset:9216
    v_exp_f32 v132, v132
    v_mfma_f32_16x16x32_bf16 v[80:83], a[100:103], v[100:103], v[80:83]
    v_exp_f32 v133, v133
    v_mfma_f32_16x16x32_bf16 v[84:87], a[104:107], v[100:103], v[84:87]
    v_exp_f32 v134, v134
    s_waitcnt lgkmcnt(2)
    v_mfma_f32_16x16x32_bf16 v[88:91], a[96:99], v[104:107], v[88:91]
    ds_read_b128 v[100:103], v10 offset:10240
    v_exp_f32 v135, v135
    v_mul_f32 v56, v56, v68
    v_mfma_f32_16x16x32_bf16 v[92:95], a[100:103], v[104:107], v[92:95]
    v_mul_f32 v57, v57, v69
    v_mfma_f32_16x16x32_bf16 v[96:99], a[104:107], v[104:107], v[96:99]
    v_mul_f32 v58, v58, v70
    v_mul_f32 v59, v59, v71
    s_waitcnt lgkmcnt(2)
    v_mfma_f32_16x16x32_bf16 v[76:79], a[108:111], v[108:111], v[76:79]
    ds_read_b128 v[104:107], v11 offset:10240
    v_exp_f32 v136, v136
    v_mfma_f32_16x16x32_bf16 v[80:83], a[112:115], v[108:111], v[80:83]
    v_exp_f32 v137, v137
    v_mfma_f32_16x16x32_bf16 v[84:87], a[116:119], v[108:111], v[84:87]
    v_exp_f32 v138, v138
    s_waitcnt lgkmcnt(2)
    v_mfma_f32_16x16x32_bf16 v[88:91], a[108:111], v[112:115], v[88:91]
    ds_read_b128 v[108:111], v10 offset:11264
    v_exp_f32 v139, v139
    v_mfma_f32_16x16x32_bf16 v[92:95], a[112:115], v[112:115], v[92:95]
    v_mul_f32 v60, v60, v72
    v_mfma_f32_16x16x32_bf16 v[96:99], a[116:119], v[112:115], v[96:99]
    v_mul_f32 v61, v61, v73
    v_mul_f32 v62, v62, v74
    s_waitcnt lgkmcnt(2)
    v_mfma_f32_16x16x32_bf16 v[76:79], a[120:123], v[100:103], v[76:79]
    ds_read_b128 v[112:115], v11 offset:11264
    v_mul_f32 v63, v63, v75
    v_fma_f32 v128, v128, v27, v27
    v_mfma_f32_16x16x32_bf16 v[80:83], a[124:127], v[100:103], v[80:83]
    v_fma_f32 v129, v129, v27, v27
    v_fma_f32 v130, v130, v27, v27
    v_mfma_f32_16x16x32_bf16 v[84:87], a[128:131], v[100:103], v[84:87]
    v_fma_f32 v131, v131, v27, v27
    v_fma_f32 v132, v132, v27, v27
    s_waitcnt lgkmcnt(2)
    v_mfma_f32_16x16x32_bf16 v[88:91], a[120:123], v[104:107], v[88:91]
    ds_read_b128 v[100:103], v10 offset:12288
    v_fma_f32 v133, v133, v27, v27
    v_fma_f32 v134, v134, v27, v27
    v_mfma_f32_16x16x32_bf16 v[92:95], a[124:127], v[104:107], v[92:95]
    v_fma_f32 v135, v135, v27, v27
    v_mfma_f32_16x16x32_bf16 v[96:99], a[128:131], v[104:107], v[96:99]
    v_fma_f32 v136, v136, v27, v27
    v_fma_f32 v137, v137, v27, v27
    s_waitcnt lgkmcnt(2)
    v_mfma_f32_16x16x32_bf16 v[76:79], a[132:135], v[108:111], v[76:79]
    ds_read_b128 v[104:107], v11 offset:12288
    v_fma_f32 v138, v138, v27, v27
    v_fma_f32 v139, v139, v27, v27
    v_mfma_f32_16x16x32_bf16 v[80:83], a[136:139], v[108:111], v[80:83]
    v_rcp_f32 v128, v128
    v_mfma_f32_16x16x32_bf16 v[84:87], a[140:143], v[108:111], v[84:87]
    v_rcp_f32 v129, v129
    s_waitcnt lgkmcnt(2)
    v_mfma_f32_16x16x32_bf16 v[88:91], a[132:135], v[112:115], v[88:91]
    ds_read_b128 v[108:111], v10 offset:13312
    v_rcp_f32 v130, v130
    v_mfma_f32_16x16x32_bf16 v[92:95], a[136:139], v[112:115], v[92:95]
    v_mfma_f32_16x16x32_bf16 v[96:99], a[140:143], v[112:115], v[96:99]
    v_rcp_f32 v131, v131
    s_waitcnt lgkmcnt(2)
    v_mfma_f32_16x16x32_bf16 v[76:79], a[144:147], v[100:103], v[76:79]
    ds_read_b128 v[112:115], v11 offset:13312
    v_rcp_f32 v132, v132
    v_mfma_f32_16x16x32_bf16 v[80:83], a[148:151], v[100:103], v[80:83]
    v_rcp_f32 v133, v133
    v_mfma_f32_16x16x32_bf16 v[84:87], a[152:155], v[100:103], v[84:87]
    v_rcp_f32 v134, v134
    s_waitcnt lgkmcnt(2)
    v_mfma_f32_16x16x32_bf16 v[88:91], a[144:147], v[104:107], v[88:91]
    ds_read_b128 v[100:103], v10 offset:14336
    v_rcp_f32 v135, v135
    v_mfma_f32_16x16x32_bf16 v[92:95], a[148:151], v[104:107], v[92:95]
    v_rcp_f32 v136, v136
    v_mfma_f32_16x16x32_bf16 v[96:99], a[152:155], v[104:107], v[96:99]
    v_rcp_f32 v137, v137
    s_waitcnt vmcnt(0)
    s_barrier
    s_waitcnt lgkmcnt(2)
    v_mfma_f32_16x16x32_bf16 v[76:79], a[156:159], v[108:111], v[76:79]
    ds_read_b128 v[104:107], v11 offset:14336
    v_rcp_f32 v138, v138
    v_mfma_f32_16x16x32_bf16 v[80:83], a[160:163], v[108:111], v[80:83]
    v_rcp_f32 v139, v139
    v_mfma_f32_16x16x32_bf16 v[84:87], a[164:167], v[108:111], v[84:87]
    v_mul_f32 v52, v52, v128
    v_mul_f32 v53, v53, v129
    s_waitcnt lgkmcnt(2)
    v_mfma_f32_16x16x32_bf16 v[88:91], a[156:159], v[112:115], v[88:91]
    ds_read_b128 v[108:111], v10 offset:15360
    v_mul_f32 v54, v54, v130
    v_mul_f32 v55, v55, v131
    v_mfma_f32_16x16x32_bf16 v[92:95], a[160:163], v[112:115], v[92:95]
    v_mul_f32 v56, v56, v132
    v_mfma_f32_16x16x32_bf16 v[96:99], a[164:167], v[112:115], v[96:99]
    v_mul_f32 v57, v57, v133
    v_mul_f32 v58, v58, v134
    s_waitcnt lgkmcnt(2)
    v_mfma_f32_16x16x32_bf16 v[76:79], a[168:171], v[100:103], v[76:79]
    ds_read_b128 v[112:115], v11 offset:15360
    v_mul_f32 v59, v59, v135
    v_mul_f32 v60, v60, v136
    v_mfma_f32_16x16x32_bf16 v[80:83], a[172:175], v[100:103], v[80:83]
    v_mul_f32 v61, v61, v137
    v_mul_f32 v62, v62, v138
    v_mfma_f32_16x16x32_bf16 v[84:87], a[176:179], v[100:103], v[84:87]
    v_mul_f32 v63, v63, v139
    v_cvt_pk_bf16_f32 v64, v52, v53
    s_waitcnt lgkmcnt(2)
    v_mfma_f32_16x16x32_bf16 v[88:91], a[168:171], v[104:107], v[88:91]
    ds_read_b128 v[100:103], v8 offset:0
    v_cvt_pk_bf16_f32 v65, v54, v55
    v_cvt_pk_bf16_f32 v68, v56, v57
    v_mfma_f32_16x16x32_bf16 v[92:95], a[172:175], v[104:107], v[92:95]
    v_cvt_pk_bf16_f32 v69, v58, v59
    v_mfma_f32_16x16x32_bf16 v[96:99], a[176:179], v[104:107], v[96:99]
    v_cvt_pk_bf16_f32 v72, v60, v61
    v_cvt_pk_bf16_f32 v73, v62, v63
    s_waitcnt lgkmcnt(2)
    v_mfma_f32_16x16x32_bf16 v[76:79], a[180:183], v[108:111], v[76:79]
    ds_read_b128 v[104:107], v9 offset:0
    buffer_store_dwordx2 v[64:65], v12, s[28:31], s52 offen sc1
    buffer_store_dwordx2 v[68:69], v12, s[28:31], s53 offen sc1
    v_mfma_f32_16x16x32_bf16 v[80:83], a[184:187], v[108:111], v[80:83]
    buffer_store_dwordx2 v[72:73], v12, s[28:31], s54 offen sc1
    v_add_u32 v12, 176128, v12
    v_mfma_f32_16x16x32_bf16 v[84:87], a[188:191], v[108:111], v[84:87]
    s_waitcnt lgkmcnt(2)
    v_mfma_f32_16x16x32_bf16 v[88:91], a[180:183], v[112:115], v[88:91]
    ds_read_b128 v[108:111], v8 offset:1024
    v_mfma_f32_16x16x32_bf16 v[92:95], a[184:187], v[112:115], v[92:95]
    v_mfma_f32_16x16x32_bf16 v[96:99], a[188:191], v[112:115], v[96:99]
    s_waitcnt lgkmcnt(2)
    v_mfma_f32_16x16x32_bf16 v[52:55], a[0:3], v[100:103], 0
    ds_read_b128 v[112:115], v9 offset:1024
    ds_read_b32 v22, v17 offset:8
    ds_read_b32 v24, v18 offset:8
    v_mfma_f32_16x16x32_bf16 v[56:59], a[4:7], v[100:103], 0
    ds_read_b64 v[26:27], v20 offset:0
    v_mfma_f32_16x16x32_bf16 v[60:63], a[8:11], v[100:103], 0
    s_waitcnt lgkmcnt(2)
    v_mfma_f32_16x16x32_bf16 v[64:67], a[0:3], v[104:107], 0
    ds_read_b128 v[100:103], v8 offset:2048
    v_mfma_f32_16x16x32_bf16 v[68:71], a[4:7], v[104:107], 0
    v_mfma_f32_16x16x32_bf16 v[72:75], a[8:11], v[104:107], 0
    s_waitcnt lgkmcnt(2)
    v_mfma_f32_16x16x32_bf16 v[52:55], a[12:15], v[108:111], v[52:55]
    ds_read_b128 v[104:107], v9 offset:2048
    v_mfma_f32_16x16x32_bf16 v[56:59], a[16:19], v[108:111], v[56:59]
    v_fma_f32 v76, v32, v22, v76
    v_fma_f32 v77, v33, v22, v77
    v_mfma_f32_16x16x32_bf16 v[60:63], a[20:23], v[108:111], v[60:63]
    v_fma_f32 v78, v34, v22, v78
    s_waitcnt lgkmcnt(2)
    v_mfma_f32_16x16x32_bf16 v[64:67], a[12:15], v[112:115], v[64:67]
    ds_read_b128 v[108:111], v8 offset:3072
    v_fma_f32 v79, v35, v22, v79
    v_fma_f32 v88, v32, v24, v88
    v_mfma_f32_16x16x32_bf16 v[68:71], a[16:19], v[112:115], v[68:71]
    v_fma_f32 v89, v33, v24, v89
    v_fma_f32 v90, v34, v24, v90
    v_mfma_f32_16x16x32_bf16 v[72:75], a[20:23], v[112:115], v[72:75]
    v_fma_f32 v91, v35, v24, v91
    v_fma_f32 v80, v36, v22, v80
    v_add_u32 v10, 0x10000, v10
    v_add_u32 v11, 0x10000, v11
    s_waitcnt lgkmcnt(2)
    v_mfma_f32_16x16x32_bf16 v[52:55], a[24:27], v[100:103], v[52:55]
    ds_read_b128 v[112:115], v9 offset:3072
    v_fma_f32 v81, v37, v22, v81
    v_fma_f32 v82, v38, v22, v82
    v_mfma_f32_16x16x32_bf16 v[56:59], a[28:31], v[100:103], v[56:59]
    v_fma_f32 v83, v39, v22, v83
    v_mfma_f32_16x16x32_bf16 v[60:63], a[32:35], v[100:103], v[60:63]
    v_fma_f32 v92, v36, v24, v92
    v_fma_f32 v93, v37, v24, v93
    s_waitcnt lgkmcnt(2)
    v_mfma_f32_16x16x32_bf16 v[64:67], a[24:27], v[104:107], v[64:67]
    ds_read_b128 v[100:103], v8 offset:4096
    v_fma_f32 v94, v38, v24, v94
    v_fma_f32 v95, v39, v24, v95
    v_mfma_f32_16x16x32_bf16 v[68:71], a[28:31], v[104:107], v[68:71]
    v_fma_f32 v84, v40, v22, v84
    v_fma_f32 v85, v41, v22, v85
    v_mfma_f32_16x16x32_bf16 v[72:75], a[32:35], v[104:107], v[72:75]
    v_fma_f32 v86, v42, v22, v86
    v_fma_f32 v87, v43, v22, v87
    s_waitcnt lgkmcnt(2)
    v_mfma_f32_16x16x32_bf16 v[52:55], a[36:39], v[108:111], v[52:55]
    ds_read_b128 v[104:107], v9 offset:4096
    v_fma_f32 v96, v40, v24, v96
    v_mfma_f32_16x16x32_bf16 v[56:59], a[40:43], v[108:111], v[56:59]
    v_fma_f32 v97, v41, v24, v97
    v_fma_f32 v98, v42, v24, v98
    v_mfma_f32_16x16x32_bf16 v[60:63], a[44:47], v[108:111], v[60:63]
    v_fma_f32 v99, v43, v24, v99
    s_waitcnt lgkmcnt(2)
    v_mfma_f32_16x16x32_bf16 v[64:67], a[36:39], v[112:115], v[64:67]
    ds_read_b128 v[108:111], v8 offset:5120
    v_permlane32_swap_b32 v76, v88
    v_mfma_f32_16x16x32_bf16 v[68:71], a[40:43], v[112:115], v[68:71]
    v_permlane32_swap_b32 v77, v89
    v_mfma_f32_16x16x32_bf16 v[72:75], a[44:47], v[112:115], v[72:75]
    v_permlane32_swap_b32 v78, v90
    s_waitcnt lgkmcnt(2)
    v_mfma_f32_16x16x32_bf16 v[52:55], a[48:51], v[100:103], v[52:55]
    ds_read_b128 v[112:115], v9 offset:5120
    v_permlane32_swap_b32 v79, v91
    v_mfma_f32_16x16x32_bf16 v[56:59], a[52:55], v[100:103], v[56:59]
    v_permlane32_swap_b32 v80, v92
    v_mfma_f32_16x16x32_bf16 v[60:63], a[56:59], v[100:103], v[60:63]
    v_permlane32_swap_b32 v81, v93
    s_waitcnt lgkmcnt(2)
    v_mfma_f32_16x16x32_bf16 v[64:67], a[48:51], v[104:107], v[64:67]
    ds_read_b128 v[100:103], v8 offset:6144
    v_permlane32_swap_b32 v82, v94
    v_mfma_f32_16x16x32_bf16 v[68:71], a[52:55], v[104:107], v[68:71]
    v_permlane32_swap_b32 v83, v95
    v_mfma_f32_16x16x32_bf16 v[72:75], a[56:59], v[104:107], v[72:75]
    s_waitcnt lgkmcnt(2)
    v_mfma_f32_16x16x32_bf16 v[52:55], a[60:63], v[108:111], v[52:55]
    ds_read_b128 v[104:107], v9 offset:6144
    v_permlane32_swap_b32 v84, v96
    v_mfma_f32_16x16x32_bf16 v[56:59], a[64:67], v[108:111], v[56:59]
    v_permlane32_swap_b32 v85, v97
    v_mfma_f32_16x16x32_bf16 v[60:63], a[68:71], v[108:111], v[60:63]
    v_permlane32_swap_b32 v86, v98
    s_waitcnt lgkmcnt(2)
    v_mfma_f32_16x16x32_bf16 v[64:67], a[60:63], v[112:115], v[64:67]
    ds_read_b128 v[108:111], v8 offset:7168
    v_permlane32_swap_b32 v87, v99
    v_mul_f32 v128, v76, v26
    v_mfma_f32_16x16x32_bf16 v[68:71], a[64:67], v[112:115], v[68:71]
    v_mul_f32 v129, v77, v26
    v_mul_f32 v130, v78, v26
    v_mfma_f32_16x16x32_bf16 v[72:75], a[68:71], v[112:115], v[72:75]
    v_mul_f32 v131, v79, v26
    s_waitcnt lgkmcnt(2)
    v_mfma_f32_16x16x32_bf16 v[52:55], a[72:75], v[100:103], v[52:55]
    ds_read_b128 v[112:115], v9 offset:7168
    v_mul_f32 v132, v80, v26
    v_mul_f32 v133, v81, v26
    v_mfma_f32_16x16x32_bf16 v[56:59], a[76:79], v[100:103], v[56:59]
    v_mul_f32 v134, v82, v26
    v_mul_f32 v135, v83, v26
    v_mfma_f32_16x16x32_bf16 v[60:63], a[80:83], v[100:103], v[60:63]
    v_mul_f32 v136, v84, v26
    v_mul_f32 v137, v85, v26
    s_waitcnt lgkmcnt(2)
    v_mfma_f32_16x16x32_bf16 v[64:67], a[72:75], v[104:107], v[64:67]
    ds_read_b128 v[100:103], v8 offset:8192
    v_mul_f32 v138, v86, v26
    v_mul_f32 v139, v87, v26
    v_mfma_f32_16x16x32_bf16 v[68:71], a[76:79], v[104:107], v[68:71]
    v_mfma_f32_16x16x32_bf16 v[72:75], a[80:83], v[104:107], v[72:75]
    v_exp_f32 v128, v128
    s_waitcnt lgkmcnt(2)
    v_mfma_f32_16x16x32_bf16 v[52:55], a[84:87], v[108:111], v[52:55]
    ds_read_b128 v[104:107], v9 offset:8192
    v_exp_f32 v129, v129
    v_mfma_f32_16x16x32_bf16 v[56:59], a[88:91], v[108:111], v[56:59]
    v_exp_f32 v130, v130
    v_mfma_f32_16x16x32_bf16 v[60:63], a[92:95], v[108:111], v[60:63]
    v_exp_f32 v131, v131
    v_mul_f32 v76, v76, v88
    s_waitcnt lgkmcnt(2)
    v_mfma_f32_16x16x32_bf16 v[64:67], a[84:87], v[112:115], v[64:67]
    ds_read_b128 v[108:111], v8 offset:9216
    v_mul_f32 v77, v77, v89
    v_mfma_f32_16x16x32_bf16 v[68:71], a[88:91], v[112:115], v[68:71]
    v_mul_f32 v78, v78, v90
    v_mul_f32 v79, v79, v91
    v_mfma_f32_16x16x32_bf16 v[72:75], a[92:95], v[112:115], v[72:75]
    v_exp_f32 v132, v132
    s_waitcnt lgkmcnt(2)
    v_mfma_f32_16x16x32_bf16 v[52:55], a[96:99], v[100:103], v[52:55]
    ds_read_b128 v[112:115], v9 offset:9216
    v_exp_f32 v133, v133
    v_mfma_f32_16x16x32_bf16 v[56:59], a[100:103], v[100:103], v[56:59]
    v_exp_f32 v134, v134
    v_mfma_f32_16x16x32_bf16 v[60:63], a[104:107], v[100:103], v[60:63]
    v_exp_f32 v135, v135
    s_waitcnt lgkmcnt(2)
    v_mfma_f32_16x16x32_bf16 v[64:67], a[96:99], v[104:107], v[64:67]
    ds_read_b128 v[100:103], v8 offset:10240
    v_mul_f32 v80, v80, v92
    v_mfma_f32_16x16x32_bf16 v[68:71], a[100:103], v[104:107], v[68:71]
    v_mul_f32 v81, v81, v93
    v_mul_f32 v82, v82, v94
    v_mfma_f32_16x16x32_bf16 v[72:75], a[104:107], v[104:107], v[72:75]
    v_mul_f32 v83, v83, v95
    s_waitcnt lgkmcnt(2)
    v_mfma_f32_16x16x32_bf16 v[52:55], a[108:111], v[108:111], v[52:55]
    ds_read_b128 v[104:107], v9 offset:10240
    v_exp_f32 v136, v136
    v_mfma_f32_16x16x32_bf16 v[56:59], a[112:115], v[108:111], v[56:59]
    v_exp_f32 v137, v137
    v_mfma_f32_16x16x32_bf16 v[60:63], a[116:119], v[108:111], v[60:63]
    v_exp_f32 v138, v138
    s_waitcnt lgkmcnt(2)
    v_mfma_f32_16x16x32_bf16 v[64:67], a[108:111], v[112:115], v[64:67]
    ds_read_b128 v[108:111], v8 offset:11264
    v_exp_f32 v139, v139
    v_mfma_f32_16x16x32_bf16 v[68:71], a[112:115], v[112:115], v[68:71]
    v_mul_f32 v84, v84, v96
    v_mul_f32 v85, v85, v97
    v_mfma_f32_16x16x32_bf16 v[72:75], a[116:119], v[112:115], v[72:75]
    v_mul_f32 v86, v86, v98
    v_mul_f32 v87, v87, v99
    s_waitcnt lgkmcnt(2)
    v_mfma_f32_16x16x32_bf16 v[52:55], a[120:123], v[100:103], v[52:55]
    ds_read_b128 v[112:115], v9 offset:11264
    v_fma_f32 v128, v128, v27, v27
    v_fma_f32 v129, v129, v27, v27
    v_mfma_f32_16x16x32_bf16 v[56:59], a[124:127], v[100:103], v[56:59]
    v_fma_f32 v130, v130, v27, v27
    v_fma_f32 v131, v131, v27, v27
    v_mfma_f32_16x16x32_bf16 v[60:63], a[128:131], v[100:103], v[60:63]
    v_fma_f32 v132, v132, v27, v27
    s_waitcnt lgkmcnt(2)
    v_mfma_f32_16x16x32_bf16 v[64:67], a[120:123], v[104:107], v[64:67]
    ds_read_b128 v[100:103], v8 offset:12288
    v_fma_f32 v133, v133, v27, v27
    v_fma_f32 v134, v134, v27, v27
    v_mfma_f32_16x16x32_bf16 v[68:71], a[124:127], v[104:107], v[68:71]
    v_fma_f32 v135, v135, v27, v27
    v_fma_f32 v136, v136, v27, v27
    v_mfma_f32_16x16x32_bf16 v[72:75], a[128:131], v[104:107], v[72:75]
    v_fma_f32 v137, v137, v27, v27
    v_fma_f32 v138, v138, v27, v27
    s_waitcnt lgkmcnt(2)
    v_mfma_f32_16x16x32_bf16 v[52:55], a[132:135], v[108:111], v[52:55]
    ds_read_b128 v[104:107], v9 offset:12288
    v_fma_f32 v139, v139, v27, v27
    v_mfma_f32_16x16x32_bf16 v[56:59], a[136:139], v[108:111], v[56:59]
    v_rcp_f32 v128, v128
    v_mfma_f32_16x16x32_bf16 v[60:63], a[140:143], v[108:111], v[60:63]
    v_rcp_f32 v129, v129
    s_waitcnt lgkmcnt(2)
    v_mfma_f32_16x16x32_bf16 v[64:67], a[132:135], v[112:115], v[64:67]
    ds_read_b128 v[108:111], v8 offset:13312
    v_rcp_f32 v130, v130
    v_mfma_f32_16x16x32_bf16 v[68:71], a[136:139], v[112:115], v[68:71]
    v_rcp_f32 v131, v131
    v_mfma_f32_16x16x32_bf16 v[72:75], a[140:143], v[112:115], v[72:75]
    v_rcp_f32 v132, v132
    s_waitcnt lgkmcnt(2)
    v_mfma_f32_16x16x32_bf16 v[52:55], a[144:147], v[100:103], v[52:55]
    ds_read_b128 v[112:115], v9 offset:13312
    v_rcp_f32 v133, v133
    v_mfma_f32_16x16x32_bf16 v[56:59], a[148:151], v[100:103], v[56:59]
    v_mfma_f32_16x16x32_bf16 v[60:63], a[152:155], v[100:103], v[60:63]
    v_rcp_f32 v134, v134
    s_waitcnt lgkmcnt(2)
    v_mfma_f32_16x16x32_bf16 v[64:67], a[144:147], v[104:107], v[64:67]
    ds_read_b128 v[100:103], v8 offset:14336
    v_rcp_f32 v135, v135
    v_mfma_f32_16x16x32_bf16 v[68:71], a[148:151], v[104:107], v[68:71]
    v_rcp_f32 v136, v136
    v_mfma_f32_16x16x32_bf16 v[72:75], a[152:155], v[104:107], v[72:75]
    v_rcp_f32 v137, v137
    s_waitcnt lgkmcnt(2)
    v_mfma_f32_16x16x32_bf16 v[52:55], a[156:159], v[108:111], v[52:55]
    ds_read_b128 v[104:107], v9 offset:14336
    v_rcp_f32 v138, v138
    v_mfma_f32_16x16x32_bf16 v[56:59], a[160:163], v[108:111], v[56:59]
    v_rcp_f32 v139, v139
    v_mfma_f32_16x16x32_bf16 v[60:63], a[164:167], v[108:111], v[60:63]
    v_mul_f32 v76, v76, v128
    v_mul_f32 v77, v77, v129
    s_waitcnt lgkmcnt(2)
    v_mfma_f32_16x16x32_bf16 v[64:67], a[156:159], v[112:115], v[64:67]
    ds_read_b128 v[108:111], v8 offset:15360
    v_mul_f32 v78, v78, v130
    v_mul_f32 v79, v79, v131
    v_mfma_f32_16x16x32_bf16 v[68:71], a[160:163], v[112:115], v[68:71]
    v_mul_f32 v80, v80, v132
    v_mul_f32 v81, v81, v133
    v_mfma_f32_16x16x32_bf16 v[72:75], a[164:167], v[112:115], v[72:75]
    v_mul_f32 v82, v82, v134
    s_waitcnt lgkmcnt(2)
    v_mfma_f32_16x16x32_bf16 v[52:55], a[168:171], v[100:103], v[52:55]
    ds_read_b128 v[112:115], v9 offset:15360
    v_mul_f32 v83, v83, v135
    v_mul_f32 v84, v84, v136
    v_mfma_f32_16x16x32_bf16 v[56:59], a[172:175], v[100:103], v[56:59]
    v_mul_f32 v85, v85, v137
    v_mul_f32 v86, v86, v138
    v_mfma_f32_16x16x32_bf16 v[60:63], a[176:179], v[100:103], v[60:63]
    v_mul_f32 v87, v87, v139
    v_cvt_pk_bf16_f32 v88, v76, v77
    s_waitcnt lgkmcnt(2)
    v_mfma_f32_16x16x32_bf16 v[64:67], a[168:171], v[104:107], v[64:67]
    ds_read_b128 v[100:103], v10 offset:0
    v_cvt_pk_bf16_f32 v89, v78, v79
    v_cvt_pk_bf16_f32 v92, v80, v81
    v_mfma_f32_16x16x32_bf16 v[68:71], a[172:175], v[104:107], v[68:71]
    v_cvt_pk_bf16_f32 v93, v82, v83
    v_cvt_pk_bf16_f32 v96, v84, v85
    v_mfma_f32_16x16x32_bf16 v[72:75], a[176:179], v[104:107], v[72:75]
    v_cvt_pk_bf16_f32 v97, v86, v87
    s_waitcnt lgkmcnt(2)
    v_mfma_f32_16x16x32_bf16 v[52:55], a[180:183], v[108:111], v[52:55]
    ds_read_b128 v[104:107], v11 offset:0
    buffer_store_dwordx2 v[88:89], v13, s[28:31], s52 offen sc1
    buffer_store_dwordx2 v[92:93], v13, s[28:31], s53 offen sc1
    v_mfma_f32_16x16x32_bf16 v[56:59], a[184:187], v[108:111], v[56:59]
    buffer_store_dwordx2 v[96:97], v13, s[28:31], s54 offen sc1
    v_add_u32 v13, 176128, v13
    v_mfma_f32_16x16x32_bf16 v[60:63], a[188:191], v[108:111], v[60:63]
    s_waitcnt lgkmcnt(2)
    v_mfma_f32_16x16x32_bf16 v[64:67], a[180:183], v[112:115], v[64:67]
    ds_read_b128 v[108:111], v10 offset:1024
    v_mfma_f32_16x16x32_bf16 v[68:71], a[184:187], v[112:115], v[68:71]
    v_mfma_f32_16x16x32_bf16 v[72:75], a[188:191], v[112:115], v[72:75]
    s_waitcnt lgkmcnt(2)
    v_mfma_f32_16x16x32_bf16 v[76:79], a[0:3], v[100:103], 0
    ds_read_b128 v[112:115], v11 offset:1024
    ds_read_b32 v22, v15 offset:1032
    ds_read_b32 v24, v16 offset:1032
    v_mfma_f32_16x16x32_bf16 v[80:83], a[4:7], v[100:103], 0
    ds_read_b64 v[26:27], v19 offset:1024
    v_mfma_f32_16x16x32_bf16 v[84:87], a[8:11], v[100:103], 0
    s_waitcnt lgkmcnt(2)
    v_mfma_f32_16x16x32_bf16 v[88:91], a[0:3], v[104:107], 0
    ds_read_b128 v[100:103], v10 offset:2048
    v_mfma_f32_16x16x32_bf16 v[92:95], a[4:7], v[104:107], 0
    v_mfma_f32_16x16x32_bf16 v[96:99], a[8:11], v[104:107], 0
    s_waitcnt lgkmcnt(2)
    v_mfma_f32_16x16x32_bf16 v[76:79], a[12:15], v[108:111], v[76:79]
    ds_read_b128 v[104:107], v11 offset:2048
    v_mfma_f32_16x16x32_bf16 v[80:83], a[16:19], v[108:111], v[80:83]
    v_fma_f32 v52, v32, v22, v52
    v_fma_f32 v53, v33, v22, v53
    v_mfma_f32_16x16x32_bf16 v[84:87], a[20:23], v[108:111], v[84:87]
    v_fma_f32 v54, v34, v22, v54
    s_waitcnt lgkmcnt(2)
    v_mfma_f32_16x16x32_bf16 v[88:91], a[12:15], v[112:115], v[88:91]
    ds_read_b128 v[108:111], v10 offset:3072
    v_fma_f32 v55, v35, v22, v55
    v_fma_f32 v64, v32, v24, v64
    v_mfma_f32_16x16x32_bf16 v[92:95], a[16:19], v[112:115], v[92:95]
    v_fma_f32 v65, v33, v24, v65
    v_fma_f32 v66, v34, v24, v66
    v_mfma_f32_16x16x32_bf16 v[96:99], a[20:23], v[112:115], v[96:99]
    v_fma_f32 v67, v35, v24, v67
    v_fma_f32 v56, v36, v22, v56
    s_waitcnt lgkmcnt(2)
    v_mfma_f32_16x16x32_bf16 v[76:79], a[24:27], v[100:103], v[76:79]
    ds_read_b128 v[112:115], v11 offset:3072
    v_fma_f32 v57, v37, v22, v57
    v_fma_f32 v58, v38, v22, v58
    v_mfma_f32_16x16x32_bf16 v[80:83], a[28:31], v[100:103], v[80:83]
    v_fma_f32 v59, v39, v22, v59
    v_mfma_f32_16x16x32_bf16 v[84:87], a[32:35], v[100:103], v[84:87]
    v_fma_f32 v68, v36, v24, v68
    v_fma_f32 v69, v37, v24, v69
    s_waitcnt lgkmcnt(2)
    v_mfma_f32_16x16x32_bf16 v[88:91], a[24:27], v[104:107], v[88:91]
    ds_read_b128 v[100:103], v10 offset:4096
    v_fma_f32 v70, v38, v24, v70
    v_fma_f32 v71, v39, v24, v71
    v_mfma_f32_16x16x32_bf16 v[92:95], a[28:31], v[104:107], v[92:95]
    v_fma_f32 v60, v40, v22, v60
    v_fma_f32 v61, v41, v22, v61
    v_mfma_f32_16x16x32_bf16 v[96:99], a[32:35], v[104:107], v[96:99]
    v_fma_f32 v62, v42, v22, v62
    v_fma_f32 v63, v43, v22, v63
    s_waitcnt lgkmcnt(2)
    v_mfma_f32_16x16x32_bf16 v[76:79], a[36:39], v[108:111], v[76:79]
    ds_read_b128 v[104:107], v11 offset:4096
    v_fma_f32 v72, v40, v24, v72
    v_mfma_f32_16x16x32_bf16 v[80:83], a[40:43], v[108:111], v[80:83]
    v_fma_f32 v73, v41, v24, v73
    v_fma_f32 v74, v42, v24, v74
    v_mfma_f32_16x16x32_bf16 v[84:87], a[44:47], v[108:111], v[84:87]
    v_fma_f32 v75, v43, v24, v75
    s_waitcnt lgkmcnt(2)
    v_mfma_f32_16x16x32_bf16 v[88:91], a[36:39], v[112:115], v[88:91]
    ds_read_b128 v[108:111], v10 offset:5120
    v_permlane32_swap_b32 v52, v64
    v_mfma_f32_16x16x32_bf16 v[92:95], a[40:43], v[112:115], v[92:95]
    v_permlane32_swap_b32 v53, v65
    v_mfma_f32_16x16x32_bf16 v[96:99], a[44:47], v[112:115], v[96:99]
    v_permlane32_swap_b32 v54, v66
    s_waitcnt lgkmcnt(2)
    v_mfma_f32_16x16x32_bf16 v[76:79], a[48:51], v[100:103], v[76:79]
    ds_read_b128 v[112:115], v11 offset:5120
    v_permlane32_swap_b32 v55, v67
    v_mfma_f32_16x16x32_bf16 v[80:83], a[52:55], v[100:103], v[80:83]
    v_permlane32_swap_b32 v56, v68
    v_mfma_f32_16x16x32_bf16 v[84:87], a[56:59], v[100:103], v[84:87]
    v_permlane32_swap_b32 v57, v69
    s_waitcnt lgkmcnt(2)
    v_mfma_f32_16x16x32_bf16 v[88:91], a[48:51], v[104:107], v[88:91]
    ds_read_b128 v[100:103], v10 offset:6144
    v_permlane32_swap_b32 v58, v70
    v_mfma_f32_16x16x32_bf16 v[92:95], a[52:55], v[104:107], v[92:95]
    v_permlane32_swap_b32 v59, v71
    v_mfma_f32_16x16x32_bf16 v[96:99], a[56:59], v[104:107], v[96:99]
    s_waitcnt lgkmcnt(2)
    v_mfma_f32_16x16x32_bf16 v[76:79], a[60:63], v[108:111], v[76:79]
    ds_read_b128 v[104:107], v11 offset:6144
    v_permlane32_swap_b32 v60, v72
    v_mfma_f32_16x16x32_bf16 v[80:83], a[64:67], v[108:111], v[80:83]
    v_permlane32_swap_b32 v61, v73
    v_mfma_f32_16x16x32_bf16 v[84:87], a[68:71], v[108:111], v[84:87]
    v_permlane32_swap_b32 v62, v74
    s_waitcnt lgkmcnt(2)
    v_mfma_f32_16x16x32_bf16 v[88:91], a[60:63], v[112:115], v[88:91]
    ds_read_b128 v[108:111], v10 offset:7168
    v_permlane32_swap_b32 v63, v75
    v_mul_f32 v128, v52, v26
    v_mfma_f32_16x16x32_bf16 v[92:95], a[64:67], v[112:115], v[92:95]
    v_mul_f32 v129, v53, v26
    v_mul_f32 v130, v54, v26
    v_mfma_f32_16x16x32_bf16 v[96:99], a[68:71], v[112:115], v[96:99]
    v_mul_f32 v131, v55, v26
    s_add_u32 s36, s3, 7
    v_mov_b32 v30, s36
    v_mov_b32 v29, s64
    s_waitcnt vmcnt(0)
    s_barrier
    s_cmp_lg_u32 s18, 0
    s_cbranch_scc1 sg_24
    s_mov_b64 exec, 1
    s_cmp_eq_u32 s17, 1
    s_cbranch_scc1 ds_25_l
    buffer_store_dword v30, v29, s[28:31], 0 offen sc1
    s_branch ds_25_e
ds_25_l:
    buffer_store_dword v30, v29, s[28:31], 0 offen
ds_25_e:
    s_mov_b64 exec, -1
sg_24:
    s_waitcnt lgkmcnt(2)
    v_mfma_f32_16x16x32_bf16 v[76:79], a[72:75], v[100:103], v[76:79]
    ds_read_b128 v[112:115], v11 offset:7168
    v_mul_f32 v132, v56, v26
    v_mul_f32 v133, v57, v26
    v_mfma_f32_16x16x32_bf16 v[80:83], a[76:79], v[100:103], v[80:83]
    v_mul_f32 v134, v58, v26
    v_mul_f32 v135, v59, v26
    v_mfma_f32_16x16x32_bf16 v[84:87], a[80:83], v[100:103], v[84:87]
    v_mul_f32 v136, v60, v26
    v_mul_f32 v137, v61, v26
    s_waitcnt lgkmcnt(2)
    v_mfma_f32_16x16x32_bf16 v[88:91], a[72:75], v[104:107], v[88:91]
    ds_read_b128 v[100:103], v10 offset:8192
    v_mul_f32 v138, v62, v26
    v_mul_f32 v139, v63, v26
    v_mfma_f32_16x16x32_bf16 v[92:95], a[76:79], v[104:107], v[92:95]
    v_mfma_f32_16x16x32_bf16 v[96:99], a[80:83], v[104:107], v[96:99]
    v_exp_f32 v128, v128
    s_waitcnt lgkmcnt(2)
    v_mfma_f32_16x16x32_bf16 v[76:79], a[84:87], v[108:111], v[76:79]
    ds_read_b128 v[104:107], v11 offset:8192
    v_exp_f32 v129, v129
    v_mfma_f32_16x16x32_bf16 v[80:83], a[88:91], v[108:111], v[80:83]
    v_exp_f32 v130, v130
    v_mfma_f32_16x16x32_bf16 v[84:87], a[92:95], v[108:111], v[84:87]
    v_exp_f32 v131, v131
    v_mul_f32 v52, v52, v64
    s_waitcnt lgkmcnt(2)
    v_mfma_f32_16x16x32_bf16 v[88:91], a[84:87], v[112:115], v[88:91]
    ds_read_b128 v[108:111], v10 offset:9216
    v_mul_f32 v53, v53, v65
    v_mfma_f32_16x16x32_bf16 v[92:95], a[88:91], v[112:115], v[92:95]
    v_mul_f32 v54, v54, v66
    v_mul_f32 v55, v55, v67
    v_mfma_f32_16x16x32_bf16 v[96:99], a[92:95], v[112:115], v[96:99]
    v_exp_f32 v132, v132
    s_waitcnt lgkmcnt(2)
    v_mfma_f32_16x16x32_bf16 v[76:79], a[96:99], v[100:103], v[76:79]
    ds_read_b128 v[112:115], v11 offset:9216
    v_exp_f32 v133, v133
    v_mfma_f32_16x16x32_bf16 v[80:83], a[100:103], v[100:103], v[80:83]
    v_exp_f32 v134, v134
    v_mfma_f32_16x16x32_bf16 v[84:87], a[104:107], v[100:103], v[84:87]
    v_exp_f32 v135, v135
    s_waitcnt lgkmcnt(2)
    v_mfma_f32_16x16x32_bf16 v[88:91], a[96:99], v[104:107], v[88:91]
    ds_read_b128 v[100:103], v10 offset:10240
    v_mul_f32 v56, v56, v68
    v_mfma_f32_16x16x32_bf16 v[92:95], a[100:103], v[104:107], v[92:95]
    v_mul_f32 v57, v57, v69
    v_mul_f32 v58, v58, v70
    v_mfma_f32_16x16x32_bf16 v[96:99], a[104:107], v[104:107], v[96:99]
    v_mul_f32 v59, v59, v71
    s_waitcnt lgkmcnt(2)
    v_mfma_f32_16x16x32_bf16 v[76:79], a[108:111], v[108:111], v[76:79]
    ds_read_b128 v[104:107], v11 offset:10240
    v_exp_f32 v136, v136
    v_mfma_f32_16x16x32_bf16 v[80:83], a[112:115], v[108:111], v[80:83]
    v_exp_f32 v137, v137
    v_mfma_f32_16x16x32_bf16 v[84:87], a[116:119], v[108:111], v[84:87]
    v_exp_f32 v138, v138
    s_waitcnt lgkmcnt(2)
    v_mfma_f32_16x16x32_bf16 v[88:91], a[108:111], v[112:115], v[88:91]
    ds_read_b128 v[108:111], v10 offset:11264
    v_exp_f32 v139, v139
    v_mfma_f32_16x16x32_bf16 v[92:95], a[112:115], v[112:115], v[92:95]
    v_mul_f32 v60, v60, v72
    v_mul_f32 v61, v61, v73
    v_mfma_f32_16x16x32_bf16 v[96:99], a[116:119], v[112:115], v[96:99]
    v_mul_f32 v62, v62, v74
    v_mul_f32 v63, v63, v75
    s_waitcnt lgkmcnt(2)
    v_mfma_f32_16x16x32_bf16 v[76:79], a[120:123], v[100:103], v[76:79]
    ds_read_b128 v[112:115], v11 offset:11264
    v_fma_f32 v128, v128, v27, v27
    v_fma_f32 v129, v129, v27, v27
    v_mfma_f32_16x16x32_bf16 v[80:83], a[124:127], v[100:103], v[80:83]
    v_fma_f32 v130, v130, v27, v27
    v_fma_f32 v131, v131, v27, v27
    v_mfma_f32_16x16x32_bf16 v[84:87], a[128:131], v[100:103], v[84:87]
    v_fma_f32 v132, v132, v27, v27
    s_waitcnt lgkmcnt(2)
    v_mfma_f32_16x16x32_bf16 v[88:91], a[120:123], v[104:107], v[88:91]
    ds_read_b128 v[100:103], v10 offset:12288
    v_fma_f32 v133, v133, v27, v27
    v_fma_f32 v134, v134, v27, v27
    v_mfma_f32_16x16x32_bf16 v[92:95], a[124:127], v[104:107], v[92:95]
    v_fma_f32 v135, v135, v27, v27
    v_fma_f32 v136, v136, v27, v27
    v_mfma_f32_16x16x32_bf16 v[96:99], a[128:131], v[104:107], v[96:99]
    v_fma_f32 v137, v137, v27, v27
    v_fma_f32 v138, v138, v27, v27
    s_waitcnt lgkmcnt(2)
    v_mfma_f32_16x16x32_bf16 v[76:79], a[132:135], v[108:111], v[76:79]
    ds_read_b128 v[104:107], v11 offset:12288
    v_fma_f32 v139, v139, v27, v27
    v_mfma_f32_16x16x32_bf16 v[80:83], a[136:139], v[108:111], v[80:83]
    v_rcp_f32 v128, v128
    v_mfma_f32_16x16x32_bf16 v[84:87], a[140:143], v[108:111], v[84:87]
    v_rcp_f32 v129, v129
    s_waitcnt lgkmcnt(2)
    v_mfma_f32_16x16x32_bf16 v[88:91], a[132:135], v[112:115], v[88:91]
    ds_read_b128 v[108:111], v10 offset:13312
    v_rcp_f32 v130, v130
    v_mfma_f32_16x16x32_bf16 v[92:95], a[136:139], v[112:115], v[92:95]
    v_rcp_f32 v131, v131
    v_mfma_f32_16x16x32_bf16 v[96:99], a[140:143], v[112:115], v[96:99]
    v_rcp_f32 v132, v132
    s_waitcnt lgkmcnt(2)
    v_mfma_f32_16x16x32_bf16 v[76:79], a[144:147], v[100:103], v[76:79]
    ds_read_b128 v[112:115], v11 offset:13312
    v_rcp_f32 v133, v133
    v_mfma_f32_16x16x32_bf16 v[80:83], a[148:151], v[100:103], v[80:83]
    v_mfma_f32_16x16x32_bf16 v[84:87], a[152:155], v[100:103], v[84:87]
    v_rcp_f32 v134, v134
    s_waitcnt lgkmcnt(2)
    v_mfma_f32_16x16x32_bf16 v[88:91], a[144:147], v[104:107], v[88:91]
    ds_read_b128 v[100:103], v10 offset:14336
    v_rcp_f32 v135, v135
    v_mfma_f32_16x16x32_bf16 v[92:95], a[148:151], v[104:107], v[92:95]
    v_rcp_f32 v136, v136
    v_mfma_f32_16x16x32_bf16 v[96:99], a[152:155], v[104:107], v[96:99]
    v_rcp_f32 v137, v137
    s_waitcnt lgkmcnt(2)
    v_mfma_f32_16x16x32_bf16 v[76:79], a[156:159], v[108:111], v[76:79]
    ds_read_b128 v[104:107], v11 offset:14336
    v_rcp_f32 v138, v138
    v_mfma_f32_16x16x32_bf16 v[80:83], a[160:163], v[108:111], v[80:83]
    v_rcp_f32 v139, v139
    v_mfma_f32_16x16x32_bf16 v[84:87], a[164:167], v[108:111], v[84:87]
    v_mul_f32 v52, v52, v128
    v_mul_f32 v53, v53, v129
    s_waitcnt lgkmcnt(2)
    v_mfma_f32_16x16x32_bf16 v[88:91], a[156:159], v[112:115], v[88:91]
    ds_read_b128 v[108:111], v10 offset:15360
    v_mul_f32 v54, v54, v130
    v_mul_f32 v55, v55, v131
    v_mfma_f32_16x16x32_bf16 v[92:95], a[160:163], v[112:115], v[92:95]
    v_mul_f32 v56, v56, v132
    v_mul_f32 v57, v57, v133
    v_mfma_f32_16x16x32_bf16 v[96:99], a[164:167], v[112:115], v[96:99]
    v_mul_f32 v58, v58, v134
    s_waitcnt lgkmcnt(2)
    v_mfma_f32_16x16x32_bf16 v[76:79], a[168:171], v[100:103], v[76:79]
    ds_read_b128 v[112:115], v11 offset:15360
    v_mul_f32 v59, v59, v135
    v_mul_f32 v60, v60, v136
    v_mfma_f32_16x16x32_bf16 v[80:83], a[172:175], v[100:103], v[80:83]
    v_mul_f32 v61, v61, v137
    v_mul_f32 v62, v62, v138
    v_mfma_f32_16x16x32_bf16 v[84:87], a[176:179], v[100:103], v[84:87]
    v_mul_f32 v63, v63, v139
    v_cvt_pk_bf16_f32 v64, v52, v53
    s_waitcnt lgkmcnt(2)
    v_mfma_f32_16x16x32_bf16 v[88:91], a[168:171], v[104:107], v[88:91]
    v_cvt_pk_bf16_f32 v65, v54, v55
    v_cvt_pk_bf16_f32 v68, v56, v57
    v_mfma_f32_16x16x32_bf16 v[92:95], a[172:175], v[104:107], v[92:95]
    v_cvt_pk_bf16_f32 v69, v58, v59
    v_cvt_pk_bf16_f32 v72, v60, v61
    v_mfma_f32_16x16x32_bf16 v[96:99], a[176:179], v[104:107], v[96:99]
    v_cvt_pk_bf16_f32 v73, v62, v63
    s_waitcnt lgkmcnt(1)
    v_mfma_f32_16x16x32_bf16 v[76:79], a[180:183], v[108:111], v[76:79]
    buffer_store_dwordx2 v[64:65], v12, s[28:31], s52 offen sc1
    buffer_store_dwordx2 v[68:69], v12, s[28:31], s53 offen sc1
    v_mfma_f32_16x16x32_bf16 v[80:83], a[184:187], v[108:111], v[80:83]
    buffer_store_dwordx2 v[72:73], v12, s[28:31], s54 offen sc1
    v_add_u32 v12, 176128, v12
    v_mfma_f32_16x16x32_bf16 v[84:87], a[188:191], v[108:111], v[84:87]
    s_waitcnt lgkmcnt(0)
    v_mfma_f32_16x16x32_bf16 v[88:91], a[180:183], v[112:115], v[88:91]
    v_mfma_f32_16x16x32_bf16 v[92:95], a[184:187], v[112:115], v[92:95]
    v_mfma_f32_16x16x32_bf16 v[96:99], a[188:191], v[112:115], v[96:99]
    ds_read_b32 v22, v17 offset:1032
    ds_read_b32 v24, v18 offset:1032
    ds_read_b64 v[26:27], v20 offset:1024
    s_waitcnt lgkmcnt(0)
    v_pk_fma_f32 v[76:77], v[32:33], v[22:23], v[76:77] op_sel_hi:[1,0,1]
    v_pk_fma_f32 v[78:79], v[34:35], v[22:23], v[78:79] op_sel_hi:[1,0,1]
    v_pk_fma_f32 v[88:89], v[32:33], v[24:25], v[88:89] op_sel_hi:[1,0,1]
    v_pk_fma_f32 v[90:91], v[34:35], v[24:25], v[90:91] op_sel_hi:[1,0,1]
    v_pk_fma_f32 v[80:81], v[36:37], v[22:23], v[80:81] op_sel_hi:[1,0,1]
    v_pk_fma_f32 v[82:83], v[38:39], v[22:23], v[82:83] op_sel_hi:[1,0,1]
    v_pk_fma_f32 v[92:93], v[36:37], v[24:25], v[92:93] op_sel_hi:[1,0,1]
    v_pk_fma_f32 v[94:95], v[38:39], v[24:25], v[94:95] op_sel_hi:[1,0,1]
    v_pk_fma_f32 v[84:85], v[40:41], v[22:23], v[84:85] op_sel_hi:[1,0,1]
    v_pk_fma_f32 v[86:87], v[42:43], v[22:23], v[86:87] op_sel_hi:[1,0,1]
    v_pk_fma_f32 v[96:97], v[40:41], v[24:25], v[96:97] op_sel_hi:[1,0,1]
    v_pk_fma_f32 v[98:99], v[42:43], v[24:25], v[98:99] op_sel_hi:[1,0,1]
    v_permlane32_swap_b32 v76, v88
    v_permlane32_swap_b32 v77, v89
    v_permlane32_swap_b32 v78, v90
    v_permlane32_swap_b32 v79, v91
    v_permlane32_swap_b32 v80, v92
    v_permlane32_swap_b32 v81, v93
    v_permlane32_swap_b32 v82, v94
    v_permlane32_swap_b32 v83, v95
    v_permlane32_swap_b32 v84, v96
    v_permlane32_swap_b32 v85, v97
    v_permlane32_swap_b32 v86, v98
    v_permlane32_swap_b32 v87, v99
    v_pk_mul_f32 v[100:101], v[76:77], v[26:27] op_sel_hi:[1,0]
    v_pk_mul_f32 v[102:103], v[78:79], v[26:27] op_sel_hi:[1,0]
    v_pk_mul_f32 v[104:105], v[80:81], v[26:27] op_sel_hi:[1,0]
    v_pk_mul_f32 v[106:107], v[82:83], v[26:27] op_sel_hi:[1,0]
    v_pk_mul_f32 v[108:109], v[84:85], v[26:27] op_sel_hi:[1,0]
    v_pk_mul_f32 v[110:111], v[86:87], v[26:27] op_sel_hi:[1,0]
    v_exp_f32 v100, v100
    v_exp_f32 v101, v101
    v_exp_f32 v102, v102
    v_exp_f32 v103, v103
    v_exp_f32 v104, v104
    v_exp_f32 v105, v105
    v_exp_f32 v106, v106
    v_exp_f32 v107, v107
    v_exp_f32 v108, v108
    v_exp_f32 v109, v109
    v_exp_f32 v110, v110
    v_exp_f32 v111, v111
    v_pk_mul_f32 v[76:77], v[76:77], v[88:89]
    v_pk_mul_f32 v[78:79], v[78:79], v[90:91]
    v_pk_mul_f32 v[80:81], v[80:81], v[92:93]
    v_pk_mul_f32 v[82:83], v[82:83], v[94:95]
    v_pk_mul_f32 v[84:85], v[84:85], v[96:97]
    v_pk_mul_f32 v[86:87], v[86:87], v[98:99]
    v_pk_fma_f32 v[100:101], v[100:101], v[26:27], v[26:27] op_sel:[0,1,1] op_sel_hi:[1,1,1]
    v_pk_fma_f32 v[102:103], v[102:103], v[26:27], v[26:27] op_sel:[0,1,1] op_sel_hi:[1,1,1]
    v_pk_fma_f32 v[104:105], v[104:105], v[26:27], v[26:27] op_sel:[0,1,1] op_sel_hi:[1,1,1]
    v_pk_fma_f32 v[106:107], v[106:107], v[26:27], v[26:27] op_sel:[0,1,1] op_sel_hi:[1,1,1]
    v_pk_fma_f32 v[108:109], v[108:109], v[26:27], v[26:27] op_sel:[0,1,1] op_sel_hi:[1,1,1]
    v_pk_fma_f32 v[110:111], v[110:111], v[26:27], v[26:27] op_sel:[0,1,1] op_sel_hi:[1,1,1]
    v_rcp_f32 v100, v100
    v_rcp_f32 v101, v101
    v_rcp_f32 v102, v102
    v_rcp_f32 v103, v103
    v_rcp_f32 v104, v104
    v_rcp_f32 v105, v105
    v_rcp_f32 v106, v106
    v_rcp_f32 v107, v107
    v_rcp_f32 v108, v108
    v_rcp_f32 v109, v109
    v_rcp_f32 v110, v110
    v_rcp_f32 v111, v111
    v_pk_mul_f32 v[76:77], v[76:77], v[100:101]
    v_pk_mul_f32 v[78:79], v[78:79], v[102:103]
    v_pk_mul_f32 v[80:81], v[80:81], v[104:105]
    v_pk_mul_f32 v[82:83], v[82:83], v[106:107]
    v_pk_mul_f32 v[84:85], v[84:85], v[108:109]
    v_pk_mul_f32 v[86:87], v[86:87], v[110:111]
    v_cvt_pk_bf16_f32 v88, v76, v77
    v_cvt_pk_bf16_f32 v89, v78, v79
    v_cvt_pk_bf16_f32 v92, v80, v81
    v_cvt_pk_bf16_f32 v93, v82, v83
    v_cvt_pk_bf16_f32 v96, v84, v85
    v_cvt_pk_bf16_f32 v97, v86, v87
    buffer_store_dwordx2 v[88:89], v13, s[28:31], s52 offen sc1
    buffer_store_dwordx2 v[92:93], v13, s[28:31], s53 offen sc1
    buffer_store_dwordx2 v[96:97], v13, s[28:31], s54 offen sc1
    s_add_u32 s36, s3, 8
    v_mov_b32 v2, s36
    v_mov_b32 v3, s64
    s_waitcnt vmcnt(0)
    s_barrier
    s_cmp_lg_u32 s18, 0
    s_cbranch_scc1 sg_26
    s_mov_b64 exec, 1
    s_cmp_eq_u32 s17, 1
    s_cbranch_scc1 ds_27_l
    buffer_store_dword v2, v3, s[28:31], 0 offen sc1
    s_branch ds_27_e
ds_27_l:
    buffer_store_dword v2, v3, s[28:31], 0 offen
ds_27_e:
    s_mov_b64 exec, -1
sg_26:
    s_add_u32 s36, s18, 0
    s_and_b32 s36, s36, 3
    s_lshl_b32 s37, s20, 3
    s_add_u32 s36, s36, s37
    s_lshl_b32 s37, s22, 2
    s_add_u32 s36, s36, s37
    s_mul_i32 s36, s36, 44032
    s_mul_i32 s37, s18, 11264
    s_add_u32 s36, s36, s37
    s_add_u32 s56, s36, 16777216
    s_cmp_eq_u32 s18, 3
    s_cselect_b32 s60, 0x80000000, s56
    s_add_u32 s36, s18, 1
    s_and_b32 s36, s36, 3
    s_lshl_b32 s37, s20, 3
    s_add_u32 s36, s36, s37
    s_lshl_b32 s37, s22, 2
    s_add_u32 s36, s36, s37
    s_mul_i32 s36, s36, 44032
    s_mul_i32 s37, s18, 11264
    s_add_u32 s36, s36, s37
    s_add_u32 s57, s36, 16777216
    s_cmp_eq_u32 s18, 3
    s_cselect_b32 s61, 0x80000000, s57
    s_add_u32 s36, s18, 2
    s_and_b32 s36, s36, 3
    s_lshl_b32 s37, s20, 3
    s_add_u32 s36, s36, s37
    s_lshl_b32 s37, s22, 2
    s_add_u32 s36, s36, s37
    s_mul_i32 s36, s36, 44032
    s_mul_i32 s37, s18, 11264
    s_add_u32 s36, s36, s37
    s_add_u32 s58, s36, 16777216
    s_cmp_eq_u32 s18, 3
    s_cselect_b32 s62, 0x80000000, s58
    s_add_u32 s36, s18, 3
    s_and_b32 s36, s36, 3
    s_lshl_b32 s37, s20, 3
    s_add_u32 s36, s36, s37
    s_lshl_b32 s37, s22, 2
    s_add_u32 s36, s36, s37
    s_mul_i32 s36, s36, 44032
    s_mul_i32 s37, s18, 11264
    s_add_u32 s36, s36, s37
    s_add_u32 s59, s36, 16777216
    s_cmp_eq_u32 s18, 3
    s_cselect_b32 s63, 0x80000000, s59
    s_lshl_b32 s51, s18, 15
    v_lshrrev_b32 v2, 4, v1
    v_and_b32 v3, 15, v1
    v_lshlrev_b32 v8, 7, v2
    v_lshl_add_u32 v8, v3, 3, v8
    v_add_u32 v8, s51, v8
    s_add_u32 s50, s3, s22
    s_add_u32 s50, s50, 7
    s_cmp_lg_u32 s18, 0
    s_cbranch_scc1 ww_28
    v_and_b32 v9, 15, v1
    v_add_u32 v9, 0, v9
    v_lshlrev_b32 v9, 1, v9
    s_lshr_b32 s36, s20, 1
    s_lshl_b32 s36, s36, 5
    s_and_b32 s37, s20, 1
    s_add_u32 s36, s36, s37
    v_add_u32 v9, s36, v9
    v_lshlrev_b32 v9, 6, v9
    v_add_u32 v9, 9961472, v9
    s_mov_b32 s38, 0
    s_nop 0
wf_29:
    buffer_load_dword v116, v9, s[28:31], 0 offen sc1
    s_add_u32 s38, s38, 1
    s_waitcnt vmcnt(0)
    v_subrev_u32 v116, s50, v116
    v_cmp_gt_u32 vcc, 16, v116
    s_cmp_gt_u32 s38, 200000
    s_nop 2
    s_cbranch_scc1 wf_29_x
    s_cmp_eq_u64 vcc, -1
    s_cbranch_scc1 wf_29_x
    s_branch wf_29
wf_29_x:
ww_28:
    s_barrier
    v_add_u32 v10, s56, v31
    v_add_u32 v11, s57, v31
    v_add_u32 v12, s58, v31
    v_add_u32 v13, s59, v31
    s_mov_b32 s56, 0
    s_movk_i32 s57, 4096
    s_movk_i32 s58, 8192
    s_cmp_eq_u32 s18, 3
    s_cselect_b32 s59, 0x80000000, s58
    s_add_u32 m0, s51, 0
    s_nop 0
    buffer_load_dwordx4 v10, s[28:31], s56 offen offset:0 sc1 lds
    s_add_u32 m0, s51, 8192
    s_nop 0
    buffer_load_dwordx4 v11, s[28:31], s56 offen offset:0 sc1 lds
    s_add_u32 m0, s51, 16384
    s_nop 0
    buffer_load_dwordx4 v12, s[28:31], s56 offen offset:0 sc1 lds
    s_add_u32 m0, s51, 24576
    s_nop 0
    buffer_load_dwordx4 v13, s[28:31], s56 offen offset:0 sc1 lds
    s_add_u32 m0, s51, 0
    s_nop 0
    buffer_load_dwordx4 v10, s[28:31], s56 offen offset:1024 sc1 lds
    s_add_u32 m0, s51, 8192
    s_nop 0
    buffer_load_dwordx4 v11, s[28:31], s56 offen offset:1024 sc1 lds
    s_add_u32 m0, s51, 16384
    s_nop 0
    buffer_load_dwordx4 v12, s[28:31], s56 offen offset:1024 sc1 lds
    s_add_u32 m0, s51, 24576
    s_nop 0
    buffer_load_dwordx4 v13, s[28:31], s56 offen offset:1024 sc1 lds
    s_add_u32 m0, s51, 0
    s_nop 0
    buffer_load_dwordx4 v10, s[28:31], s56 offen offset:2048 sc1 lds
    s_add_u32 m0, s51, 8192
    s_nop 0
    buffer_load_dwordx4 v11, s[28:31], s56 offen offset:2048 sc1 lds
    s_add_u32 m0, s51, 16384
    s_nop 0
    buffer_load_dwordx4 v12, s[28:31], s56 offen offset:2048 sc1 lds
    s_add_u32 m0, s51, 24576
    s_nop 0
    buffer_load_dwordx4 v13, s[28:31], s56 offen offset:2048 sc1 lds
    s_add_u32 m0, s51, 0
    s_nop 0
    buffer_load_dwordx4 v10, s[28:31], s56 offen offset:3072 sc1 lds
    s_add_u32 m0, s51, 8192
    s_nop 0
    buffer_load_dwordx4 v11, s[28:31], s56 offen offset:3072 sc1 lds
    s_add_u32 m0, s51, 16384
    s_nop 0
    buffer_load_dwordx4 v12, s[28:31], s56 offen offset:3072 sc1 lds
    s_add_u32 m0, s51, 24576
    s_nop 0
    buffer_load_dwordx4 v13, s[28:31], s56 offen offset:3072 sc1 lds
    s_waitcnt vmcnt(13)
    ds_read_b64 v[116:117], v8 offset:0
    ds_read_b64 v[118:119], v8 offset:512
    ds_read_b64 v[120:121], v8 offset:8192
    ds_read_b64 v[122:123], v8 offset:8704
    ds_read_b64 v[124:125], v8 offset:16384
    ds_read_b64 v[126:127], v8 offset:16896
    v_add_u32 v9, s51, v31
    s_waitcnt lgkmcnt(4)
    v_mfma_f32_16x16x32_bf16 v[52:55], a[192:195], v[116:119], 0
    s_waitcnt vmcnt(12)
    ds_read_b64 v[128:129], v8 offset:24576
    ds_read_b64 v[130:131], v8 offset:25088
    v_mfma_f32_16x16x32_bf16 v[56:59], a[196:199], v[116:119], 0
    s_add_u32 m0, s51, 4096
    v_mfma_f32_16x16x32_bf16 v[60:63], a[200:203], v[116:119], 0
    buffer_load_dwordx4 v10, s[28:31], s57 offen offset:0 sc1 lds
    v_mfma_f32_16x16x32_bf16 v[64:67], a[204:207], v[116:119], 0
    s_waitcnt lgkmcnt(4)
    v_mfma_f32_16x16x32_bf16 v[68:71], a[192:195], v[120:123], 0
    s_waitcnt vmcnt(12)
    ds_read_b64 v[116:117], v8 offset:1024
    ds_read_b64 v[118:119], v8 offset:1536
    v_mfma_f32_16x16x32_bf16 v[72:75], a[196:199], v[120:123], 0
    s_add_u32 m0, s51, 12288
    v_mfma_f32_16x16x32_bf16 v[76:79], a[200:203], v[120:123], 0
    buffer_load_dwordx4 v11, s[28:31], s57 offen offset:0 sc1 lds
    v_mfma_f32_16x16x32_bf16 v[80:83], a[204:207], v[120:123], 0
    s_waitcnt lgkmcnt(4)
    v_mfma_f32_16x16x32_bf16 v[84:87], a[192:195], v[124:127], 0
    s_waitcnt vmcnt(12)
    ds_read_b64 v[120:121], v8 offset:9216
    ds_read_b64 v[122:123], v8 offset:9728
    v_mfma_f32_16x16x32_bf16 v[88:91], a[196:199], v[124:127], 0
    s_add_u32 m0, s51, 20480
    v_mfma_f32_16x16x32_bf16 v[92:95], a[200:203], v[124:127], 0
    buffer_load_dwordx4 v12, s[28:31], s57 offen offset:0 sc1 lds
    v_mfma_f32_16x16x32_bf16 v[96:99], a[204:207], v[124:127], 0
    s_waitcnt lgkmcnt(4)
    v_mfma_f32_16x16x32_bf16 v[100:103], a[192:195], v[128:131], 0
    s_waitcnt vmcnt(12)
    ds_read_b64 v[124:125], v8 offset:17408
    ds_read_b64 v[126:127], v8 offset:17920
    v_mfma_f32_16x16x32_bf16 v[104:107], a[196:199], v[128:131], 0
    s_add_u32 m0, s51, 28672
    v_mfma_f32_16x16x32_bf16 v[108:111], a[200:203], v[128:131], 0
    buffer_load_dwordx4 v13, s[28:31], s57 offen offset:0 sc1 lds
    v_mfma_f32_16x16x32_bf16 v[112:115], a[204:207], v[128:131], 0
    s_waitcnt lgkmcnt(4)
    v_mfma_f32_16x16x32_bf16 v[52:55], a[208:211], v[116:119], v[52:55]
    s_waitcnt vmcnt(12)
    ds_read_b64 v[128:129], v8 offset:25600
    ds_read_b64 v[130:131], v8 offset:26112
    v_mfma_f32_16x16x32_bf16 v[56:59], a[212:215], v[116:119], v[56:59]
    s_add_u32 m0, s51, 4096
    v_mfma_f32_16x16x32_bf16 v[60:63], a[216:219], v[116:119], v[60:63]
    buffer_load_dwordx4 v10, s[28:31], s57 offen offset:1024 sc1 lds
    v_mfma_f32_16x16x32_bf16 v[64:67], a[220:223], v[116:119], v[64:67]
    s_waitcnt lgkmcnt(4)
    v_mfma_f32_16x16x32_bf16 v[68:71], a[208:211], v[120:123], v[68:71]
    s_waitcnt vmcnt(12)
    ds_read_b64 v[116:117], v8 offset:2048
    ds_read_b64 v[118:119], v8 offset:2560
    v_mfma_f32_16x16x32_bf16 v[72:75], a[212:215], v[120:123], v[72:75]
    s_add_u32 m0, s51, 12288
    v_mfma_f32_16x16x32_bf16 v[76:79], a[216:219], v[120:123], v[76:79]
    buffer_load_dwordx4 v11, s[28:31], s57 offen offset:1024 sc1 lds
    v_mfma_f32_16x16x32_bf16 v[80:83], a[220:223], v[120:123], v[80:83]
    s_waitcnt lgkmcnt(4)
    v_mfma_f32_16x16x32_bf16 v[84:87], a[208:211], v[124:127], v[84:87]
    s_waitcnt vmcnt(12)
    ds_read_b64 v[120:121], v8 offset:10240
    ds_read_b64 v[122:123], v8 offset:10752
    v_mfma_f32_16x16x32_bf16 v[88:91], a[212:215], v[124:127], v[88:91]
    s_add_u32 m0, s51, 20480
    v_mfma_f32_16x16x32_bf16 v[92:95], a[216:219], v[124:127], v[92:95]
    buffer_load_dwordx4 v12, s[28:31], s57 offen offset:1024 sc1 lds
    v_mfma_f32_16x16x32_bf16 v[96:99], a[220:223], v[124:127], v[96:99]
    s_waitcnt lgkmcnt(4)
    v_mfma_f32_16x16x32_bf16 v[100:103], a[208:211], v[128:131], v[100:103]
    s_waitcnt vmcnt(12)
    ds_read_b64 v[124:125], v8 offset:18432
    ds_read_b64 v[126:127], v8 offset:18944
    v_mfma_f32_16x16x32_bf16 v[104:107], a[212:215], v[128:131], v[104:107]
    s_add_u32 m0, s51, 28672
    v_mfma_f32_16x16x32_bf16 v[108:111], a[216:219], v[128:131], v[108:111]
    buffer_load_dwordx4 v13, s[28:31], s57 offen offset:1024 sc1 lds
    v_mfma_f32_16x16x32_bf16 v[112:115], a[220:223], v[128:131], v[112:115]
    s_waitcnt lgkmcnt(4)
    v_mfma_f32_16x16x32_bf16 v[52:55], a[224:227], v[116:119], v[52:55]
    s_waitcnt vmcnt(12)
    ds_read_b64 v[128:129], v8 offset:26624
    ds_read_b64 v[130:131], v8 offset:27136
    v_mfma_f32_16x16x32_bf16 v[56:59], a[228:231], v[116:119], v[56:59]
    s_add_u32 m0, s51, 4096
    v_mfma_f32_16x16x32_bf16 v[60:63], a[232:235], v[116:119], v[60:63]
    buffer_load_dwordx4 v10, s[28:31], s57 offen offset:2048 sc1 lds
    v_mfma_f32_16x16x32_bf16 v[64:67], a[236:239], v[116:119], v[64:67]
    s_waitcnt lgkmcnt(4)
    v_mfma_f32_16x16x32_bf16 v[68:71], a[224:227], v[120:123], v[68:71]
    s_waitcnt vmcnt(12)
    ds_read_b64 v[116:117], v8 offset:3072
    ds_read_b64 v[118:119], v8 offset:3584
    v_mfma_f32_16x16x32_bf16 v[72:75], a[228:231], v[120:123], v[72:75]
    s_add_u32 m0, s51, 12288
    v_mfma_f32_16x16x32_bf16 v[76:79], a[232:235], v[120:123], v[76:79]
    buffer_load_dwordx4 v11, s[28:31], s57 offen offset:2048 sc1 lds
    v_mfma_f32_16x16x32_bf16 v[80:83], a[236:239], v[120:123], v[80:83]
    s_waitcnt lgkmcnt(4)
    v_mfma_f32_16x16x32_bf16 v[84:87], a[224:227], v[124:127], v[84:87]
    s_waitcnt vmcnt(12)
    ds_read_b64 v[120:121], v8 offset:11264
    ds_read_b64 v[122:123], v8 offset:11776
    v_mfma_f32_16x16x32_bf16 v[88:91], a[228:231], v[124:127], v[88:91]
    s_add_u32 m0, s51, 20480
    v_mfma_f32_16x16x32_bf16 v[92:95], a[232:235], v[124:127], v[92:95]
    buffer_load_dwordx4 v12, s[28:31], s57 offen offset:2048 sc1 lds
    v_mfma_f32_16x16x32_bf16 v[96:99], a[236:239], v[124:127], v[96:99]
    s_waitcnt lgkmcnt(4)
    v_mfma_f32_16x16x32_bf16 v[100:103], a[224:227], v[128:131], v[100:103]
    s_waitcnt vmcnt(12)
    ds_read_b64 v[124:125], v8 offset:19456
    ds_read_b64 v[126:127], v8 offset:19968
    v_mfma_f32_16x16x32_bf16 v[104:107], a[228:231], v[128:131], v[104:107]
    s_add_u32 m0, s51, 28672
    v_mfma_f32_16x16x32_bf16 v[108:111], a[232:235], v[128:131], v[108:111]
    buffer_load_dwordx4 v13, s[28:31], s57 offen offset:2048 sc1 lds
    v_mfma_f32_16x16x32_bf16 v[112:115], a[236:239], v[128:131], v[112:115]
    s_waitcnt lgkmcnt(4)
    v_mfma_f32_16x16x32_bf16 v[52:55], a[240:243], v[116:119], v[52:55]
    s_waitcnt vmcnt(12)
    ds_read_b64 v[128:129], v8 offset:27648
    ds_read_b64 v[130:131], v8 offset:28160
    v_mfma_f32_16x16x32_bf16 v[56:59], a[244:247], v[116:119], v[56:59]
    s_add_u32 m0, s51, 4096
    v_mfma_f32_16x16x32_bf16 v[60:63], a[248:251], v[116:119], v[60:63]
    buffer_load_dwordx4 v10, s[28:31], s57 offen offset:3072 sc1 lds
    v_mfma_f32_16x16x32_bf16 v[64:67], a[252:255], v[116:119], v[64:67]
    s_waitcnt lgkmcnt(4)
    v_mfma_f32_16x16x32_bf16 v[68:71], a[240:243], v[120:123], v[68:71]
    s_waitcnt vmcnt(12)
    ds_read_b64 v[116:117], v8 offset:4096
    ds_read_b64 v[118:119], v8 offset:4608
    v_mfma_f32_16x16x32_bf16 v[72:75], a[244:247], v[120:123], v[72:75]
    s_add_u32 m0, s51, 12288
    v_mfma_f32_16x16x32_bf16 v[76:79], a[248:251], v[120:123], v[76:79]
    buffer_load_dwordx4 v11, s[28:31], s57 offen offset:3072 sc1 lds
    v_mfma_f32_16x16x32_bf16 v[80:83], a[252:255], v[120:123], v[80:83]
    s_waitcnt lgkmcnt(4)
    v_mfma_f32_16x16x32_bf16 v[84:87], a[240:243], v[124:127], v[84:87]
    s_waitcnt vmcnt(12)
    ds_read_b64 v[120:121], v8 offset:12288
    ds_read_b64 v[122:123], v8 offset:12800
    v_mfma_f32_16x16x32_bf16 v[88:91], a[244:247], v[124:127], v[88:91]
    s_add_u32 m0, s51, 20480
    v_mfma_f32_16x16x32_bf16 v[92:95], a[248:251], v[124:127], v[92:95]
    buffer_load_dwordx4 v12, s[28:31], s57 offen offset:3072 sc1 lds
    v_mfma_f32_16x16x32_bf16 v[96:99], a[252:255], v[124:127], v[96:99]
    s_waitcnt lgkmcnt(4)
    v_mfma_f32_16x16x32_bf16 v[100:103], a[240:243], v[128:131], v[100:103]
    s_waitcnt vmcnt(12)
    ds_read_b64 v[124:125], v8 offset:20480
    ds_read_b64 v[126:127], v8 offset:20992
    v_mfma_f32_16x16x32_bf16 v[104:107], a[244:247], v[128:131], v[104:107]
    s_add_u32 m0, s51, 28672
    v_mfma_f32_16x16x32_bf16 v[108:111], a[248:251], v[128:131], v[108:111]
    buffer_load_dwordx4 v13, s[28:31], s57 offen offset:3072 sc1 lds
    v_mfma_f32_16x16x32_bf16 v[112:115], a[252:255], v[128:131], v[112:115]
    s_waitcnt lgkmcnt(4)
    v_mfma_f32_16x16x32_bf16 v[52:55], v[144:147], v[116:119], v[52:55]
    s_waitcnt vmcnt(12)
    ds_read_b64 v[128:129], v8 offset:28672
    ds_read_b64 v[130:131], v8 offset:29184
    v_mfma_f32_16x16x32_bf16 v[56:59], v[148:151], v[116:119], v[56:59]
    s_add_u32 m0, s51, 0
    v_mfma_f32_16x16x32_bf16 v[60:63], v[152:155], v[116:119], v[60:63]
    buffer_load_dwordx4 v10, s[28:31], s58 offen offset:0 sc1 lds
    v_mfma_f32_16x16x32_bf16 v[64:67], v[156:159], v[116:119], v[64:67]
    s_waitcnt lgkmcnt(4)
    v_mfma_f32_16x16x32_bf16 v[68:71], v[144:147], v[120:123], v[68:71]
    s_waitcnt vmcnt(12)
    ds_read_b64 v[116:117], v8 offset:5120
    ds_read_b64 v[118:119], v8 offset:5632
    v_mfma_f32_16x16x32_bf16 v[72:75], v[148:151], v[120:123], v[72:75]
    s_add_u32 m0, s51, 8192
    v_mfma_f32_16x16x32_bf16 v[76:79], v[152:155], v[120:123], v[76:79]
    buffer_load_dwordx4 v11, s[28:31], s58 offen offset:0 sc1 lds
    v_mfma_f32_16x16x32_bf16 v[80:83], v[156:159], v[120:123], v[80:83]
    s_waitcnt lgkmcnt(4)
    v_mfma_f32_16x16x32_bf16 v[84:87], v[144:147], v[124:127], v[84:87]
    s_waitcnt vmcnt(12)
    ds_read_b64 v[120:121], v8 offset:13312
    ds_read_b64 v[122:123], v8 offset:13824
    v_mfma_f32_16x16x32_bf16 v[88:91], v[148:151], v[124:127], v[88:91]
    s_add_u32 m0, s51, 16384
    v_mfma_f32_16x16x32_bf16 v[92:95], v[152:155], v[124:127], v[92:95]
    buffer_load_dwordx4 v12, s[28:31], s58 offen offset:0 sc1 lds
    v_mfma_f32_16x16x32_bf16 v[96:99], v[156:159], v[124:127], v[96:99]
    s_waitcnt lgkmcnt(4)
    v_mfma_f32_16x16x32_bf16 v[100:103], v[144:147], v[128:131], v[100:103]
    s_waitcnt vmcnt(12)
    ds_read_b64 v[124:125], v8 offset:21504
    ds_read_b64 v[126:127], v8 offset:22016
    v_mfma_f32_16x16x32_bf16 v[104:107], v[148:151], v[128:131], v[104:107]
    s_add_u32 m0, s51, 24576
    v_mfma_f32_16x16x32_bf16 v[108:111], v[152:155], v[128:131], v[108:111]
    buffer_load_dwordx4 v13, s[28:31], s58 offen offset:0 sc1 lds
    v_mfma_f32_16x16x32_bf16 v[112:115], v[156:159], v[128:131], v[112:115]
    s_waitcnt lgkmcnt(4)
    v_mfma_f32_16x16x32_bf16 v[52:55], v[160:163], v[116:119], v[52:55]
    s_waitcnt vmcnt(12)
    ds_read_b64 v[128:129], v8 offset:29696
    ds_read_b64 v[130:131], v8 offset:30208
    v_mfma_f32_16x16x32_bf16 v[56:59], v[164:167], v[116:119], v[56:59]
    s_add_u32 m0, s51, 0
    v_mfma_f32_16x16x32_bf16 v[60:63], v[168:171], v[116:119], v[60:63]
    buffer_load_dwordx4 v10, s[28:31], s58 offen offset:1024 sc1 lds
    v_mfma_f32_16x16x32_bf16 v[64:67], v[172:175], v[116:119], v[64:67]
    s_waitcnt lgkmcnt(4)
    v_mfma_f32_16x16x32_bf16 v[68:71], v[160:163], v[120:123], v[68:71]
    s_waitcnt vmcnt(12)
    ds_read_b64 v[116:117], v8 offset:6144
    ds_read_b64 v[118:119], v8 offset:6656
    v_mfma_f32_16x16x32_bf16 v[72:75], v[164:167], v[120:123], v[72:75]
    s_add_u32 m0, s51, 8192
    v_mfma_f32_16x16x32_bf16 v[76:79], v[168:171], v[120:123], v[76:79]
    buffer_load_dwordx4 v11, s[28:31], s58 offen offset:1024 sc1 lds
    v_mfma_f32_16x16x32_bf16 v[80:83], v[172:175], v[120:123], v[80:83]
    s_waitcnt lgkmcnt(4)
    v_mfma_f32_16x16x32_bf16 v[84:87], v[160:163], v[124:127], v[84:87]
    s_waitcnt vmcnt(12)
    ds_read_b64 v[120:121], v8 offset:14336
    ds_read_b64 v[122:123], v8 offset:14848
    v_mfma_f32_16x16x32_bf16 v[88:91], v[164:167], v[124:127], v[88:91]
    s_add_u32 m0, s51, 16384
    v_mfma_f32_16x16x32_bf16 v[92:95], v[168:171], v[124:127], v[92:95]
    buffer_load_dwordx4 v12, s[28:31], s58 offen offset:1024 sc1 lds
    v_mfma_f32_16x16x32_bf16 v[96:99], v[172:175], v[124:127], v[96:99]
    s_waitcnt lgkmcnt(4)
    v_mfma_f32_16x16x32_bf16 v[100:103], v[160:163], v[128:131], v[100:103]
    s_waitcnt vmcnt(12)
    ds_read_b64 v[124:125], v8 offset:22528
    ds_read_b64 v[126:127], v8 offset:23040
    v_mfma_f32_16x16x32_bf16 v[104:107], v[164:167], v[128:131], v[104:107]
    s_add_u32 m0, s51, 24576
    v_mfma_f32_16x16x32_bf16 v[108:111], v[168:171], v[128:131], v[108:111]
    buffer_load_dwordx4 v13, s[28:31], s58 offen offset:1024 sc1 lds
    v_mfma_f32_16x16x32_bf16 v[112:115], v[172:175], v[128:131], v[112:115]
    s_waitcnt lgkmcnt(4)
    v_mfma_f32_16x16x32_bf16 v[52:55], v[176:179], v[116:119], v[52:55]
    s_waitcnt vmcnt(12)
    ds_read_b64 v[128:129], v8 offset:30720
    ds_read_b64 v[130:131], v8 offset:31232
    v_mfma_f32_16x16x32_bf16 v[56:59], v[180:183], v[116:119], v[56:59]
    s_add_u32 m0, s51, 0
    v_mfma_f32_16x16x32_bf16 v[60:63], v[184:187], v[116:119], v[60:63]
    buffer_load_dwordx4 v10, s[28:31], s59 offen offset:2048 sc1 lds
    v_mfma_f32_16x16x32_bf16 v[64:67], v[188:191], v[116:119], v[64:67]
    s_waitcnt lgkmcnt(4)
    v_mfma_f32_16x16x32_bf16 v[68:71], v[176:179], v[120:123], v[68:71]
    s_waitcnt vmcnt(12)
    ds_read_b64 v[116:117], v8 offset:7168
    ds_read_b64 v[118:119], v8 offset:7680
    v_mfma_f32_16x16x32_bf16 v[72:75], v[180:183], v[120:123], v[72:75]
    s_add_u32 m0, s51, 8192
    v_mfma_f32_16x16x32_bf16 v[76:79], v[184:187], v[120:123], v[76:79]
    buffer_load_dwordx4 v11, s[28:31], s59 offen offset:2048 sc1 lds
    v_mfma_f32_16x16x32_bf16 v[80:83], v[188:191], v[120:123], v[80:83]
    s_waitcnt lgkmcnt(4)
    v_mfma_f32_16x16x32_bf16 v[84:87], v[176:179], v[124:127], v[84:87]
    s_waitcnt vmcnt(12)
    ds_read_b64 v[120:121], v8 offset:15360
    ds_read_b64 v[122:123], v8 offset:15872
    v_mfma_f32_16x16x32_bf16 v[88:91], v[180:183], v[124:127], v[88:91]
    s_add_u32 m0, s51, 16384
    v_mfma_f32_16x16x32_bf16 v[92:95], v[184:187], v[124:127], v[92:95]
    buffer_load_dwordx4 v12, s[28:31], s59 offen offset:2048 sc1 lds
    v_mfma_f32_16x16x32_bf16 v[96:99], v[188:191], v[124:127], v[96:99]
    s_waitcnt lgkmcnt(4)
    v_mfma_f32_16x16x32_bf16 v[100:103], v[176:179], v[128:131], v[100:103]
    s_waitcnt vmcnt(12)
    ds_read_b64 v[124:125], v8 offset:23552
    ds_read_b64 v[126:127], v8 offset:24064
    v_mfma_f32_16x16x32_bf16 v[104:107], v[180:183], v[128:131], v[104:107]
    s_add_u32 m0, s51, 24576
    v_mfma_f32_16x16x32_bf16 v[108:111], v[184:187], v[128:131], v[108:111]
    buffer_load_dwordx4 v13, s[28:31], s59 offen offset:2048 sc1 lds
    v_mfma_f32_16x16x32_bf16 v[112:115], v[188:191], v[128:131], v[112:115]
    s_waitcnt lgkmcnt(4)
    v_mfma_f32_16x16x32_bf16 v[52:55], v[192:195], v[116:119], v[52:55]
    s_waitcnt vmcnt(12)
    ds_read_b64 v[128:129], v8 offset:31744
    ds_read_b64 v[130:131], v8 offset:32256
    v_mfma_f32_16x16x32_bf16 v[56:59], v[196:199], v[116:119], v[56:59]
    v_mfma_f32_16x16x32_bf16 v[60:63], v[200:203], v[116:119], v[60:63]
    v_mfma_f32_16x16x32_bf16 v[64:67], v[204:207], v[116:119], v[64:67]
    s_waitcnt lgkmcnt(4)
    v_mfma_f32_16x16x32_bf16 v[68:71], v[192:195], v[120:123], v[68:71]
    s_waitcnt vmcnt(11)
    ds_read_b64 v[116:117], v8 offset:0
    ds_read_b64 v[118:119], v8 offset:512
    v_mfma_f32_16x16x32_bf16 v[72:75], v[196:199], v[120:123], v[72:75]
    v_mfma_f32_16x16x32_bf16 v[76:79], v[200:203], v[120:123], v[76:79]
    v_mfma_f32_16x16x32_bf16 v[80:83], v[204:207], v[120:123], v[80:83]
    s_waitcnt lgkmcnt(4)
    v_mfma_f32_16x16x32_bf16 v[84:87], v[192:195], v[124:127], v[84:87]
    s_waitcnt vmcnt(10)
    ds_read_b64 v[120:121], v8 offset:8192
    ds_read_b64 v[122:123], v8 offset:8704
    v_mfma_f32_16x16x32_bf16 v[88:91], v[196:199], v[124:127], v[88:91]
    v_mfma_f32_16x16x32_bf16 v[92:95], v[200:203], v[124:127], v[92:95]
    v_mfma_f32_16x16x32_bf16 v[96:99], v[204:207], v[124:127], v[96:99]
    s_waitcnt lgkmcnt(4)
    v_mfma_f32_16x16x32_bf16 v[100:103], v[192:195], v[128:131], v[100:103]
    s_waitcnt vmcnt(9)
    ds_read_b64 v[124:125], v8 offset:16384
    ds_read_b64 v[126:127], v8 offset:16896
    v_mfma_f32_16x16x32_bf16 v[104:107], v[196:199], v[128:131], v[104:107]
    v_mfma_f32_16x16x32_bf16 v[108:111], v[200:203], v[128:131], v[108:111]
    v_mfma_f32_16x16x32_bf16 v[112:115], v[204:207], v[128:131], v[112:115]
    s_waitcnt lgkmcnt(4)
    v_mfma_f32_16x16x32_bf16 v[52:55], v[208:211], v[116:119], v[52:55]
    s_waitcnt vmcnt(8)
    ds_read_b64 v[128:129], v8 offset:24576
    ds_read_b64 v[130:131], v8 offset:25088
    v_mfma_f32_16x16x32_bf16 v[56:59], v[212:215], v[116:119], v[56:59]
    v_mfma_f32_16x16x32_bf16 v[60:63], v[216:219], v[116:119], v[60:63]
    v_mfma_f32_16x16x32_bf16 v[64:67], v[220:223], v[116:119], v[64:67]
    s_waitcnt lgkmcnt(4)
    v_mfma_f32_16x16x32_bf16 v[68:71], v[208:211], v[120:123], v[68:71]
    s_waitcnt vmcnt(7)
    ds_read_b64 v[116:117], v8 offset:1024
    ds_read_b64 v[118:119], v8 offset:1536
    v_mfma_f32_16x16x32_bf16 v[72:75], v[212:215], v[120:123], v[72:75]
    v_mfma_f32_16x16x32_bf16 v[76:79], v[216:219], v[120:123], v[76:79]
    v_mfma_f32_16x16x32_bf16 v[80:83], v[220:223], v[120:123], v[80:83]
    s_waitcnt lgkmcnt(4)
    v_mfma_f32_16x16x32_bf16 v[84:87], v[208:211], v[124:127], v[84:87]
    s_waitcnt vmcnt(6)
    ds_read_b64 v[120:121], v8 offset:9216
    ds_read_b64 v[122:123], v8 offset:9728
    v_mfma_f32_16x16x32_bf16 v[88:91], v[212:215], v[124:127], v[88:91]
    v_mfma_f32_16x16x32_bf16 v[92:95], v[216:219], v[124:127], v[92:95]
    v_mfma_f32_16x16x32_bf16 v[96:99], v[220:223], v[124:127], v[96:99]
    s_waitcnt lgkmcnt(4)
    v_mfma_f32_16x16x32_bf16 v[100:103], v[208:211], v[128:131], v[100:103]
    s_waitcnt vmcnt(5)
    ds_read_b64 v[124:125], v8 offset:17408
    ds_read_b64 v[126:127], v8 offset:17920
    v_mfma_f32_16x16x32_bf16 v[104:107], v[212:215], v[128:131], v[104:107]
    v_mfma_f32_16x16x32_bf16 v[108:111], v[216:219], v[128:131], v[108:111]
    v_mfma_f32_16x16x32_bf16 v[112:115], v[220:223], v[128:131], v[112:115]
    s_waitcnt lgkmcnt(4)
    v_mfma_f32_16x16x32_bf16 v[52:55], v[224:227], v[116:119], v[52:55]
    s_waitcnt vmcnt(4)
    ds_read_b64 v[128:129], v8 offset:25600
    ds_read_b64 v[130:131], v8 offset:26112
    v_mfma_f32_16x16x32_bf16 v[56:59], v[228:231], v[116:119], v[56:59]
    v_mfma_f32_16x16x32_bf16 v[60:63], v[232:235], v[116:119], v[60:63]
    v_mfma_f32_16x16x32_bf16 v[64:67], v[236:239], v[116:119], v[64:67]
    s_waitcnt lgkmcnt(4)
    v_mfma_f32_16x16x32_bf16 v[68:71], v[224:227], v[120:123], v[68:71]
    s_waitcnt vmcnt(2)
    ds_read_b64 v[116:117], v8 offset:10240
    ds_read_b64 v[118:119], v8 offset:10752
    v_mfma_f32_16x16x32_bf16 v[72:75], v[228:231], v[120:123], v[72:75]
    v_mfma_f32_16x16x32_bf16 v[76:79], v[232:235], v[120:123], v[76:79]
    v_mfma_f32_16x16x32_bf16 v[80:83], v[236:239], v[120:123], v[80:83]
    s_waitcnt lgkmcnt(4)
    v_mfma_f32_16x16x32_bf16 v[84:87], v[224:227], v[124:127], v[84:87]
    s_waitcnt vmcnt(1)
    ds_read_b64 v[120:121], v8 offset:18432
    ds_read_b64 v[122:123], v8 offset:18944
    v_mfma_f32_16x16x32_bf16 v[88:91], v[228:231], v[124:127], v[88:91]
    v_mfma_f32_16x16x32_bf16 v[92:95], v[232:235], v[124:127], v[92:95]
    v_mfma_f32_16x16x32_bf16 v[96:99], v[236:239], v[124:127], v[96:99]
    s_waitcnt lgkmcnt(4)
    v_mfma_f32_16x16x32_bf16 v[100:103], v[224:227], v[128:131], v[100:103]
    s_waitcnt vmcnt(0)
    ds_read_b64 v[124:125], v8 offset:26624
    ds_read_b64 v[126:127], v8 offset:27136
    v_mfma_f32_16x16x32_bf16 v[104:107], v[228:231], v[128:131], v[104:107]
    v_mfma_f32_16x16x32_bf16 v[108:111], v[232:235], v[128:131], v[108:111]
    v_mfma_f32_16x16x32_bf16 v[112:115], v[236:239], v[128:131], v[112:115]
    s_waitcnt lgkmcnt(4)
    v_mfma_f32_16x16x32_bf16 v[68:71], v[240:243], v[116:119], v[68:71]
    ds_read_b64 v[128:129], v8 offset:2048
    ds_read_b64 v[130:131], v8 offset:2560
    v_mfma_f32_16x16x32_bf16 v[72:75], v[244:247], v[116:119], v[72:75]
    v_mfma_f32_16x16x32_bf16 v[76:79], v[248:251], v[116:119], v[76:79]
    v_mfma_f32_16x16x32_bf16 v[80:83], v[252:255], v[116:119], v[80:83]
    s_waitcnt lgkmcnt(4)
    v_mfma_f32_16x16x32_bf16 v[84:87], v[240:243], v[120:123], v[84:87]
    v_mfma_f32_16x16x32_bf16 v[88:91], v[244:247], v[120:123], v[88:91]
    v_mfma_f32_16x16x32_bf16 v[92:95], v[248:251], v[120:123], v[92:95]
    v_mfma_f32_16x16x32_bf16 v[96:99], v[252:255], v[120:123], v[96:99]
    s_waitcnt lgkmcnt(2)
    v_mfma_f32_16x16x32_bf16 v[100:103], v[240:243], v[124:127], v[100:103]
    v_mfma_f32_16x16x32_bf16 v[104:107], v[244:247], v[124:127], v[104:107]
    v_mfma_f32_16x16x32_bf16 v[108:111], v[248:251], v[124:127], v[108:111]
    v_mfma_f32_16x16x32_bf16 v[112:115], v[252:255], v[124:127], v[112:115]
    ds_write_b128 v9, v[68:71] offset:0
    ds_write_b128 v9, v[72:75] offset:1024
    ds_write_b128 v9, v[76:79] offset:2048
    ds_write_b128 v9, v[80:83] offset:3072
    s_waitcnt lgkmcnt(4)
    v_mfma_f32_16x16x32_bf16 v[52:55], v[240:243], v[128:131], v[52:55]
    v_mfma_f32_16x16x32_bf16 v[56:59], v[244:247], v[128:131], v[56:59]
    v_mfma_f32_16x16x32_bf16 v[60:63], v[248:251], v[128:131], v[60:63]
    v_mfma_f32_16x16x32_bf16 v[64:67], v[252:255], v[128:131], v[64:67]
    ds_write_b128 v9, v[84:87] offset:4096
    ds_write_b128 v9, v[88:91] offset:5120
    ds_write_b128 v9, v[92:95] offset:6144
    ds_write_b128 v9, v[96:99] offset:7168
    ds_write_b128 v9, v[100:103] offset:8192
    ds_write_b128 v9, v[104:107] offset:9216
    ds_write_b128 v9, v[108:111] offset:10240
    ds_write_b128 v9, v[112:115] offset:11264
    s_sub_u32 s36, s18, 1
    s_and_b32 s36, s36, 3
    s_lshl_b32 s36, s36, 15
    v_add_u32 v10, s36, v31
    s_sub_u32 s36, s18, 2
    s_and_b32 s36, s36, 3
    s_lshl_b32 s36, s36, 15
    v_add_u32 v11, s36, v31
    s_sub_u32 s36, s18, 3
    s_and_b32 s36, s36, 3
    s_lshl_b32 s36, s36, 15
    v_add_u32 v12, s36, v31
    s_waitcnt lgkmcnt(0)
    s_barrier
    ds_read_b128 v[68:71], v10 offset:0
    ds_read_b128 v[72:75], v10 offset:1024
    ds_read_b128 v[76:79], v10 offset:2048
    ds_read_b128 v[80:83], v10 offset:3072
    ds_read_b128 v[84:87], v11 offset:4096
    ds_read_b128 v[88:91], v11 offset:5120
    ds_read_b128 v[92:95], v11 offset:6144
    ds_read_b128 v[96:99], v11 offset:7168
    ds_read_b128 v[100:103], v12 offset:8192
    ds_read_b128 v[104:107], v12 offset:9216
    ds_read_b128 v[108:111], v12 offset:10240
    ds_read_b128 v[112:115], v12 offset:11264
    s_waitcnt lgkmcnt(8)
    v_pk_add_f32 v[52:53], v[52:53], v[68:69]
    v_pk_add_f32 v[54:55], v[54:55], v[70:71]
    v_pk_add_f32 v[56:57], v[56:57], v[72:73]
    v_pk_add_f32 v[58:59], v[58:59], v[74:75]
    v_pk_add_f32 v[60:61], v[60:61], v[76:77]
    v_pk_add_f32 v[62:63], v[62:63], v[78:79]
    v_pk_add_f32 v[64:65], v[64:65], v[80:81]
    v_pk_add_f32 v[66:67], v[66:67], v[82:83]
    s_waitcnt lgkmcnt(4)
    v_pk_add_f32 v[52:53], v[52:53], v[84:85]
    v_pk_add_f32 v[54:55], v[54:55], v[86:87]
    v_pk_add_f32 v[56:57], v[56:57], v[88:89]
    v_pk_add_f32 v[58:59], v[58:59], v[90:91]
    v_pk_add_f32 v[60:61], v[60:61], v[92:93]
    v_pk_add_f32 v[62:63], v[62:63], v[94:95]
    v_pk_add_f32 v[64:65], v[64:65], v[96:97]
    v_pk_add_f32 v[66:67], v[66:67], v[98:99]
    s_waitcnt lgkmcnt(0)
    v_pk_add_f32 v[52:53], v[52:53], v[100:101]
    v_pk_add_f32 v[54:55], v[54:55], v[102:103]
    v_pk_add_f32 v[56:57], v[56:57], v[104:105]
    v_pk_add_f32 v[58:59], v[58:59], v[106:107]
    v_pk_add_f32 v[60:61], v[60:61], v[108:109]
    v_pk_add_f32 v[62:63], v[62:63], v[110:111]
    v_pk_add_f32 v[64:65], v[64:65], v[112:113]
    v_pk_add_f32 v[66:67], v[66:67], v[114:115]
    s_waitcnt lgkmcnt(0)
    v_lshlrev_b32 v68, 16, v44
    v_and_b32 v69, 0xffff0000, v44
    v_lshlrev_b32 v70, 16, v45
    v_and_b32 v71, 0xffff0000, v45
    v_lshlrev_b32 v72, 16, v46
    v_and_b32 v73, 0xffff0000, v46
    v_lshlrev_b32 v74, 16, v47
    v_and_b32 v75, 0xffff0000, v47
    v_lshlrev_b32 v76, 16, v48
    v_and_b32 v77, 0xffff0000, v48
    v_lshlrev_b32 v78, 16, v49
    v_and_b32 v79, 0xffff0000, v49
    v_lshlrev_b32 v80, 16, v50
    v_and_b32 v81, 0xffff0000, v50
    v_lshlrev_b32 v82, 16, v51
    v_and_b32 v83, 0xffff0000, v51
    v_cvt_pk_bf16_f32 v100, v52, v53
    v_cvt_pk_bf16_f32 v101, v54, v55
    v_cvt_pk_bf16_f32 v102, v56, v57
    v_cvt_pk_bf16_f32 v103, v58, v59
    v_cvt_pk_bf16_f32 v104, v60, v61
    v_cvt_pk_bf16_f32 v105, v62, v63
    v_cvt_pk_bf16_f32 v106, v64, v65
    v_cvt_pk_bf16_f32 v107, v66, v67
    v_lshlrev_b32 v52, 16, v100
    v_and_b32 v53, 0xffff0000, v100
    v_lshlrev_b32 v54, 16, v101
    v_and_b32 v55, 0xffff0000, v101
    v_lshlrev_b32 v56, 16, v102
    v_and_b32 v57, 0xffff0000, v102
    v_lshlrev_b32 v58, 16, v103
    v_and_b32 v59, 0xffff0000, v103
    v_lshlrev_b32 v60, 16, v104
    v_and_b32 v61, 0xffff0000, v104
    v_lshlrev_b32 v62, 16, v105
    v_and_b32 v63, 0xffff0000, v105
    v_lshlrev_b32 v64, 16, v106
    v_and_b32 v65, 0xffff0000, v106
    v_lshlrev_b32 v66, 16, v107
    v_and_b32 v67, 0xffff0000, v107
    v_pk_add_f32 v[52:53], v[52:53], v[68:69]
    v_pk_add_f32 v[54:55], v[54:55], v[70:71]
    v_pk_add_f32 v[56:57], v[56:57], v[72:73]
    v_pk_add_f32 v[58:59], v[58:59], v[74:75]
    v_pk_add_f32 v[60:61], v[60:61], v[76:77]
    v_pk_add_f32 v[62:63], v[62:63], v[78:79]
    v_pk_add_f32 v[64:65], v[64:65], v[80:81]
    v_pk_add_f32 v[66:67], v[66:67], v[82:83]
    v_cvt_pk_bf16_f32 v100, v52, v53
    v_cvt_pk_bf16_f32 v101, v54, v55
    v_cvt_pk_bf16_f32 v102, v56, v57
    v_cvt_pk_bf16_f32 v103, v58, v59
    v_cvt_pk_bf16_f32 v104, v60, v61
    v_cvt_pk_bf16_f32 v105, v62, v63
    v_cvt_pk_bf16_f32 v106, v64, v65
    v_cvt_pk_bf16_f32 v107, v66, v67
    s_load_dwordx2 s[32:33], s[0:1], 80
    s_lshl_b32 s36, s20, 7
    s_lshl_b32 s37, s22, 6
    s_add_u32 s36, s36, s37
    s_lshl_b32 s37, s18, 4
    s_add_u32 s36, s36, s37
    s_lshl_b32 s36, s36, 10
    s_lshl_b32 s37, s23, 7
    s_add_u32 s36, s36, s37
    v_lshlrev_b32 v4, 10, v3
    v_lshl_add_u32 v4, v2, 5, v4
    s_waitcnt lgkmcnt(0)
    s_mov_b32 s34, 2097152
    s_mov_b32 s35, 0x20000
    buffer_store_dwordx4 v[100:103], v4, s[32:35], s36 offen
    buffer_store_dwordx4 v[104:107], v4, s[32:35], s36 offen offset:16
    s_or_b32 s36, s2, s18
    s_cmp_lg_u32 s36, 0
    s_cbranch_scc1 L_nogen
    s_add_u32 s36, s3, 16
    v_mov_b32 v2, s36
    v_mov_b32 v3, 9977856
    s_mov_b64 exec, 1
    buffer_store_dword v2, v3, s[28:31], 0 offen
    s_mov_b64 exec, -1
L_nogen:
L_end:
    s_endpgm
L_codeend:
    s_endpgm
.section .rodata,"a"
.p2align 6
.amdhsa_kernel interleave_layers__ssm_conv_h3__glu_gated_swiglu__prompt_kernel
  .amdhsa_next_free_vgpr 512
  .amdhsa_next_free_sgpr 102
  .amdhsa_accum_offset 256
  .amdhsa_group_segment_fixed_size 0
  .amdhsa_kernarg_size 104
  .amdhsa_user_sgpr_count 2
  .amdhsa_user_sgpr_kernarg_segment_ptr 1
  .amdhsa_system_sgpr_workgroup_id_x 1
  .amdhsa_float_denorm_mode_32 3
.end_amdhsa_kernel
```
